```python
import torch

def _softmax(x, axis=-1):
    return torch.softmax(x, dim=axis)

def _gelu(x):
    return torch.nn.functional.gelu(x, approximate='tanh')

def _silu(x):
    return torch.nn.functional.silu(x)

def _sigmoid(x):
    return torch.sigmoid(x)

def _layernorm(x, axis=-1, eps=1e-05):
    m = x.mean(dim=axis, keepdim=True)
    v = x.var(dim=axis, keepdim=True, unbiased=False)
    return (x - m) / torch.sqrt(v + eps)

def _scatter_add(tgt, idx, src, axis=0):
    return tgt.clone().index_add_(axis, idx, src)

def _segment_sum(src, seg, n):
    out = torch.zeros((n,) + src.shape[1:], dtype=src.dtype)
    return out.index_add_(0, seg, src)

def _pad(x, pw):
    flat = tuple((v for pair in reversed(pw) for v in pair))
    return torch.nn.functional.pad(x, flat)
kernel_name = 'interleave_layers__ssm_conv_h3__memory_aug_recurrent_mem_tr__prompt'

def setup_inputs():

    _w = lambda a: (lambda t: t.to(torch.bfloat16) if t.is_floating_point() else t)(torch.as_tensor(a))

    def _A_setup():
        B, S, D = (1, 2048, 576)
        ks = 4
        return {'q': _w((lambda *s: torch.randn(*s, dtype=torch.bfloat16) * 0.05)(B, S, D)), 'k': _w((lambda *s: torch.randn(*s, dtype=torch.bfloat16) * 0.2)(B, S, D)), 'v': _w((lambda *s: torch.randn(*s, dtype=torch.bfloat16) * 0.2)(B, S, D)), 'shift_k': _w((lambda *s: torch.randn(*s, dtype=torch.bfloat16) * 0.2)(D, ks) * 0.5), 'ssm_k': _w((lambda *s: torch.randn(*s, dtype=torch.bfloat16) * 0.4)(D, S) * (1.0 / S ** 0.5)), 'ssm_D': _w((lambda *s: torch.randn(*s, dtype=torch.bfloat16) * 0.2)(D))}
    _A_in = _A_setup()

    def _B_setup():
        B, S, Dm = (1, 2048, 576)
        H, Dh = (32, 128)
        M, seg = (8, 32)
        seg = min(seg, S)
        S = S // seg * seg
        return {'x': _w((lambda *s: torch.randn(*s, dtype=torch.bfloat16) * 0.05)(B, S, Dm)), 'mem0': _w((lambda *s: torch.randn(*s, dtype=torch.bfloat16) * 0.2)(B, M, Dm)), 'Wq': _w((lambda *s: torch.randn(*s, dtype=torch.bfloat16) * 1.6)(Dm, H, Dh) * Dm ** (-0.5)), 'Wk': _w((lambda *s: torch.randn(*s, dtype=torch.bfloat16) * 1.6)(Dm, H, Dh) * Dm ** (-0.5)), 'Wv': _w((lambda *s: torch.randn(*s, dtype=torch.bfloat16) * 0.2)(Dm, H, Dh) * Dm ** (-0.5)), 'Wo': _w((lambda *s: torch.randn(*s, dtype=torch.bfloat16) * 0.2)(H, Dh, Dm) * (H * Dh) ** (-0.5)), 'seg_len': seg}
    _B_in = _B_setup()
    return {'A_q': _A_in['q'], 'A_k': _A_in['k'], 'A_v': _A_in['v'], 'A_shift_k': _A_in['shift_k'], 'A_ssm_k': _A_in['ssm_k'], 'A_ssm_D': _A_in['ssm_D'], 'B_x': _B_in['x'], 'B_mem0': _B_in['mem0'], 'B_Wq': _B_in['Wq'], 'B_Wk': _B_in['Wk'], 'B_Wv': _B_in['Wv'], 'B_Wo': _B_in['Wo'], 'B_seg_len': _B_in['seg_len']}

def reference(A_q, A_k, A_v, A_shift_k, A_ssm_k, A_ssm_D, B_x, B_mem0, B_Wq, B_Wk, B_Wv, B_Wo, B_seg_len):

    def _A_ref(q, k, v, shift_k, ssm_k, ssm_D):
        B, S, D = q.shape
        ks = shift_k.shape[-1]
        k_pad = _pad(k, ((0, 0), (ks - 1, 0), (0, 0)))
        k_shift = torch.zeros_like(k)
        for t in range(ks):
            k_shift = k_shift + k_pad[:, t:t + S, :] * shift_k[:, ks - 1 - t][None, None, :]
        kv = k_shift * v
        L = 2 * S
        kv_pad = _pad(kv, ((0, 0), (0, S), (0, 0)))
        kf_pad = _pad(ssm_k, ((0, 0), (0, S)))
        kv_f = (lambda x, axes=(-2, -1): torch.fft.rfft2(x.float(), dim=axes))(kv_pad[:, None, :, :], axes=(1, 2))
        kf_f = (lambda x, axes=(-2, -1): torch.fft.rfft2(x.float(), dim=axes))(kf_pad[:, None, :], axes=(1, 2))
        kf_f = (lambda x, *d: x.permute(*d))(kf_f, 1, 2, 0)
        y_f = kv_f * kf_f[None, :, :, :]
        y = (lambda x, s, axes=(-2, -1): torch.fft.irfft2(x, s=s, dim=axes).to(torch.bfloat16))(y_f, (1, L), axes=(1, 2))[:, 0, :S, :]
        y = y + kv * ssm_D[None, None, :]
        return q * y

    def _B_ref(x, mem0, Wq, Wk, Wv, Wo, seg_len):
        B, S, Dm = x.shape
        H, Dh = (Wq.shape[1], Wq.shape[2])
        M = mem0.shape[1]
        scale = Dh ** (-0.5)
        n_seg = S // seg_len
        L = M + seg_len
        idx = torch.arange(L)
        mask = (idx[:, None] < M) | (idx[:, None] >= idx[None, :])
        mem = mem0
        outs = []
        for s in range(n_seg):
            xs = x[:, s * seg_len:(s + 1) * seg_len, :].clone()
            h = torch.concatenate([mem, xs], axis=1)
            q = torch.einsum('btd,dhe->bhte', h, Wq)
            k = torch.einsum('btd,dhe->bhte', h, Wk)
            v = torch.einsum('btd,dhe->bhte', h, Wv)
            scores = torch.einsum('bhqe,bhke->bhqk', q, k) * scale
            scores = torch.where(mask[None, None], scores, -1000000000.0)
            p = _softmax(scores, axis=-1)
            o = torch.einsum('bhqk,bhke->bhqe', p, v)
            o = torch.einsum('bhte,hed->btd', o, Wo)
            mem = o[:, :M, :].clone()
            outs.append(o[:, M:, :])
        return torch.concatenate(outs, axis=1)
    x = A_q
    x = x + _A_ref(_layernorm(x, axis=-1), A_k, A_v, A_shift_k, A_ssm_k, A_ssm_D)
    x = x + _B_ref(_layernorm(x, axis=-1), B_mem0, B_Wq, B_Wk, B_Wv, B_Wo, B_seg_len)
    x = x + _A_ref(_layernorm(x, axis=-1), A_k, A_v, A_shift_k, A_ssm_k, A_ssm_D)
    x = x + _B_ref(_layernorm(x, axis=-1), B_mem0, B_Wq, B_Wk, B_Wv, B_Wo, B_seg_len)
    return x
```

```asm
; @launch grid=(256,1,1) block=(256,1,1) lds=163840
.amdgcn_target "amdgcn-amd-amdhsa--gfx950"
.text
.globl interleave_layers__ssm_conv_h3__memory_aug_recurrent_mem_tr__prompt_kernel
.p2align 8
.type interleave_layers__ssm_conv_h3__memory_aug_recurrent_mem_tr__prompt_kernel,@function
interleave_layers__ssm_conv_h3__memory_aug_recurrent_mem_tr__prompt_kernel:
    s_cmp_ge_u32 s2, 256
    s_cbranch_scc1 L_abort
    s_load_dwordx16 s[16:31], s[0:1], 0
    s_load_dwordx16 s[32:47], s[0:1], 64
    s_getreg_b32 s61, hwreg(HW_REG_XCC_ID, 0, 3)
    s_getpc_b64 s[64:65]
    s_lshr_b32 s63, s2, 3
    s_and_b32 s63, s63, 3
    s_lshl_b32 s63, s63, 15
    v_lshlrev_b32 v2, 7, v0
    v_add_u32 v2, s63, v2
    v_min_u32 v2, L_abort - interleave_layers__ssm_conv_h3__memory_aug_recurrent_mem_tr__prompt_kernel - 256, v2
    global_load_dword v255, v2, s[64:65]
    v_lshrrev_b32 v1, 6, v0
    v_and_b32 v0, 63, v0
    v_readfirstlane_b32 s3, v1
    s_lshl_b32 s4, s61, 2
    s_lshr_b32 s4, 0x53721460, s4
    s_and_b32 s4, s4, 7
    s_lshr_b32 s5, s2, 3
    s_mov_b32 s6, 0
    s_mov_b32 s7, 0
    s_mov_b32 s62, 0
    s_waitcnt lgkmcnt(0)
    s_mov_b32 s8, s46
    s_mov_b32 s9, s47
    s_mov_b32 s10, 268435456
    s_mov_b32 s11, 0x20000
    s_mov_b32 s12, s44
    s_mov_b32 s13, s45
    s_mov_b32 s14, 256
    s_mov_b32 s15, 0x20000
L_restart:
    s_cmp_ge_u32 s4, 3
    s_cbranch_scc1 L_pro
    s_cmp_lg_u32 s3, 0
    s_cbranch_scc1 L_reg_1
    s_lshl_b32 s64, 1, s5
    s_mov_b32 s65, 0x100
    s_lshl_b32 s63, s4, 2
    s_add_u32 s63, s63, s7
    s_lshl_b32 s63, s63, 3
    s_atomic_add_x2 s[64:65], s[44:45], s63
    s_nop 4
L_reg_1:
    s_branch L_main
L_pro:
    s_sub_u32 s66, s4, 3
    s_mul_i32 s66, s66, 29
    s_add_u32 s66, s66, s5
    s_cmp_ge_u32 s5, 29
    s_cbranch_scc1 L_noconv
    s_cmp_ge_u32 s66, 144
    s_cbranch_scc1 L_noconv
    s_cmp_lg_u32 s3, 0
    s_cbranch_scc1 L_reg_2
    s_lshl_b32 s64, 1, s5
    s_mov_b32 s65, 0x100
    s_lshl_b32 s63, s4, 2
    s_add_u32 s63, s63, s7
    s_lshl_b32 s63, s63, 3
    s_atomic_add_x2 s[64:65], s[44:45], s63
    s_nop 4
L_reg_2:
    s_mov_b32 s62, s66
    s_mov_b32 s48, s18
    s_mov_b32 s49, s19
    s_mov_b32 s50, 2359296
    s_mov_b32 s51, 0x20000
    s_mov_b32 s52, s20
    s_mov_b32 s53, s21
    s_mov_b32 s54, 2359296
    s_mov_b32 s55, 0x20000
    s_mov_b32 s56, s24
    s_mov_b32 s57, s25
    s_mov_b32 s58, 2359296
    s_mov_b32 s59, 0x20000
    s_mov_b32 s72, s22
    s_mov_b32 s73, s23
    s_mov_b32 s74, 4608
    s_mov_b32 s75, 0x20000
    s_lshl_b32 s67, s66, 2
    s_lshl_b32 s68, s66, 3
    s_add_u32 s70, s26, s68
    s_addc_u32 s71, s27, 0
    s_load_dwordx2 s[98:99], s[70:71], 0
    s_lshl_b32 s68, s66, 8
    s_lshl_b32 s69, s3, 6
    s_add_u32 s68, s68, s69
    v_add_u32 v1, s68, v0
    s_mov_b32 s70, 29826162
    v_mul_hi_u32 v4, s70, v1
    v_mul_u32_u24 v5, 144, v4
    v_sub_u32 v5, v1, v5
    v_mul_u32_u24 v2, 9216, v4
    v_lshl_add_u32 v2, v5, 3, v2
    v_subrev_u32 v3, 3456, v2
    v_cmp_eq_u32 vcc, 0, v4
    v_mov_b32 v8, 0x7ff00000
    s_nop 0
    v_cndmask_b32 v3, v3, v8, vcc
    v_lshlrev_b32 v5, 5, v5
    s_mov_b32 s69, 4608
    v_and_b32 v56, 3, v0
    buffer_load_dwordx4 v[96:99], v5, s[72:75], 0 offen
    buffer_load_dwordx4 v[100:103], v5, s[72:75], 0 offen offset:16
    buffer_load_dwordx2 v[16:17], v3, s[48:51], 0 offen offset:0
    buffer_load_dwordx2 v[18:19], v3, s[48:51], 0 offen offset:1152
    buffer_load_dwordx2 v[20:21], v3, s[48:51], 0 offen offset:2304
    buffer_load_dwordx2 v[22:23], v2, s[48:51], 0 offen offset:0
    buffer_load_dwordx2 v[24:25], v2, s[48:51], 0 offen offset:1152
    buffer_load_dwordx2 v[26:27], v2, s[48:51], 0 offen offset:2304
    buffer_load_dwordx2 v[28:29], v2, s[48:51], 0 offen offset:3456
    buffer_load_dwordx2 v[30:31], v2, s[48:51], s69 offen offset:0
    buffer_load_dwordx2 v[32:33], v2, s[48:51], s69 offen offset:1152
    buffer_load_dwordx2 v[34:35], v2, s[48:51], s69 offen offset:2304
    buffer_load_dwordx2 v[36:37], v2, s[48:51], s69 offen offset:3456
    buffer_load_dwordx2 v[40:41], v2, s[52:55], 0 offen offset:0
    buffer_load_dwordx2 v[42:43], v2, s[52:55], 0 offen offset:1152
    buffer_load_dwordx2 v[44:45], v2, s[52:55], 0 offen offset:2304
    buffer_load_dwordx2 v[46:47], v2, s[52:55], 0 offen offset:3456
    buffer_load_dwordx2 v[48:49], v2, s[52:55], s69 offen offset:0
    buffer_load_dwordx2 v[50:51], v2, s[52:55], s69 offen offset:1152
    buffer_load_dwordx2 v[52:53], v2, s[52:55], s69 offen offset:2304
    buffer_load_dwordx2 v[54:55], v2, s[52:55], s69 offen offset:3456
    s_lshl_b32 s80, s68, 6
    s_add_u32 s80, s80, 41943040
    s_add_u32 s68, s67, s3
    s_lshl_b32 s68, s68, 12
    v_lshlrev_b32 v10, 4, v0
    v_cmp_eq_u32 vcc, 3, v0
    s_nop 1
    v_cndmask_b32 v7, v8, v0, vcc
    v_and_b32 v7, 0xfffffff0, v7
    v_mov_b64 v[176:177], 0
    v_mov_b64 v[178:179], 0
    buffer_load_dwordx4 v[144:147], v10, s[56:59], s68 offen offset:0
    buffer_load_dwordx2 v[148:149], v10, s[56:59], s68 offen offset:16
    buffer_load_dwordx4 v[152:155], v10, s[56:59], s68 offen offset:1024
    buffer_load_dwordx2 v[156:157], v10, s[56:59], s68 offen offset:1040
    buffer_load_dwordx4 v[160:163], v10, s[56:59], s68 offen offset:2048
    buffer_load_dwordx2 v[164:165], v10, s[56:59], s68 offen offset:2064
    buffer_load_dwordx4 v[168:171], v10, s[56:59], s68 offen offset:3072
    buffer_load_dwordx2 v[172:173], v10, s[56:59], s68 offen offset:3088
    buffer_load_dwordx2 v[180:181], v7, s[56:59], s68 offen
    v_mov_b32 v12, 0
    v_mov_b32 v13, 0
    v_mov_b32 v14, 0
    v_mov_b32 v15, 0
    v_lshrrev_b32 v57, 2, v0
    v_mul_u32_u24 v57, 80, v57
    v_lshl_add_u32 v57, v56, 4, v57
    s_mul_i32 s69, s3, 5120
    s_add_u32 s69, s69, 97280
    v_add_u32 v61, s69, v57
    s_mul_i32 s71, s3, 7680
    s_add_u32 s71, s71, 71680
    v_add_u32 v57, s71, v57
    ds_write_b128 v57, v[12:15]
    ds_write_b128 v57, v[12:15] offset:1280
    v_mul_u32_u24 v60, 80, v0
    v_add_u32 v60, s69, v60
    s_waitcnt vmcnt(9)
    v_lshlrev_b32 v104, 16, v96
    v_and_b32 v105, 0xffff0000, v96
    v_lshlrev_b32 v106, 16, v97
    v_and_b32 v107, 0xffff0000, v97
    v_lshlrev_b32 v108, 16, v98
    v_and_b32 v109, 0xffff0000, v98
    v_lshlrev_b32 v110, 16, v99
    v_and_b32 v111, 0xffff0000, v99
    v_lshlrev_b32 v112, 16, v100
    v_and_b32 v113, 0xffff0000, v100
    v_lshlrev_b32 v114, 16, v101
    v_and_b32 v115, 0xffff0000, v101
    v_lshlrev_b32 v116, 16, v102
    v_and_b32 v117, 0xffff0000, v102
    v_lshlrev_b32 v118, 16, v103
    v_and_b32 v119, 0xffff0000, v103
    v_lshlrev_b32 v64, 16, v16
    v_lshlrev_b32 v65, 16, v18
    v_lshlrev_b32 v66, 16, v20
    v_lshlrev_b32 v67, 16, v22
    v_lshlrev_b32 v68, 16, v24
    v_lshlrev_b32 v69, 16, v26
    v_lshlrev_b32 v70, 16, v28
    v_lshlrev_b32 v71, 16, v30
    v_lshlrev_b32 v72, 16, v32
    v_lshlrev_b32 v73, 16, v34
    v_lshlrev_b32 v74, 16, v36
    v_mul_f32 v80, v107, v64
    v_mul_f32 v81, v107, v65
    v_mul_f32 v82, v107, v66
    v_mul_f32 v83, v107, v67
    v_mul_f32 v84, v107, v68
    v_mul_f32 v85, v107, v69
    v_mul_f32 v86, v107, v70
    v_mul_f32 v87, v107, v71
    v_fmac_f32 v80, v106, v65
    v_fmac_f32 v81, v106, v66
    v_fmac_f32 v82, v106, v67
    v_fmac_f32 v83, v106, v68
    v_fmac_f32 v84, v106, v69
    v_fmac_f32 v85, v106, v70
    v_fmac_f32 v86, v106, v71
    v_fmac_f32 v87, v106, v72
    v_fmac_f32 v80, v105, v66
    v_fmac_f32 v81, v105, v67
    v_fmac_f32 v82, v105, v68
    v_fmac_f32 v83, v105, v69
    v_fmac_f32 v84, v105, v70
    v_fmac_f32 v85, v105, v71
    v_fmac_f32 v86, v105, v72
    v_fmac_f32 v87, v105, v73
    v_fmac_f32 v80, v104, v67
    v_fmac_f32 v81, v104, v68
    v_fmac_f32 v82, v104, v69
    v_fmac_f32 v83, v104, v70
    v_fmac_f32 v84, v104, v71
    v_fmac_f32 v85, v104, v72
    v_fmac_f32 v86, v104, v73
    v_fmac_f32 v87, v104, v74
    v_lshlrev_b32 v64, 16, v40
    v_lshlrev_b32 v65, 16, v42
    v_lshlrev_b32 v66, 16, v44
    v_lshlrev_b32 v67, 16, v46
    v_lshlrev_b32 v68, 16, v48
    v_lshlrev_b32 v69, 16, v50
    v_lshlrev_b32 v70, 16, v52
    v_lshlrev_b32 v71, 16, v54
    v_pk_mul_f32 v[80:81], v[80:81], v[64:65]
    v_pk_mul_f32 v[82:83], v[82:83], v[66:67]
    v_pk_mul_f32 v[84:85], v[84:85], v[68:69]
    v_pk_mul_f32 v[86:87], v[86:87], v[70:71]
    v_cvt_pk_bf16_f32 v120, v87, v86
    v_cvt_pk_bf16_f32 v121, v85, v84
    v_cvt_pk_bf16_f32 v122, v83, v82
    v_cvt_pk_bf16_f32 v123, v81, v80
    ds_write_b128 v60, v[120:123] offset:0
    v_and_b32 v64, 0xffff0000, v16
    v_and_b32 v65, 0xffff0000, v18
    v_and_b32 v66, 0xffff0000, v20
    v_and_b32 v67, 0xffff0000, v22
    v_and_b32 v68, 0xffff0000, v24
    v_and_b32 v69, 0xffff0000, v26
    v_and_b32 v70, 0xffff0000, v28
    v_and_b32 v71, 0xffff0000, v30
    v_and_b32 v72, 0xffff0000, v32
    v_and_b32 v73, 0xffff0000, v34
    v_and_b32 v74, 0xffff0000, v36
    v_mul_f32 v80, v111, v64
    v_mul_f32 v81, v111, v65
    v_mul_f32 v82, v111, v66
    v_mul_f32 v83, v111, v67
    v_mul_f32 v84, v111, v68
    v_mul_f32 v85, v111, v69
    v_mul_f32 v86, v111, v70
    v_mul_f32 v87, v111, v71
    v_fmac_f32 v80, v110, v65
    v_fmac_f32 v81, v110, v66
    v_fmac_f32 v82, v110, v67
    v_fmac_f32 v83, v110, v68
    v_fmac_f32 v84, v110, v69
    v_fmac_f32 v85, v110, v70
    v_fmac_f32 v86, v110, v71
    v_fmac_f32 v87, v110, v72
    v_fmac_f32 v80, v109, v66
    v_fmac_f32 v81, v109, v67
    v_fmac_f32 v82, v109, v68
    v_fmac_f32 v83, v109, v69
    v_fmac_f32 v84, v109, v70
    v_fmac_f32 v85, v109, v71
    v_fmac_f32 v86, v109, v72
    v_fmac_f32 v87, v109, v73
    v_fmac_f32 v80, v108, v67
    v_fmac_f32 v81, v108, v68
    v_fmac_f32 v82, v108, v69
    v_fmac_f32 v83, v108, v70
    v_fmac_f32 v84, v108, v71
    v_fmac_f32 v85, v108, v72
    v_fmac_f32 v86, v108, v73
    v_fmac_f32 v87, v108, v74
    v_and_b32 v64, 0xffff0000, v40
    v_and_b32 v65, 0xffff0000, v42
    v_and_b32 v66, 0xffff0000, v44
    v_and_b32 v67, 0xffff0000, v46
    v_and_b32 v68, 0xffff0000, v48
    v_and_b32 v69, 0xffff0000, v50
    v_and_b32 v70, 0xffff0000, v52
    v_and_b32 v71, 0xffff0000, v54
    v_pk_mul_f32 v[80:81], v[80:81], v[64:65]
    v_pk_mul_f32 v[82:83], v[82:83], v[66:67]
    v_pk_mul_f32 v[84:85], v[84:85], v[68:69]
    v_pk_mul_f32 v[86:87], v[86:87], v[70:71]
    v_cvt_pk_bf16_f32 v124, v87, v86
    v_cvt_pk_bf16_f32 v125, v85, v84
    v_cvt_pk_bf16_f32 v126, v83, v82
    v_cvt_pk_bf16_f32 v127, v81, v80
    ds_write_b128 v60, v[124:127] offset:16
    v_lshlrev_b32 v64, 16, v17
    v_lshlrev_b32 v65, 16, v19
    v_lshlrev_b32 v66, 16, v21
    v_lshlrev_b32 v67, 16, v23
    v_lshlrev_b32 v68, 16, v25
    v_lshlrev_b32 v69, 16, v27
    v_lshlrev_b32 v70, 16, v29
    v_lshlrev_b32 v71, 16, v31
    v_lshlrev_b32 v72, 16, v33
    v_lshlrev_b32 v73, 16, v35
    v_lshlrev_b32 v74, 16, v37
    v_mul_f32 v80, v115, v64
    v_mul_f32 v81, v115, v65
    v_mul_f32 v82, v115, v66
    v_mul_f32 v83, v115, v67
    v_mul_f32 v84, v115, v68
    v_mul_f32 v85, v115, v69
    v_mul_f32 v86, v115, v70
    v_mul_f32 v87, v115, v71
    v_fmac_f32 v80, v114, v65
    v_fmac_f32 v81, v114, v66
    v_fmac_f32 v82, v114, v67
    v_fmac_f32 v83, v114, v68
    v_fmac_f32 v84, v114, v69
    v_fmac_f32 v85, v114, v70
    v_fmac_f32 v86, v114, v71
    v_fmac_f32 v87, v114, v72
    v_fmac_f32 v80, v113, v66
    v_fmac_f32 v81, v113, v67
    v_fmac_f32 v82, v113, v68
    v_fmac_f32 v83, v113, v69
    v_fmac_f32 v84, v113, v70
    v_fmac_f32 v85, v113, v71
    v_fmac_f32 v86, v113, v72
    v_fmac_f32 v87, v113, v73
    v_fmac_f32 v80, v112, v67
    v_fmac_f32 v81, v112, v68
    v_fmac_f32 v82, v112, v69
    v_fmac_f32 v83, v112, v70
    v_fmac_f32 v84, v112, v71
    v_fmac_f32 v85, v112, v72
    v_fmac_f32 v86, v112, v73
    v_fmac_f32 v87, v112, v74
    v_lshlrev_b32 v64, 16, v41
    v_lshlrev_b32 v65, 16, v43
    v_lshlrev_b32 v66, 16, v45
    v_lshlrev_b32 v67, 16, v47
    v_lshlrev_b32 v68, 16, v49
    v_lshlrev_b32 v69, 16, v51
    v_lshlrev_b32 v70, 16, v53
    v_lshlrev_b32 v71, 16, v55
    v_pk_mul_f32 v[80:81], v[80:81], v[64:65]
    v_pk_mul_f32 v[82:83], v[82:83], v[66:67]
    v_pk_mul_f32 v[84:85], v[84:85], v[68:69]
    v_pk_mul_f32 v[86:87], v[86:87], v[70:71]
    v_cvt_pk_bf16_f32 v128, v87, v86
    v_cvt_pk_bf16_f32 v129, v85, v84
    v_cvt_pk_bf16_f32 v130, v83, v82
    v_cvt_pk_bf16_f32 v131, v81, v80
    ds_write_b128 v60, v[128:131] offset:32
    v_and_b32 v64, 0xffff0000, v17
    v_and_b32 v65, 0xffff0000, v19
    v_and_b32 v66, 0xffff0000, v21
    v_and_b32 v67, 0xffff0000, v23
    v_and_b32 v68, 0xffff0000, v25
    v_and_b32 v69, 0xffff0000, v27
    v_and_b32 v70, 0xffff0000, v29
    v_and_b32 v71, 0xffff0000, v31
    v_and_b32 v72, 0xffff0000, v33
    v_and_b32 v73, 0xffff0000, v35
    v_and_b32 v74, 0xffff0000, v37
    v_mul_f32 v80, v119, v64
    v_mul_f32 v81, v119, v65
    v_mul_f32 v82, v119, v66
    v_mul_f32 v83, v119, v67
    v_mul_f32 v84, v119, v68
    v_mul_f32 v85, v119, v69
    v_mul_f32 v86, v119, v70
    v_mul_f32 v87, v119, v71
    v_fmac_f32 v80, v118, v65
    v_fmac_f32 v81, v118, v66
    v_fmac_f32 v82, v118, v67
    v_fmac_f32 v83, v118, v68
    v_fmac_f32 v84, v118, v69
    v_fmac_f32 v85, v118, v70
    v_fmac_f32 v86, v118, v71
    v_fmac_f32 v87, v118, v72
    v_fmac_f32 v80, v117, v66
    v_fmac_f32 v81, v117, v67
    v_fmac_f32 v82, v117, v68
    v_fmac_f32 v83, v117, v69
    v_fmac_f32 v84, v117, v70
    v_fmac_f32 v85, v117, v71
    v_fmac_f32 v86, v117, v72
    v_fmac_f32 v87, v117, v73
    v_fmac_f32 v80, v116, v67
    v_fmac_f32 v81, v116, v68
    v_fmac_f32 v82, v116, v69
    v_fmac_f32 v83, v116, v70
    v_fmac_f32 v84, v116, v71
    v_fmac_f32 v85, v116, v72
    v_fmac_f32 v86, v116, v73
    v_fmac_f32 v87, v116, v74
    v_and_b32 v64, 0xffff0000, v41
    v_and_b32 v65, 0xffff0000, v43
    v_and_b32 v66, 0xffff0000, v45
    v_and_b32 v67, 0xffff0000, v47
    v_and_b32 v68, 0xffff0000, v49
    v_and_b32 v69, 0xffff0000, v51
    v_and_b32 v70, 0xffff0000, v53
    v_and_b32 v71, 0xffff0000, v55
    v_pk_mul_f32 v[80:81], v[80:81], v[64:65]
    v_pk_mul_f32 v[82:83], v[82:83], v[66:67]
    v_pk_mul_f32 v[84:85], v[84:85], v[68:69]
    v_pk_mul_f32 v[86:87], v[86:87], v[70:71]
    v_cvt_pk_bf16_f32 v132, v87, v86
    v_cvt_pk_bf16_f32 v133, v85, v84
    v_cvt_pk_bf16_f32 v134, v83, v82
    v_cvt_pk_bf16_f32 v135, v81, v80
    ds_write_b128 v60, v[132:135] offset:48
    s_waitcnt lgkmcnt(0)
    ds_read_b128 v[16:19], v61 offset:0
    ds_read_b128 v[20:23], v61 offset:1280
    ds_read_b128 v[24:27], v61 offset:2560
    ds_read_b128 v[28:31], v61 offset:3840
    s_waitcnt lgkmcnt(3)
    buffer_store_dwordx4 v[16:19], v10, s[8:11], s80 offen offset:0 sc1
    s_waitcnt lgkmcnt(2)
    buffer_store_dwordx4 v[20:23], v10, s[8:11], s80 offen offset:1024 sc1
    s_waitcnt lgkmcnt(1)
    buffer_store_dwordx4 v[24:27], v10, s[8:11], s80 offen offset:2048 sc1
    s_waitcnt lgkmcnt(0)
    buffer_store_dwordx4 v[28:31], v10, s[8:11], s80 offen offset:3072 sc1
    s_cmp_lt_u32 s3, 2
    s_cselect_b32 s96, s98, s99
    s_bitcmp1_b32 s3, 0
    s_cselect_b32 s97, 0, 16
    s_lshl_b32 s96, s96, s97
    s_and_b32 s96, s96, 0xffff0000
    s_mov_b32 s60, 1048576
    v_and_b32 v14, 7, v0
    v_lshlrev_b32 v14, 5, v14
    s_lshl_b32 s63, s7, 3
    s_cmp_lg_u32 s3, 0
    s_cbranch_scc1 L_cenw_5
L_cen_3:
    buffer_load_dwordx2 v[12:13], v14, s[12:15], s63 offen sc1
    s_waitcnt vmcnt(0)
    v_lshrrev_b32 v13, 8, v13
    s_nop 1
    v_add_u32_dpp v13, v13, v13 quad_perm:[1,0,3,2] row_mask:0xf bank_mask:0xf
    s_nop 1
    v_add_u32_dpp v13, v13, v13 quad_perm:[2,3,0,1] row_mask:0xf bank_mask:0xf
    s_nop 1
    v_add_u32_dpp v13, v13, v13 row_half_mirror row_mask:0xf bank_mask:0xf
    s_nop 0
    v_readfirstlane_b32 s64, v13
    s_nop 0
    s_cmp_ge_u32 s64, 256
    s_cbranch_scc1 L_cenw_5
    s_sleep 8
    s_sub_u32 s60, s60, 1
    s_cbranch_scc1 L_abort
    s_branch L_cen_3
L_cenw_5:
    s_barrier
    buffer_load_dwordx2 v[12:13], v14, s[12:15], s63 offen sc1
    s_waitcnt vmcnt(0)
    v_not_b32 v12, v12
    v_xor_b32 v13, 0x2000, v13
    v_or_b32 v12, v12, v13
    v_cmp_ne_u32 vcc, 0, v12
    s_cbranch_vccz L_cend_4
    v_lshrrev_b32 v13, 8, v13
    v_cmp_ne_u32 vcc, 0, v13
    s_branch L_renumber
L_cend_4:
    s_barrier
    s_lshl_b32 s81, s66, 7
    s_cmp_lg_u32 s3, 0
    s_cbranch_scc1 L_pf_6
    v_mov_b32 v1, 32832
    v_mov_b32 v2, 1
    s_mov_b64 exec, 1
    buffer_store_dword v2, v1, s[8:11], s81 offen sc1
    s_mov_b64 exec, -1
L_pf_6:
    s_mul_i32 s70, s3, 16640
    v_add_u32 v11, s70, v10
    v_alignbit_b32 v184, v145, v144, 16
    v_alignbit_b32 v185, v146, v145, 16
    v_alignbit_b32 v186, v147, v146, 16
    v_alignbit_b32 v187, v148, v147, 16
    v_alignbit_b32 v188, v146, v145, 16
    v_alignbit_b32 v189, v147, v146, 16
    v_alignbit_b32 v190, v148, v147, 16
    v_alignbit_b32 v191, v149, v148, 16
    v_mov_b32 v192, v145
    v_mov_b32 v193, v146
    v_mov_b32 v194, v147
    v_mov_b32 v195, v148
    ds_write_b128 v11, v[184:187] offset:64
    ds_write_b128 v11, v[192:195] offset:4224
    ds_write_b128 v11, v[188:191] offset:8384
    ds_write_b128 v11, v[146:149] offset:12544
    s_waitcnt lgkmcnt(0)
    v_alignbit_b32 v184, v153, v152, 16
    v_alignbit_b32 v185, v154, v153, 16
    v_alignbit_b32 v186, v155, v154, 16
    v_alignbit_b32 v187, v156, v155, 16
    v_alignbit_b32 v188, v154, v153, 16
    v_alignbit_b32 v189, v155, v154, 16
    v_alignbit_b32 v190, v156, v155, 16
    v_alignbit_b32 v191, v157, v156, 16
    v_mov_b32 v192, v153
    v_mov_b32 v193, v154
    v_mov_b32 v194, v155
    v_mov_b32 v195, v156
    ds_write_b128 v11, v[184:187] offset:1088
    ds_write_b128 v11, v[192:195] offset:5248
    ds_write_b128 v11, v[188:191] offset:9408
    ds_write_b128 v11, v[154:157] offset:13568
    s_waitcnt lgkmcnt(0)
    v_alignbit_b32 v184, v161, v160, 16
    v_alignbit_b32 v185, v162, v161, 16
    v_alignbit_b32 v186, v163, v162, 16
    v_alignbit_b32 v187, v164, v163, 16
    v_alignbit_b32 v188, v162, v161, 16
    v_alignbit_b32 v189, v163, v162, 16
    v_alignbit_b32 v190, v164, v163, 16
    v_alignbit_b32 v191, v165, v164, 16
    v_mov_b32 v192, v161
    v_mov_b32 v193, v162
    v_mov_b32 v194, v163
    v_mov_b32 v195, v164
    ds_write_b128 v11, v[184:187] offset:2112
    ds_write_b128 v11, v[192:195] offset:6272
    ds_write_b128 v11, v[188:191] offset:10432
    ds_write_b128 v11, v[162:165] offset:14592
    s_waitcnt lgkmcnt(0)
    v_alignbit_b32 v184, v169, v168, 16
    v_alignbit_b32 v185, v170, v169, 16
    v_alignbit_b32 v186, v171, v170, 16
    v_alignbit_b32 v187, v172, v171, 16
    v_alignbit_b32 v188, v170, v169, 16
    v_alignbit_b32 v189, v171, v170, 16
    v_alignbit_b32 v190, v172, v171, 16
    v_alignbit_b32 v191, v173, v172, 16
    v_mov_b32 v192, v169
    v_mov_b32 v193, v170
    v_mov_b32 v194, v171
    v_mov_b32 v195, v172
    ds_write_b128 v11, v[184:187] offset:3136
    ds_write_b128 v11, v[192:195] offset:7296
    ds_write_b128 v11, v[188:191] offset:11456
    ds_write_b128 v11, v[170:173] offset:15616
    s_waitcnt lgkmcnt(0)
    s_mov_b64 exec, 15
    v_alignbit_b32 v184, v177, v176, 16
    v_alignbit_b32 v185, v178, v177, 16
    v_alignbit_b32 v186, v179, v178, 16
    v_alignbit_b32 v187, v180, v179, 16
    v_alignbit_b32 v188, v178, v177, 16
    v_alignbit_b32 v189, v179, v178, 16
    v_alignbit_b32 v190, v180, v179, 16
    v_alignbit_b32 v191, v181, v180, 16
    v_mov_b32 v192, v177
    v_mov_b32 v193, v178
    v_mov_b32 v194, v179
    v_mov_b32 v195, v180
    ds_write_b128 v11, v[184:187] offset:0
    ds_write_b128 v11, v[192:195] offset:4160
    ds_write_b128 v11, v[188:191] offset:8320
    ds_write_b128 v11, v[178:181] offset:12480
    s_waitcnt lgkmcnt(0)
    s_mov_b64 exec, -1
    v_min_u32 v4, 47, v0
    v_lshlrev_b32 v4, 7, v4
    s_mov_b32 s74, 32768
    s_mov_b32 s75, 38912
    s_mov_b32 s76, 45056
    v_lshrrev_b32 v57, 2, v0
    v_mul_u32_u24 v58, 9216, v57
    v_lshl_add_u32 v58, v56, 4, v58
    s_mul_i32 s80, s3, 589824
    s_lshl_b32 s68, s66, 6
    s_add_u32 s80, s80, s68
    s_add_u32 s80, s80, 41943040
    s_lshl_b32 s68, s3, 6
    v_add_u32 v57, s68, v57
    v_sub_u32 v57, 207, v57
    v_lshrrev_b32 v59, 2, v57
    v_mul_u32_u24 v59, 80, v59
    v_and_b32 v57, 3, v57
    v_lshl_add_u32 v59, v57, 4, v59
    v_mul_u32_u24 v57, 7680, v56
    v_add_u32 v59, v59, v57
    v_add_u32 v59, 66560, v59
    s_mov_b32 s60, 1048576
L_poll_7:
    buffer_load_dword v8, v4, s[8:11], s74 offen offset:64 sc1
    buffer_load_dword v9, v4, s[8:11], s75 offen offset:64 sc1
    buffer_load_dword v11, v4, s[8:11], s76 offen offset:64 sc1
    s_waitcnt vmcnt(0)
    v_min3_u32 v8, v8, v9, v11
    v_cmp_eq_u32 vcc, 0, v8
    s_cbranch_vccz L_pdone_8
    s_sleep 4
    s_sub_u32 s60, s60, 1
    s_cbranch_scc1 L_abort
    s_branch L_poll_7
L_pdone_8:
    buffer_load_dwordx4 v[16:19], v58, s[8:11], s80 offen sc1
    s_add_u32 s80, s80, 147456
    buffer_load_dwordx4 v[20:23], v58, s[8:11], s80 offen sc1
    s_add_u32 s80, s80, 147456
    buffer_load_dwordx4 v[24:27], v58, s[8:11], s80 offen sc1
    s_add_u32 s80, s80, 147456
    buffer_load_dwordx4 v[28:31], v58, s[8:11], s80 offen sc1
    s_waitcnt vmcnt(3)
    ds_write_b128 v59, v[16:19] offset:960
    s_waitcnt vmcnt(2)
    ds_write_b128 v59, v[20:23] offset:640
    s_waitcnt vmcnt(1)
    ds_write_b128 v59, v[24:27] offset:320
    s_waitcnt vmcnt(0)
    ds_write_b128 v59, v[28:31] offset:0
    s_waitcnt vmcnt(0) lgkmcnt(0)
    s_barrier
    v_and_b32 v1, 31, v0
    v_lshrrev_b32 v2, 5, v0
    v_and_b32 v3, 3, v0
    v_mul_u32_u24 v3, 4160, v3
    v_lshrrev_b32 v4, 2, v1
    v_lshl_add_u32 v4, v2, 1, v4
    v_lshl_add_u32 v3, v4, 3, v3
    s_mul_i32 s70, s3, 16640
    v_add_u32 v3, s70, v3
    v_sub_u32 v4, 31, v1
    v_mul_u32_u24 v4, 80, v4
    v_lshl_add_u32 v5, v2, 4, v4
    s_mul_i32 s71, s3, 7680
    s_add_u32 s71, s71, 66560
    v_add_u32 v5, s71, v5
    ds_read_b64 v[64:65], v3 offset:0
    ds_read_b64 v[66:67], v3 offset:8
    ds_read_b128 v[68:71], v5 offset:2560
    ds_read_b64 v[72:73], v3 offset:32
    ds_read_b64 v[74:75], v3 offset:40
    ds_read_b128 v[76:79], v5 offset:2592
    ds_read_b64 v[80:81], v3 offset:64
    ds_read_b64 v[82:83], v3 offset:72
    ds_read_b128 v[84:87], v5 offset:2640
    ds_read_b64 v[88:89], v3 offset:96
    ds_read_b64 v[90:91], v3 offset:104
    ds_read_b128 v[92:95], v5 offset:2672
    s_waitcnt lgkmcnt(9)
    v_mfma_f32_32x32x16_bf16 v[16:31], v[64:67], v[68:71], 0
    ds_read_b64 v[96:97], v3 offset:128
    ds_read_b64 v[98:99], v3 offset:136
    ds_read_b128 v[100:103], v5 offset:2720
    s_waitcnt lgkmcnt(9)
    v_mfma_f32_32x32x16_bf16 v[16:31], v[72:75], v[76:79], v[16:31]
    ds_read_b64 v[64:65], v3 offset:160
    ds_read_b64 v[66:67], v3 offset:168
    ds_read_b128 v[68:71], v5 offset:2752
    s_waitcnt lgkmcnt(9)
    v_mfma_f32_32x32x16_bf16 v[16:31], v[80:83], v[84:87], v[16:31]
    ds_read_b64 v[72:73], v3 offset:192
    ds_read_b64 v[74:75], v3 offset:200
    ds_read_b128 v[76:79], v5 offset:2800
    s_waitcnt lgkmcnt(9)
    v_mfma_f32_32x32x16_bf16 v[16:31], v[88:91], v[92:95], v[16:31]
    ds_read_b64 v[80:81], v3 offset:224
    ds_read_b64 v[82:83], v3 offset:232
    ds_read_b128 v[84:87], v5 offset:2832
    s_waitcnt lgkmcnt(9)
    v_mfma_f32_32x32x16_bf16 v[16:31], v[96:99], v[100:103], v[16:31]
    ds_read_b64 v[88:89], v3 offset:256
    ds_read_b64 v[90:91], v3 offset:264
    ds_read_b128 v[92:95], v5 offset:2880
    s_waitcnt lgkmcnt(9)
    v_mfma_f32_32x32x16_bf16 v[16:31], v[64:67], v[68:71], v[16:31]
    ds_read_b64 v[96:97], v3 offset:288
    ds_read_b64 v[98:99], v3 offset:296
    ds_read_b128 v[100:103], v5 offset:2912
    s_waitcnt lgkmcnt(9)
    v_mfma_f32_32x32x16_bf16 v[16:31], v[72:75], v[76:79], v[16:31]
    ds_read_b64 v[64:65], v3 offset:320
    ds_read_b64 v[66:67], v3 offset:328
    ds_read_b128 v[68:71], v5 offset:2960
    s_waitcnt lgkmcnt(9)
    v_mfma_f32_32x32x16_bf16 v[16:31], v[80:83], v[84:87], v[16:31]
    ds_read_b64 v[72:73], v3 offset:352
    ds_read_b64 v[74:75], v3 offset:360
    ds_read_b128 v[76:79], v5 offset:2992
    s_waitcnt lgkmcnt(9)
    v_mfma_f32_32x32x16_bf16 v[16:31], v[88:91], v[92:95], v[16:31]
    ds_read_b64 v[80:81], v3 offset:384
    ds_read_b64 v[82:83], v3 offset:392
    ds_read_b128 v[84:87], v5 offset:3040
    s_waitcnt lgkmcnt(9)
    v_mfma_f32_32x32x16_bf16 v[16:31], v[96:99], v[100:103], v[16:31]
    ds_read_b64 v[88:89], v3 offset:416
    ds_read_b64 v[90:91], v3 offset:424
    ds_read_b128 v[92:95], v5 offset:3072
    s_waitcnt lgkmcnt(9)
    v_mfma_f32_32x32x16_bf16 v[16:31], v[64:67], v[68:71], v[16:31]
    ds_read_b64 v[96:97], v3 offset:448
    ds_read_b64 v[98:99], v3 offset:456
    ds_read_b128 v[100:103], v5 offset:3120
    s_waitcnt lgkmcnt(9)
    v_mfma_f32_32x32x16_bf16 v[16:31], v[72:75], v[76:79], v[16:31]
    ds_read_b64 v[64:65], v3 offset:480
    ds_read_b64 v[66:67], v3 offset:488
    ds_read_b128 v[68:71], v5 offset:3152
    s_waitcnt lgkmcnt(9)
    v_mfma_f32_32x32x16_bf16 v[16:31], v[80:83], v[84:87], v[16:31]
    ds_read_b64 v[72:73], v3 offset:512
    ds_read_b64 v[74:75], v3 offset:520
    ds_read_b128 v[76:79], v5 offset:3200
    s_waitcnt lgkmcnt(9)
    v_mfma_f32_32x32x16_bf16 v[16:31], v[88:91], v[92:95], v[16:31]
    ds_read_b64 v[80:81], v3 offset:544
    ds_read_b64 v[82:83], v3 offset:552
    ds_read_b128 v[84:87], v5 offset:3232
    s_waitcnt lgkmcnt(9)
    v_mfma_f32_32x32x16_bf16 v[16:31], v[96:99], v[100:103], v[16:31]
    ds_read_b64 v[88:89], v3 offset:576
    ds_read_b64 v[90:91], v3 offset:584
    ds_read_b128 v[92:95], v5 offset:3280
    s_waitcnt lgkmcnt(9)
    v_mfma_f32_32x32x16_bf16 v[16:31], v[64:67], v[68:71], v[16:31]
    ds_read_b64 v[96:97], v3 offset:608
    ds_read_b64 v[98:99], v3 offset:616
    ds_read_b128 v[100:103], v5 offset:3312
    s_waitcnt lgkmcnt(9)
    v_mfma_f32_32x32x16_bf16 v[16:31], v[72:75], v[76:79], v[16:31]
    ds_read_b64 v[64:65], v3 offset:640
    ds_read_b64 v[66:67], v3 offset:648
    ds_read_b128 v[68:71], v5 offset:3360
    s_waitcnt lgkmcnt(9)
    v_mfma_f32_32x32x16_bf16 v[16:31], v[80:83], v[84:87], v[16:31]
    ds_read_b64 v[72:73], v3 offset:672
    ds_read_b64 v[74:75], v3 offset:680
    ds_read_b128 v[76:79], v5 offset:3392
    s_waitcnt lgkmcnt(9)
    v_mfma_f32_32x32x16_bf16 v[16:31], v[88:91], v[92:95], v[16:31]
    ds_read_b64 v[80:81], v3 offset:704
    ds_read_b64 v[82:83], v3 offset:712
    ds_read_b128 v[84:87], v5 offset:3440
    s_waitcnt lgkmcnt(9)
    v_mfma_f32_32x32x16_bf16 v[16:31], v[96:99], v[100:103], v[16:31]
    ds_read_b64 v[88:89], v3 offset:736
    ds_read_b64 v[90:91], v3 offset:744
    ds_read_b128 v[92:95], v5 offset:3472
    s_waitcnt lgkmcnt(9)
    v_mfma_f32_32x32x16_bf16 v[16:31], v[64:67], v[68:71], v[16:31]
    ds_read_b64 v[96:97], v3 offset:768
    ds_read_b64 v[98:99], v3 offset:776
    ds_read_b128 v[100:103], v5 offset:3520
    s_waitcnt lgkmcnt(9)
    v_mfma_f32_32x32x16_bf16 v[16:31], v[72:75], v[76:79], v[16:31]
    ds_read_b64 v[64:65], v3 offset:800
    ds_read_b64 v[66:67], v3 offset:808
    ds_read_b128 v[68:71], v5 offset:3552
    s_waitcnt lgkmcnt(9)
    v_mfma_f32_32x32x16_bf16 v[16:31], v[80:83], v[84:87], v[16:31]
    ds_read_b64 v[72:73], v3 offset:832
    ds_read_b64 v[74:75], v3 offset:840
    ds_read_b128 v[76:79], v5 offset:3600
    s_waitcnt lgkmcnt(9)
    v_mfma_f32_32x32x16_bf16 v[16:31], v[88:91], v[92:95], v[16:31]
    ds_read_b64 v[80:81], v3 offset:864
    ds_read_b64 v[82:83], v3 offset:872
    ds_read_b128 v[84:87], v5 offset:3632
    s_waitcnt lgkmcnt(9)
    v_mfma_f32_32x32x16_bf16 v[16:31], v[96:99], v[100:103], v[16:31]
    ds_read_b64 v[88:89], v3 offset:896
    ds_read_b64 v[90:91], v3 offset:904
    ds_read_b128 v[92:95], v5 offset:3680
    s_waitcnt lgkmcnt(9)
    v_mfma_f32_32x32x16_bf16 v[16:31], v[64:67], v[68:71], v[16:31]
    ds_read_b64 v[96:97], v3 offset:928
    ds_read_b64 v[98:99], v3 offset:936
    ds_read_b128 v[100:103], v5 offset:3712
    s_waitcnt lgkmcnt(9)
    v_mfma_f32_32x32x16_bf16 v[16:31], v[72:75], v[76:79], v[16:31]
    ds_read_b64 v[64:65], v3 offset:960
    ds_read_b64 v[66:67], v3 offset:968
    ds_read_b128 v[68:71], v5 offset:3760
    s_waitcnt lgkmcnt(9)
    v_mfma_f32_32x32x16_bf16 v[16:31], v[80:83], v[84:87], v[16:31]
    ds_read_b64 v[72:73], v3 offset:992
    ds_read_b64 v[74:75], v3 offset:1000
    ds_read_b128 v[76:79], v5 offset:3792
    s_waitcnt lgkmcnt(9)
    v_mfma_f32_32x32x16_bf16 v[16:31], v[88:91], v[92:95], v[16:31]
    ds_read_b64 v[80:81], v3 offset:1024
    ds_read_b64 v[82:83], v3 offset:1032
    ds_read_b128 v[84:87], v5 offset:3840
    s_waitcnt lgkmcnt(9)
    v_mfma_f32_32x32x16_bf16 v[16:31], v[96:99], v[100:103], v[16:31]
    ds_read_b64 v[88:89], v3 offset:1056
    ds_read_b64 v[90:91], v3 offset:1064
    ds_read_b128 v[92:95], v5 offset:3872
    s_waitcnt lgkmcnt(9)
    v_mfma_f32_32x32x16_bf16 v[16:31], v[64:67], v[68:71], v[16:31]
    ds_read_b64 v[96:97], v3 offset:1088
    ds_read_b64 v[98:99], v3 offset:1096
    ds_read_b128 v[100:103], v5 offset:3920
    s_waitcnt lgkmcnt(9)
    v_mfma_f32_32x32x16_bf16 v[16:31], v[72:75], v[76:79], v[16:31]
    ds_read_b64 v[64:65], v3 offset:1120
    ds_read_b64 v[66:67], v3 offset:1128
    ds_read_b128 v[68:71], v5 offset:3952
    s_waitcnt lgkmcnt(9)
    v_mfma_f32_32x32x16_bf16 v[16:31], v[80:83], v[84:87], v[16:31]
    ds_read_b64 v[72:73], v3 offset:1152
    ds_read_b64 v[74:75], v3 offset:1160
    ds_read_b128 v[76:79], v5 offset:4000
    s_waitcnt lgkmcnt(9)
    v_mfma_f32_32x32x16_bf16 v[16:31], v[88:91], v[92:95], v[16:31]
    ds_read_b64 v[80:81], v3 offset:1184
    ds_read_b64 v[82:83], v3 offset:1192
    ds_read_b128 v[84:87], v5 offset:4032
    s_waitcnt lgkmcnt(9)
    v_mfma_f32_32x32x16_bf16 v[16:31], v[96:99], v[100:103], v[16:31]
    ds_read_b64 v[88:89], v3 offset:1216
    ds_read_b64 v[90:91], v3 offset:1224
    ds_read_b128 v[92:95], v5 offset:4080
    s_waitcnt lgkmcnt(9)
    v_mfma_f32_32x32x16_bf16 v[16:31], v[64:67], v[68:71], v[16:31]
    ds_read_b64 v[96:97], v3 offset:1248
    ds_read_b64 v[98:99], v3 offset:1256
    ds_read_b128 v[100:103], v5 offset:4112
    s_waitcnt lgkmcnt(9)
    v_mfma_f32_32x32x16_bf16 v[16:31], v[72:75], v[76:79], v[16:31]
    ds_read_b64 v[64:65], v3 offset:1280
    ds_read_b64 v[66:67], v3 offset:1288
    ds_read_b128 v[68:71], v5 offset:4160
    s_waitcnt lgkmcnt(9)
    v_mfma_f32_32x32x16_bf16 v[16:31], v[80:83], v[84:87], v[16:31]
    ds_read_b64 v[72:73], v3 offset:1312
    ds_read_b64 v[74:75], v3 offset:1320
    ds_read_b128 v[76:79], v5 offset:4192
    s_waitcnt lgkmcnt(9)
    v_mfma_f32_32x32x16_bf16 v[16:31], v[88:91], v[92:95], v[16:31]
    ds_read_b64 v[80:81], v3 offset:1344
    ds_read_b64 v[82:83], v3 offset:1352
    ds_read_b128 v[84:87], v5 offset:4240
    s_waitcnt lgkmcnt(9)
    v_mfma_f32_32x32x16_bf16 v[16:31], v[96:99], v[100:103], v[16:31]
    ds_read_b64 v[88:89], v3 offset:1376
    ds_read_b64 v[90:91], v3 offset:1384
    ds_read_b128 v[92:95], v5 offset:4272
    s_waitcnt lgkmcnt(9)
    v_mfma_f32_32x32x16_bf16 v[16:31], v[64:67], v[68:71], v[16:31]
    ds_read_b64 v[96:97], v3 offset:1408
    ds_read_b64 v[98:99], v3 offset:1416
    ds_read_b128 v[100:103], v5 offset:4320
    s_waitcnt lgkmcnt(9)
    v_mfma_f32_32x32x16_bf16 v[16:31], v[72:75], v[76:79], v[16:31]
    ds_read_b64 v[64:65], v3 offset:1440
    ds_read_b64 v[66:67], v3 offset:1448
    ds_read_b128 v[68:71], v5 offset:4352
    s_waitcnt lgkmcnt(9)
    v_mfma_f32_32x32x16_bf16 v[16:31], v[80:83], v[84:87], v[16:31]
    ds_read_b64 v[72:73], v3 offset:1472
    ds_read_b64 v[74:75], v3 offset:1480
    ds_read_b128 v[76:79], v5 offset:4400
    s_waitcnt lgkmcnt(9)
    v_mfma_f32_32x32x16_bf16 v[16:31], v[88:91], v[92:95], v[16:31]
    ds_read_b64 v[80:81], v3 offset:1504
    ds_read_b64 v[82:83], v3 offset:1512
    ds_read_b128 v[84:87], v5 offset:4432
    s_waitcnt lgkmcnt(9)
    v_mfma_f32_32x32x16_bf16 v[16:31], v[96:99], v[100:103], v[16:31]
    ds_read_b64 v[88:89], v3 offset:1536
    ds_read_b64 v[90:91], v3 offset:1544
    ds_read_b128 v[92:95], v5 offset:4480
    s_waitcnt lgkmcnt(9)
    v_mfma_f32_32x32x16_bf16 v[16:31], v[64:67], v[68:71], v[16:31]
    ds_read_b64 v[96:97], v3 offset:1568
    ds_read_b64 v[98:99], v3 offset:1576
    ds_read_b128 v[100:103], v5 offset:4512
    s_waitcnt lgkmcnt(9)
    v_mfma_f32_32x32x16_bf16 v[16:31], v[72:75], v[76:79], v[16:31]
    ds_read_b64 v[64:65], v3 offset:1600
    ds_read_b64 v[66:67], v3 offset:1608
    ds_read_b128 v[68:71], v5 offset:4560
    s_waitcnt lgkmcnt(9)
    v_mfma_f32_32x32x16_bf16 v[16:31], v[80:83], v[84:87], v[16:31]
    ds_read_b64 v[72:73], v3 offset:1632
    ds_read_b64 v[74:75], v3 offset:1640
    ds_read_b128 v[76:79], v5 offset:4592
    s_waitcnt lgkmcnt(9)
    v_mfma_f32_32x32x16_bf16 v[16:31], v[88:91], v[92:95], v[16:31]
    ds_read_b64 v[80:81], v3 offset:1664
    ds_read_b64 v[82:83], v3 offset:1672
    ds_read_b128 v[84:87], v5 offset:4640
    s_waitcnt lgkmcnt(9)
    v_mfma_f32_32x32x16_bf16 v[16:31], v[96:99], v[100:103], v[16:31]
    ds_read_b64 v[88:89], v3 offset:1696
    ds_read_b64 v[90:91], v3 offset:1704
    ds_read_b128 v[92:95], v5 offset:4672
    s_waitcnt lgkmcnt(9)
    v_mfma_f32_32x32x16_bf16 v[16:31], v[64:67], v[68:71], v[16:31]
    ds_read_b64 v[96:97], v3 offset:1728
    ds_read_b64 v[98:99], v3 offset:1736
    ds_read_b128 v[100:103], v5 offset:4720
    s_waitcnt lgkmcnt(9)
    v_mfma_f32_32x32x16_bf16 v[16:31], v[72:75], v[76:79], v[16:31]
    ds_read_b64 v[64:65], v3 offset:1760
    ds_read_b64 v[66:67], v3 offset:1768
    ds_read_b128 v[68:71], v5 offset:4752
    s_waitcnt lgkmcnt(9)
    v_mfma_f32_32x32x16_bf16 v[16:31], v[80:83], v[84:87], v[16:31]
    ds_read_b64 v[72:73], v3 offset:1792
    ds_read_b64 v[74:75], v3 offset:1800
    ds_read_b128 v[76:79], v5 offset:4800
    s_waitcnt lgkmcnt(9)
    v_mfma_f32_32x32x16_bf16 v[16:31], v[88:91], v[92:95], v[16:31]
    ds_read_b64 v[80:81], v3 offset:1824
    ds_read_b64 v[82:83], v3 offset:1832
    ds_read_b128 v[84:87], v5 offset:4832
    s_waitcnt lgkmcnt(9)
    v_mfma_f32_32x32x16_bf16 v[16:31], v[96:99], v[100:103], v[16:31]
    ds_read_b64 v[88:89], v3 offset:1856
    ds_read_b64 v[90:91], v3 offset:1864
    ds_read_b128 v[92:95], v5 offset:4880
    s_waitcnt lgkmcnt(9)
    v_mfma_f32_32x32x16_bf16 v[16:31], v[64:67], v[68:71], v[16:31]
    ds_read_b64 v[96:97], v3 offset:1888
    ds_read_b64 v[98:99], v3 offset:1896
    ds_read_b128 v[100:103], v5 offset:4912
    s_waitcnt lgkmcnt(9)
    v_mfma_f32_32x32x16_bf16 v[16:31], v[72:75], v[76:79], v[16:31]
    ds_read_b64 v[64:65], v3 offset:1920
    ds_read_b64 v[66:67], v3 offset:1928
    ds_read_b128 v[68:71], v5 offset:4960
    s_waitcnt lgkmcnt(9)
    v_mfma_f32_32x32x16_bf16 v[16:31], v[80:83], v[84:87], v[16:31]
    ds_read_b64 v[72:73], v3 offset:1952
    ds_read_b64 v[74:75], v3 offset:1960
    ds_read_b128 v[76:79], v5 offset:4992
    s_waitcnt lgkmcnt(9)
    v_mfma_f32_32x32x16_bf16 v[16:31], v[88:91], v[92:95], v[16:31]
    ds_read_b64 v[80:81], v3 offset:1984
    ds_read_b64 v[82:83], v3 offset:1992
    ds_read_b128 v[84:87], v5 offset:5040
    s_waitcnt lgkmcnt(9)
    v_mfma_f32_32x32x16_bf16 v[16:31], v[96:99], v[100:103], v[16:31]
    ds_read_b64 v[88:89], v3 offset:2016
    ds_read_b64 v[90:91], v3 offset:2024
    ds_read_b128 v[92:95], v5 offset:5072
    s_waitcnt lgkmcnt(9)
    v_mfma_f32_32x32x16_bf16 v[16:31], v[64:67], v[68:71], v[16:31]
    s_waitcnt lgkmcnt(6)
    v_mfma_f32_32x32x16_bf16 v[16:31], v[72:75], v[76:79], v[16:31]
    s_waitcnt lgkmcnt(3)
    v_mfma_f32_32x32x16_bf16 v[16:31], v[80:83], v[84:87], v[16:31]
    s_waitcnt lgkmcnt(0)
    v_mfma_f32_32x32x16_bf16 v[16:31], v[88:91], v[92:95], v[16:31]
    v_sub_u32 v6, 1, v2
    v_lshl_add_u32 v6, v6, 3, v4
    v_add_u32 v6, s71, v6
    ds_read_b64 v[112:113], v6 offset:2608
    ds_read_b64 v[114:115], v6 offset:2592
    ds_read_b64 v[116:117], v6 offset:2576
    ds_read_b64 v[118:119], v6 offset:2560
    v_mul_u32_u24 v7, 272, v1
    v_lshl_add_u32 v7, v2, 3, v7
    s_lshl_b32 s68, s3, 5
    s_add_u32 s68, s68, 138240
    v_add_u32 v7, s68, v7
    v_lshrrev_b32 v12, 4, v0
    v_and_b32 v13, 15, v0
    v_mul_u32_u24 v14, 272, v12
    v_lshl_add_u32 v14, v13, 4, v14
    s_mul_i32 s68, s3, 2176
    s_add_u32 s68, s68, 138240
    v_add_u32 v14, s68, v14
    v_lshrrev_b32 v12, 3, v0
    v_mul_u32_u24 v15, 18432, v12
    v_and_b32 v13, 7, v0
    v_lshl_add_u32 v15, v13, 4, v15
    s_mul_i32 s68, s3, 294912
    s_lshl_b32 s69, s62, 7
    s_add_u32 s68, s68, s69
    s_add_u32 s68, s68, 1048576
    s_waitcnt lgkmcnt(0)
    v_and_b32 v8, 0xffff0000, v113
    v_lshlrev_b32 v9, 16, v113
    v_and_b32 v10, 0xffff0000, v112
    v_lshlrev_b32 v11, 16, v112
    v_fmac_f32 v16, s96, v8
    v_fmac_f32 v17, s96, v9
    v_fmac_f32 v18, s96, v10
    v_fmac_f32 v19, s96, v11
    v_cvt_pk_bf16_f32 v128, v16, v17
    v_cvt_pk_bf16_f32 v129, v18, v19
    ds_write_b64 v7, v[128:129] offset:0
    v_and_b32 v8, 0xffff0000, v115
    v_lshlrev_b32 v9, 16, v115
    v_and_b32 v10, 0xffff0000, v114
    v_lshlrev_b32 v11, 16, v114
    v_fmac_f32 v20, s96, v8
    v_fmac_f32 v21, s96, v9
    v_fmac_f32 v22, s96, v10
    v_fmac_f32 v23, s96, v11
    v_cvt_pk_bf16_f32 v130, v20, v21
    v_cvt_pk_bf16_f32 v131, v22, v23
    ds_write_b64 v7, v[130:131] offset:16
    v_and_b32 v8, 0xffff0000, v117
    v_lshlrev_b32 v9, 16, v117
    v_and_b32 v10, 0xffff0000, v116
    v_lshlrev_b32 v11, 16, v116
    v_fmac_f32 v24, s96, v8
    v_fmac_f32 v25, s96, v9
    v_fmac_f32 v26, s96, v10
    v_fmac_f32 v27, s96, v11
    v_cvt_pk_bf16_f32 v132, v24, v25
    v_cvt_pk_bf16_f32 v133, v26, v27
    ds_write_b64 v7, v[132:133] offset:128
    v_and_b32 v8, 0xffff0000, v119
    v_lshlrev_b32 v9, 16, v119
    v_and_b32 v10, 0xffff0000, v118
    v_lshlrev_b32 v11, 16, v118
    v_fmac_f32 v28, s96, v8
    v_fmac_f32 v29, s96, v9
    v_fmac_f32 v30, s96, v10
    v_fmac_f32 v31, s96, v11
    v_cvt_pk_bf16_f32 v134, v28, v29
    v_cvt_pk_bf16_f32 v135, v30, v31
    ds_write_b64 v7, v[134:135] offset:144
    s_waitcnt lgkmcnt(0)
    s_barrier
    ds_read_b128 v[16:19], v14 offset:0
    ds_read_b128 v[20:23], v14 offset:1088
    s_waitcnt lgkmcnt(1)
    buffer_store_dwordx4 v[16:19], v15, s[8:11], s68 offen sc1
    s_add_u32 s68, s68, 147456
    s_waitcnt lgkmcnt(0)
    buffer_store_dwordx4 v[20:23], v15, s[8:11], s68 offen sc1
    s_waitcnt vmcnt(0)
    s_barrier
    s_cmp_lg_u32 s3, 0
    s_cbranch_scc1 L_cf_9
    v_mov_b32 v1, 32768
    v_mov_b32 v2, 1
    s_mov_b64 exec, 1
    buffer_store_dword v2, v1, s[8:11], s69 offen sc1
    s_mov_b64 exec, -1
L_cf_9:
    s_branch L_postconv
L_noconv:
    s_mov_b32 s62, 255
    s_sub_u32 s66, s4, 3
    s_mul_i32 s66, s66, 3
    s_add_u32 s66, s66, s5
    s_sub_u32 s66, s66, 29
    s_cmp_lt_u32 s5, 29
    s_cselect_b32 s66, 15, s66
    s_lshl_b32 s63, s66, 2
    s_add_u32 s63, s63, s3
    s_lshl_b32 s64, s63, 12
    v_lshlrev_b32 v1, 4, v0
    v_mov_b64 v[4:5], 0
    v_mov_b64 v[6:7], 0
    v_mov_b64 v[8:9], -1
    v_mov_b64 v[10:11], -1
    s_lshr_b32 s65, s63, 5
    s_mul_i32 s65, s65, 2097152
    s_and_b32 s63, s63, 31
    s_mul_i32 s63, s63, 36864
    s_add_u32 s63, s63, s65
    s_add_u32 s63, s63, 20971520
    s_add_u32 s65, s63, 36864
    buffer_store_dwordx4 v[4:7], v1, s[8:11], s64 offen offset:0 sc1
    buffer_store_dwordx4 v[4:7], v1, s[8:11], s64 offen offset:1024 sc1
    buffer_store_dwordx4 v[4:7], v1, s[8:11], s64 offen offset:2048 sc1
    buffer_store_dwordx4 v[4:7], v1, s[8:11], s64 offen offset:3072 sc1
    s_mov_b32 s67, s63
    s_mov_b32 s68, s65
    s_waitcnt vmcnt(0)
    s_barrier
    s_cmp_lg_u32 s3, 0
    s_cbranch_scc1 L_reg_11
    s_lshl_b32 s64, 1, s5
    s_mov_b32 s65, 0x100
    s_lshl_b32 s63, s4, 2
    s_add_u32 s63, s63, s7
    s_lshl_b32 s63, s63, 3
    s_atomic_add_x2 s[64:65], s[44:45], s63
    s_nop 4
L_reg_11:
L_ini_10:
    buffer_store_dwordx4 v[8:11], v1, s[8:11], s67 offen offset:0 sc1
    buffer_store_dwordx4 v[8:11], v1, s[8:11], s67 offen offset:1024 sc1
    buffer_store_dwordx4 v[8:11], v1, s[8:11], s67 offen offset:2048 sc1
    buffer_store_dwordx4 v[8:11], v1, s[8:11], s67 offen offset:3072 sc1
    s_add_u32 s67, s67, 4096
    s_cmp_lt_u32 s67, s68
    s_cbranch_scc1 L_ini_10
    s_mov_b32 s60, 1048576
    v_and_b32 v14, 7, v0
    v_lshlrev_b32 v14, 5, v14
    s_lshl_b32 s63, s7, 3
    s_cmp_lg_u32 s3, 0
    s_cbranch_scc1 L_cenw_14
L_cen_12:
    buffer_load_dwordx2 v[12:13], v14, s[12:15], s63 offen sc1
    s_waitcnt vmcnt(0)
    v_lshrrev_b32 v13, 8, v13
    s_nop 1
    v_add_u32_dpp v13, v13, v13 quad_perm:[1,0,3,2] row_mask:0xf bank_mask:0xf
    s_nop 1
    v_add_u32_dpp v13, v13, v13 quad_perm:[2,3,0,1] row_mask:0xf bank_mask:0xf
    s_nop 1
    v_add_u32_dpp v13, v13, v13 row_half_mirror row_mask:0xf bank_mask:0xf
    s_nop 0
    v_readfirstlane_b32 s64, v13
    s_nop 0
    s_cmp_ge_u32 s64, 256
    s_cbranch_scc1 L_cenw_14
    s_sleep 8
    s_sub_u32 s60, s60, 1
    s_cbranch_scc1 L_abort
    s_branch L_cen_12
L_cenw_14:
    s_barrier
    buffer_load_dwordx2 v[12:13], v14, s[12:15], s63 offen sc1
    s_waitcnt vmcnt(0)
    v_not_b32 v12, v12
    v_xor_b32 v13, 0x2000, v13
    v_or_b32 v12, v12, v13
    v_cmp_ne_u32 vcc, 0, v12
    s_cbranch_vccz L_cend_13
    v_lshrrev_b32 v13, 8, v13
    v_cmp_ne_u32 vcc, 0, v13
    s_branch L_renumber
L_cend_13:
    s_barrier
    s_lshl_b32 s63, s66, 2
    s_add_u32 s63, s63, 2048
    s_mov_b64 exec, 1
    buffer_store_dword v8, v4, s[8:11], s63 offen sc1
    s_mov_b64 exec, -1
L_postconv:
    s_and_b32 s66, s4, 1
    s_lshl_b32 s66, s66, 5
    s_add_u32 s66, s66, s5
L_stageb:
    s_cmp_lt_u32 s4, 6
    s_cbranch_scc1 L_nob
    s_mov_b32 s48, s16
    s_mov_b32 s49, s17
    s_mov_b32 s50, 2359296
    s_mov_b32 s51, 0x20000
    v_lshrrev_b32 v1, 4, v0
    v_and_b32 v2, 15, v0
    v_mul_u32_u24 v3, 1152, v1
    v_lshl_add_u32 v3, v2, 4, v3
    s_lshl_b32 s67, s66, 4
    s_lshl_b32 s68, s3, 2
    s_add_u32 s67, s67, s68
    s_mul_i32 s68, s67, 1152
    s_mov_b32 s72, 0x00ff00ff
    s_mov_b32 s73, 0x00ff00ff
    v_mov_b64 v[32:33], 0
    v_mov_b64 v[34:35], 0
    buffer_load_dwordx4 v[16:19], v3, s[48:51], s68 offen offset:0
    buffer_load_dwordx4 v[20:23], v3, s[48:51], s68 offen offset:256
    buffer_load_dwordx4 v[24:27], v3, s[48:51], s68 offen offset:512
    buffer_load_dwordx4 v[28:31], v3, s[48:51], s68 offen offset:768
    s_mov_b64 exec, s[72:73]
    buffer_load_dwordx4 v[32:35], v3, s[48:51], s68 offen offset:1024
    s_mov_b64 exec, -1
    v_min_u32 v4, 47, v0
    v_lshlrev_b32 v4, 7, v4
    v_and_b32 v7, 3, v0
    v_lshl_add_u32 v6, v1, 2, v7
    v_lshlrev_b32 v6, 3, v6
    v_bfe_u32 v8, v0, 2, 2
    v_add_u32 v6, v6, v8
    v_lshlrev_b32 v6, 5, v6
    s_lshl_b32 s71, s3, 3
    s_add_u32 s71, s71, 97280
    v_add_u32 v6, s71, v6
    v_lshrrev_b32 v8, 2, v0
    v_lshl_add_u32 v7, v7, 4, v8
    v_lshlrev_b32 v7, 4, v7
    s_mul_i32 s70, s3, 5120
    s_add_u32 s71, s70, 117760
    v_add_u32 v7, s71, v7
    v_lshlrev_b32 v5, 4, v0
    v_add_u32 v15, s71, v5
    s_mul_i32 s69, s66, 18432
    s_add_u32 s69, s69, s70
    s_add_u32 s69, s69, 1048576
    s_add_u32 s70, s70, 97280
    s_lshr_b32 s74, s66, 6
    s_lshl_b32 s74, s74, 5
    s_add_u32 s75, s74, 38912
    s_add_u32 s76, s74, 45056
    s_add_u32 s74, s74, 32768
    s_waitcnt vmcnt(0)
    v_lshlrev_b32 v64, 16, v16
    v_and_b32 v65, 0xffff0000, v16
    v_lshlrev_b32 v66, 16, v17
    v_and_b32 v67, 0xffff0000, v17
    v_lshlrev_b32 v68, 16, v18
    v_and_b32 v69, 0xffff0000, v18
    v_lshlrev_b32 v70, 16, v19
    v_and_b32 v71, 0xffff0000, v19
    v_lshlrev_b32 v72, 16, v20
    v_and_b32 v73, 0xffff0000, v20
    v_lshlrev_b32 v74, 16, v21
    v_and_b32 v75, 0xffff0000, v21
    v_lshlrev_b32 v76, 16, v22
    v_and_b32 v77, 0xffff0000, v22
    v_lshlrev_b32 v78, 16, v23
    v_and_b32 v79, 0xffff0000, v23
    v_lshlrev_b32 v80, 16, v24
    v_and_b32 v81, 0xffff0000, v24
    v_lshlrev_b32 v82, 16, v25
    v_and_b32 v83, 0xffff0000, v25
    v_lshlrev_b32 v84, 16, v26
    v_and_b32 v85, 0xffff0000, v26
    v_lshlrev_b32 v86, 16, v27
    v_and_b32 v87, 0xffff0000, v27
    v_lshlrev_b32 v88, 16, v28
    v_and_b32 v89, 0xffff0000, v28
    v_lshlrev_b32 v90, 16, v29
    v_and_b32 v91, 0xffff0000, v29
    v_lshlrev_b32 v92, 16, v30
    v_and_b32 v93, 0xffff0000, v30
    v_lshlrev_b32 v94, 16, v31
    v_and_b32 v95, 0xffff0000, v31
    v_lshlrev_b32 v96, 16, v32
    v_and_b32 v97, 0xffff0000, v32
    v_lshlrev_b32 v98, 16, v33
    v_and_b32 v99, 0xffff0000, v33
    v_lshlrev_b32 v100, 16, v34
    v_and_b32 v101, 0xffff0000, v34
    v_lshlrev_b32 v102, 16, v35
    v_and_b32 v103, 0xffff0000, v35
    v_pk_add_f32 v[8:9], v[64:65], v[66:67]
    v_pk_add_f32 v[10:11], v[68:69], v[70:71]
    v_pk_add_f32 v[8:9], v[8:9], v[72:73]
    v_pk_add_f32 v[10:11], v[10:11], v[74:75]
    v_pk_add_f32 v[8:9], v[8:9], v[76:77]
    v_pk_add_f32 v[10:11], v[10:11], v[78:79]
    v_pk_add_f32 v[8:9], v[8:9], v[80:81]
    v_pk_add_f32 v[10:11], v[10:11], v[82:83]
    v_pk_add_f32 v[8:9], v[8:9], v[84:85]
    v_pk_add_f32 v[10:11], v[10:11], v[86:87]
    v_pk_add_f32 v[8:9], v[8:9], v[88:89]
    v_pk_add_f32 v[10:11], v[10:11], v[90:91]
    v_pk_add_f32 v[8:9], v[8:9], v[92:93]
    v_pk_add_f32 v[10:11], v[10:11], v[94:95]
    v_pk_add_f32 v[8:9], v[8:9], v[96:97]
    v_pk_add_f32 v[10:11], v[10:11], v[98:99]
    v_pk_add_f32 v[8:9], v[8:9], v[100:101]
    v_pk_add_f32 v[10:11], v[10:11], v[102:103]
    v_pk_add_f32 v[8:9], v[8:9], v[10:11]
    v_add_f32 v8, v8, v9
    s_nop 1
    v_add_f32_dpp v8, v8, v8 quad_perm:[1,0,3,2] row_mask:0xf bank_mask:0xf
    s_nop 1
    v_add_f32_dpp v8, v8, v8 quad_perm:[2,3,0,1] row_mask:0xf bank_mask:0xf
    s_nop 1
    v_add_f32_dpp v8, v8, v8 row_half_mirror row_mask:0xf bank_mask:0xf
    s_nop 1
    v_add_f32_dpp v8, v8, v8 row_mirror row_mask:0xf bank_mask:0xf
    v_mul_f32 v12, -1.7361111111e-03, v8
    v_mul_f32 v13, -1.7361111111e-03, v8
    v_pk_add_f32 v[112:113], v[64:65], v[12:13]
    v_pk_add_f32 v[114:115], v[66:67], v[12:13]
    v_pk_add_f32 v[116:117], v[68:69], v[12:13]
    v_pk_add_f32 v[118:119], v[70:71], v[12:13]
    v_pk_add_f32 v[120:121], v[72:73], v[12:13]
    v_pk_add_f32 v[122:123], v[74:75], v[12:13]
    v_pk_add_f32 v[124:125], v[76:77], v[12:13]
    v_pk_add_f32 v[126:127], v[78:79], v[12:13]
    v_pk_add_f32 v[128:129], v[80:81], v[12:13]
    v_pk_add_f32 v[130:131], v[82:83], v[12:13]
    v_pk_add_f32 v[132:133], v[84:85], v[12:13]
    v_pk_add_f32 v[134:135], v[86:87], v[12:13]
    v_pk_add_f32 v[136:137], v[88:89], v[12:13]
    v_pk_add_f32 v[138:139], v[90:91], v[12:13]
    v_pk_add_f32 v[140:141], v[92:93], v[12:13]
    v_pk_add_f32 v[142:143], v[94:95], v[12:13]
    v_pk_add_f32 v[144:145], v[96:97], v[12:13]
    v_pk_add_f32 v[146:147], v[98:99], v[12:13]
    v_pk_add_f32 v[148:149], v[100:101], v[12:13]
    v_pk_add_f32 v[150:151], v[102:103], v[12:13]
    v_pk_mul_f32 v[8:9], v[112:113], v[112:113]
    v_pk_mul_f32 v[10:11], v[114:115], v[114:115]
    v_pk_fma_f32 v[8:9], v[116:117], v[116:117], v[8:9]
    v_pk_fma_f32 v[10:11], v[118:119], v[118:119], v[10:11]
    v_pk_fma_f32 v[8:9], v[120:121], v[120:121], v[8:9]
    v_pk_fma_f32 v[10:11], v[122:123], v[122:123], v[10:11]
    v_pk_fma_f32 v[8:9], v[124:125], v[124:125], v[8:9]
    v_pk_fma_f32 v[10:11], v[126:127], v[126:127], v[10:11]
    v_pk_fma_f32 v[8:9], v[128:129], v[128:129], v[8:9]
    v_pk_fma_f32 v[10:11], v[130:131], v[130:131], v[10:11]
    v_pk_fma_f32 v[8:9], v[132:133], v[132:133], v[8:9]
    v_pk_fma_f32 v[10:11], v[134:135], v[134:135], v[10:11]
    v_pk_fma_f32 v[8:9], v[136:137], v[136:137], v[8:9]
    v_pk_fma_f32 v[10:11], v[138:139], v[138:139], v[10:11]
    v_pk_fma_f32 v[8:9], v[140:141], v[140:141], v[8:9]
    v_pk_fma_f32 v[10:11], v[142:143], v[142:143], v[10:11]
    s_mov_b64 exec, s[72:73]
    v_pk_fma_f32 v[8:9], v[144:145], v[144:145], v[8:9]
    v_pk_fma_f32 v[10:11], v[146:147], v[146:147], v[10:11]
    v_pk_fma_f32 v[8:9], v[148:149], v[148:149], v[8:9]
    v_pk_fma_f32 v[10:11], v[150:151], v[150:151], v[10:11]
    s_mov_b64 exec, -1
    v_pk_add_f32 v[8:9], v[8:9], v[10:11]
    v_add_f32 v8, v8, v9
    s_nop 1
    v_add_f32_dpp v8, v8, v8 quad_perm:[1,0,3,2] row_mask:0xf bank_mask:0xf
    s_nop 1
    v_add_f32_dpp v8, v8, v8 quad_perm:[2,3,0,1] row_mask:0xf bank_mask:0xf
    s_nop 1
    v_add_f32_dpp v8, v8, v8 row_half_mirror row_mask:0xf bank_mask:0xf
    s_nop 1
    v_add_f32_dpp v8, v8, v8 row_mirror row_mask:0xf bank_mask:0xf
    v_mul_f32 v14, 1.7361111111e-03, v8
    v_add_f32 v14, 0x3727c5ac, v14
    v_rsq_f32 v12, v14
    s_nop 0
    v_mov_b32 v13, v12
    v_pk_mul_f32 v[112:113], v[112:113], v[12:13]
    v_pk_mul_f32 v[114:115], v[114:115], v[12:13]
    v_pk_mul_f32 v[116:117], v[116:117], v[12:13]
    v_pk_mul_f32 v[118:119], v[118:119], v[12:13]
    v_pk_mul_f32 v[120:121], v[120:121], v[12:13]
    v_pk_mul_f32 v[122:123], v[122:123], v[12:13]
    v_pk_mul_f32 v[124:125], v[124:125], v[12:13]
    v_pk_mul_f32 v[126:127], v[126:127], v[12:13]
    v_pk_mul_f32 v[128:129], v[128:129], v[12:13]
    v_pk_mul_f32 v[130:131], v[130:131], v[12:13]
    v_pk_mul_f32 v[132:133], v[132:133], v[12:13]
    v_pk_mul_f32 v[134:135], v[134:135], v[12:13]
    v_pk_mul_f32 v[136:137], v[136:137], v[12:13]
    v_pk_mul_f32 v[138:139], v[138:139], v[12:13]
    v_pk_mul_f32 v[140:141], v[140:141], v[12:13]
    v_pk_mul_f32 v[142:143], v[142:143], v[12:13]
    v_pk_mul_f32 v[144:145], v[144:145], v[12:13]
    v_pk_mul_f32 v[146:147], v[146:147], v[12:13]
    v_pk_mul_f32 v[148:149], v[148:149], v[12:13]
    v_pk_mul_f32 v[150:151], v[150:151], v[12:13]
    s_mov_b32 s60, 1048576
L_poll_15:
    buffer_load_dword v8, v4, s[8:11], s74 offen sc1
    buffer_load_dword v9, v4, s[8:11], s75 offen sc1
    buffer_load_dword v10, v4, s[8:11], s76 offen sc1
    s_waitcnt vmcnt(0)
    v_min3_u32 v8, v8, v9, v10
    v_cmp_eq_u32 vcc, 0, v8
    s_cbranch_vccz L_pdone_16
    s_sleep 4
    s_sub_u32 s60, s60, 1
    s_cbranch_scc1 L_abort
    s_branch L_poll_15
L_pdone_16:
    s_barrier
    s_mov_b32 m0, s70
    s_nop 0
    buffer_load_dwordx4 v5, s[8:11], s69 offen offset:0 sc1 lds
    buffer_load_dwordx4 v5, s[8:11], s69 offen offset:1024 sc1 lds
    buffer_load_dwordx4 v5, s[8:11], s69 offen offset:2048 sc1 lds
    buffer_load_dwordx4 v5, s[8:11], s69 offen offset:3072 sc1 lds
    s_add_u32 m0, s70, 4096
    s_add_u32 s69, s69, 4096
    buffer_load_dwordx4 v5, s[8:11], s69 offen sc1 lds
    s_waitcnt vmcnt(0)
    s_barrier
    ds_read_b64_tr_b16 v[40:41], v6 offset:0
    ds_read_b64_tr_b16 v[42:43], v6 offset:128
    ds_read_b64_tr_b16 v[44:45], v6 offset:4096
    ds_read_b64_tr_b16 v[46:47], v6 offset:4224
    ds_read_b64_tr_b16 v[48:49], v6 offset:8192
    ds_read_b64_tr_b16 v[50:51], v6 offset:8320
    ds_read_b64_tr_b16 v[52:53], v6 offset:12288
    ds_read_b64_tr_b16 v[54:55], v6 offset:12416
    ds_read_b64_tr_b16 v[56:57], v6 offset:16384
    ds_read_b64_tr_b16 v[58:59], v6 offset:16512
    s_waitcnt lgkmcnt(8)
    ds_write_b128 v7, v[40:43] offset:0
    s_waitcnt lgkmcnt(7)
    ds_write_b128 v7, v[44:47] offset:1024
    s_waitcnt lgkmcnt(6)
    ds_write_b128 v7, v[48:51] offset:2048
    s_waitcnt lgkmcnt(5)
    ds_write_b128 v7, v[52:55] offset:3072
    s_waitcnt lgkmcnt(4)
    ds_write_b128 v7, v[56:59] offset:4096
    s_waitcnt lgkmcnt(0)
    ds_read_b128 v[40:43], v15 offset:0
    ds_read_b128 v[44:47], v15 offset:1024
    ds_read_b128 v[48:51], v15 offset:2048
    ds_read_b128 v[52:55], v15 offset:3072
    ds_read_b128 v[56:59], v15 offset:4096
    s_add_u32 s69, s68, 4194304
    s_add_u32 s70, s68, 7340032
    s_add_u32 s71, s68, 10485760
    s_waitcnt lgkmcnt(4)
    v_lshlrev_b32 v8, 16, v40
    v_and_b32 v9, 0xffff0000, v40
    v_pk_fma_f32 v[64:65], v[112:113], v[8:9], v[64:65]
    v_cvt_pk_bf16_f32 v16, v64, v65
    v_lshlrev_b32 v64, 16, v16
    v_and_b32 v65, 0xffff0000, v16
    v_lshlrev_b32 v8, 16, v41
    v_and_b32 v9, 0xffff0000, v41
    v_pk_fma_f32 v[66:67], v[114:115], v[8:9], v[66:67]
    v_cvt_pk_bf16_f32 v17, v66, v67
    v_lshlrev_b32 v66, 16, v17
    v_and_b32 v67, 0xffff0000, v17
    v_lshlrev_b32 v8, 16, v42
    v_and_b32 v9, 0xffff0000, v42
    v_pk_fma_f32 v[68:69], v[116:117], v[8:9], v[68:69]
    v_cvt_pk_bf16_f32 v18, v68, v69
    v_lshlrev_b32 v68, 16, v18
    v_and_b32 v69, 0xffff0000, v18
    v_lshlrev_b32 v8, 16, v43
    v_and_b32 v9, 0xffff0000, v43
    v_pk_fma_f32 v[70:71], v[118:119], v[8:9], v[70:71]
    v_cvt_pk_bf16_f32 v19, v70, v71
    v_lshlrev_b32 v70, 16, v19
    v_and_b32 v71, 0xffff0000, v19
    s_waitcnt lgkmcnt(3)
    v_lshlrev_b32 v8, 16, v44
    v_and_b32 v9, 0xffff0000, v44
    v_pk_fma_f32 v[72:73], v[120:121], v[8:9], v[72:73]
    v_cvt_pk_bf16_f32 v20, v72, v73
    v_lshlrev_b32 v72, 16, v20
    v_and_b32 v73, 0xffff0000, v20
    v_lshlrev_b32 v8, 16, v45
    v_and_b32 v9, 0xffff0000, v45
    v_pk_fma_f32 v[74:75], v[122:123], v[8:9], v[74:75]
    v_cvt_pk_bf16_f32 v21, v74, v75
    v_lshlrev_b32 v74, 16, v21
    v_and_b32 v75, 0xffff0000, v21
    v_lshlrev_b32 v8, 16, v46
    v_and_b32 v9, 0xffff0000, v46
    v_pk_fma_f32 v[76:77], v[124:125], v[8:9], v[76:77]
    v_cvt_pk_bf16_f32 v22, v76, v77
    v_lshlrev_b32 v76, 16, v22
    v_and_b32 v77, 0xffff0000, v22
    v_lshlrev_b32 v8, 16, v47
    v_and_b32 v9, 0xffff0000, v47
    v_pk_fma_f32 v[78:79], v[126:127], v[8:9], v[78:79]
    v_cvt_pk_bf16_f32 v23, v78, v79
    v_lshlrev_b32 v78, 16, v23
    v_and_b32 v79, 0xffff0000, v23
    s_waitcnt lgkmcnt(2)
    v_lshlrev_b32 v8, 16, v48
    v_and_b32 v9, 0xffff0000, v48
    v_pk_fma_f32 v[80:81], v[128:129], v[8:9], v[80:81]
    v_cvt_pk_bf16_f32 v24, v80, v81
    v_lshlrev_b32 v80, 16, v24
    v_and_b32 v81, 0xffff0000, v24
    v_lshlrev_b32 v8, 16, v49
    v_and_b32 v9, 0xffff0000, v49
    v_pk_fma_f32 v[82:83], v[130:131], v[8:9], v[82:83]
    v_cvt_pk_bf16_f32 v25, v82, v83
    v_lshlrev_b32 v82, 16, v25
    v_and_b32 v83, 0xffff0000, v25
    v_lshlrev_b32 v8, 16, v50
    v_and_b32 v9, 0xffff0000, v50
    v_pk_fma_f32 v[84:85], v[132:133], v[8:9], v[84:85]
    v_cvt_pk_bf16_f32 v26, v84, v85
    v_lshlrev_b32 v84, 16, v26
    v_and_b32 v85, 0xffff0000, v26
    v_lshlrev_b32 v8, 16, v51
    v_and_b32 v9, 0xffff0000, v51
    v_pk_fma_f32 v[86:87], v[134:135], v[8:9], v[86:87]
    v_cvt_pk_bf16_f32 v27, v86, v87
    v_lshlrev_b32 v86, 16, v27
    v_and_b32 v87, 0xffff0000, v27
    s_waitcnt lgkmcnt(1)
    v_lshlrev_b32 v8, 16, v52
    v_and_b32 v9, 0xffff0000, v52
    v_pk_fma_f32 v[88:89], v[136:137], v[8:9], v[88:89]
    v_cvt_pk_bf16_f32 v28, v88, v89
    v_lshlrev_b32 v88, 16, v28
    v_and_b32 v89, 0xffff0000, v28
    v_lshlrev_b32 v8, 16, v53
    v_and_b32 v9, 0xffff0000, v53
    v_pk_fma_f32 v[90:91], v[138:139], v[8:9], v[90:91]
    v_cvt_pk_bf16_f32 v29, v90, v91
    v_lshlrev_b32 v90, 16, v29
    v_and_b32 v91, 0xffff0000, v29
    v_lshlrev_b32 v8, 16, v54
    v_and_b32 v9, 0xffff0000, v54
    v_pk_fma_f32 v[92:93], v[140:141], v[8:9], v[92:93]
    v_cvt_pk_bf16_f32 v30, v92, v93
    v_lshlrev_b32 v92, 16, v30
    v_and_b32 v93, 0xffff0000, v30
    v_lshlrev_b32 v8, 16, v55
    v_and_b32 v9, 0xffff0000, v55
    v_pk_fma_f32 v[94:95], v[142:143], v[8:9], v[94:95]
    v_cvt_pk_bf16_f32 v31, v94, v95
    v_lshlrev_b32 v94, 16, v31
    v_and_b32 v95, 0xffff0000, v31
    s_waitcnt lgkmcnt(0)
    s_mov_b64 exec, s[72:73]
    v_lshlrev_b32 v8, 16, v56
    v_and_b32 v9, 0xffff0000, v56
    v_pk_fma_f32 v[96:97], v[144:145], v[8:9], v[96:97]
    v_cvt_pk_bf16_f32 v32, v96, v97
    v_lshlrev_b32 v96, 16, v32
    v_and_b32 v97, 0xffff0000, v32
    v_lshlrev_b32 v8, 16, v57
    v_and_b32 v9, 0xffff0000, v57
    v_pk_fma_f32 v[98:99], v[146:147], v[8:9], v[98:99]
    v_cvt_pk_bf16_f32 v33, v98, v99
    v_lshlrev_b32 v98, 16, v33
    v_and_b32 v99, 0xffff0000, v33
    v_lshlrev_b32 v8, 16, v58
    v_and_b32 v9, 0xffff0000, v58
    v_pk_fma_f32 v[100:101], v[148:149], v[8:9], v[100:101]
    v_cvt_pk_bf16_f32 v34, v100, v101
    v_lshlrev_b32 v100, 16, v34
    v_and_b32 v101, 0xffff0000, v34
    v_lshlrev_b32 v8, 16, v59
    v_and_b32 v9, 0xffff0000, v59
    v_pk_fma_f32 v[102:103], v[150:151], v[8:9], v[102:103]
    v_cvt_pk_bf16_f32 v35, v102, v103
    v_lshlrev_b32 v102, 16, v35
    v_and_b32 v103, 0xffff0000, v35
    s_mov_b64 exec, -1
    v_pk_add_f32 v[8:9], v[64:65], v[66:67]
    v_pk_add_f32 v[10:11], v[68:69], v[70:71]
    v_pk_add_f32 v[8:9], v[8:9], v[72:73]
    v_pk_add_f32 v[10:11], v[10:11], v[74:75]
    v_pk_add_f32 v[8:9], v[8:9], v[76:77]
    v_pk_add_f32 v[10:11], v[10:11], v[78:79]
    v_pk_add_f32 v[8:9], v[8:9], v[80:81]
    v_pk_add_f32 v[10:11], v[10:11], v[82:83]
    v_pk_add_f32 v[8:9], v[8:9], v[84:85]
    v_pk_add_f32 v[10:11], v[10:11], v[86:87]
    v_pk_add_f32 v[8:9], v[8:9], v[88:89]
    v_pk_add_f32 v[10:11], v[10:11], v[90:91]
    v_pk_add_f32 v[8:9], v[8:9], v[92:93]
    v_pk_add_f32 v[10:11], v[10:11], v[94:95]
    v_pk_add_f32 v[8:9], v[8:9], v[96:97]
    v_pk_add_f32 v[10:11], v[10:11], v[98:99]
    v_pk_add_f32 v[8:9], v[8:9], v[100:101]
    v_pk_add_f32 v[10:11], v[10:11], v[102:103]
    v_pk_add_f32 v[8:9], v[8:9], v[10:11]
    v_add_f32 v8, v8, v9
    s_nop 1
    v_add_f32_dpp v8, v8, v8 quad_perm:[1,0,3,2] row_mask:0xf bank_mask:0xf
    s_nop 1
    v_add_f32_dpp v8, v8, v8 quad_perm:[2,3,0,1] row_mask:0xf bank_mask:0xf
    s_nop 1
    v_add_f32_dpp v8, v8, v8 row_half_mirror row_mask:0xf bank_mask:0xf
    s_nop 1
    v_add_f32_dpp v8, v8, v8 row_mirror row_mask:0xf bank_mask:0xf
    v_mul_f32 v12, -1.7361111111e-03, v8
    v_mul_f32 v13, -1.7361111111e-03, v8
    v_pk_add_f32 v[112:113], v[64:65], v[12:13]
    v_pk_add_f32 v[114:115], v[66:67], v[12:13]
    v_pk_add_f32 v[116:117], v[68:69], v[12:13]
    v_pk_add_f32 v[118:119], v[70:71], v[12:13]
    v_pk_add_f32 v[120:121], v[72:73], v[12:13]
    v_pk_add_f32 v[122:123], v[74:75], v[12:13]
    v_pk_add_f32 v[124:125], v[76:77], v[12:13]
    v_pk_add_f32 v[126:127], v[78:79], v[12:13]
    v_pk_add_f32 v[128:129], v[80:81], v[12:13]
    v_pk_add_f32 v[130:131], v[82:83], v[12:13]
    v_pk_add_f32 v[132:133], v[84:85], v[12:13]
    v_pk_add_f32 v[134:135], v[86:87], v[12:13]
    v_pk_add_f32 v[136:137], v[88:89], v[12:13]
    v_pk_add_f32 v[138:139], v[90:91], v[12:13]
    v_pk_add_f32 v[140:141], v[92:93], v[12:13]
    v_pk_add_f32 v[142:143], v[94:95], v[12:13]
    v_pk_add_f32 v[144:145], v[96:97], v[12:13]
    v_pk_add_f32 v[146:147], v[98:99], v[12:13]
    v_pk_add_f32 v[148:149], v[100:101], v[12:13]
    v_pk_add_f32 v[150:151], v[102:103], v[12:13]
    v_pk_mul_f32 v[8:9], v[112:113], v[112:113]
    v_pk_mul_f32 v[10:11], v[114:115], v[114:115]
    v_pk_fma_f32 v[8:9], v[116:117], v[116:117], v[8:9]
    v_pk_fma_f32 v[10:11], v[118:119], v[118:119], v[10:11]
    v_pk_fma_f32 v[8:9], v[120:121], v[120:121], v[8:9]
    v_pk_fma_f32 v[10:11], v[122:123], v[122:123], v[10:11]
    v_pk_fma_f32 v[8:9], v[124:125], v[124:125], v[8:9]
    v_pk_fma_f32 v[10:11], v[126:127], v[126:127], v[10:11]
    v_pk_fma_f32 v[8:9], v[128:129], v[128:129], v[8:9]
    v_pk_fma_f32 v[10:11], v[130:131], v[130:131], v[10:11]
    v_pk_fma_f32 v[8:9], v[132:133], v[132:133], v[8:9]
    v_pk_fma_f32 v[10:11], v[134:135], v[134:135], v[10:11]
    v_pk_fma_f32 v[8:9], v[136:137], v[136:137], v[8:9]
    v_pk_fma_f32 v[10:11], v[138:139], v[138:139], v[10:11]
    v_pk_fma_f32 v[8:9], v[140:141], v[140:141], v[8:9]
    v_pk_fma_f32 v[10:11], v[142:143], v[142:143], v[10:11]
    s_mov_b64 exec, s[72:73]
    v_pk_fma_f32 v[8:9], v[144:145], v[144:145], v[8:9]
    v_pk_fma_f32 v[10:11], v[146:147], v[146:147], v[10:11]
    v_pk_fma_f32 v[8:9], v[148:149], v[148:149], v[8:9]
    v_pk_fma_f32 v[10:11], v[150:151], v[150:151], v[10:11]
    s_mov_b64 exec, -1
    v_pk_add_f32 v[8:9], v[8:9], v[10:11]
    v_add_f32 v8, v8, v9
    s_nop 1
    v_add_f32_dpp v8, v8, v8 quad_perm:[1,0,3,2] row_mask:0xf bank_mask:0xf
    s_nop 1
    v_add_f32_dpp v8, v8, v8 quad_perm:[2,3,0,1] row_mask:0xf bank_mask:0xf
    s_nop 1
    v_add_f32_dpp v8, v8, v8 row_half_mirror row_mask:0xf bank_mask:0xf
    s_nop 1
    v_add_f32_dpp v8, v8, v8 row_mirror row_mask:0xf bank_mask:0xf
    v_mul_f32 v14, 1.7361111111e-03, v8
    v_cvt_pk_bf16_f32 v12, v12, v12
    v_and_b32 v12, 0xffff0000, v12
    v_mov_b32 v13, v12
    v_cvt_pk_bf16_f32 v14, v14, v14
    v_and_b32 v14, 0xffff0000, v14
    v_add_f32 v14, 0x3727c5ac, v14
    v_cvt_pk_bf16_f32 v14, v14, v14
    v_and_b32 v14, 0xffff0000, v14
    v_sqrt_f32 v14, v14
    s_nop 0
    v_cvt_pk_bf16_f32 v14, v14, v14
    v_and_b32 v14, 0xffff0000, v14
    v_rcp_f32 v14, v14
    s_nop 0
    v_mov_b32 v15, v14
    v_pk_add_f32 v[8:9], v[64:65], v[12:13]
    v_cvt_pk_bf16_f32 v10, v8, v9
    v_lshlrev_b32 v8, 16, v10
    v_and_b32 v9, 0xffff0000, v10
    v_pk_mul_f32 v[8:9], v[8:9], v[14:15]
    v_cvt_pk_bf16_f32 v112, v8, v9
    v_pk_add_f32 v[8:9], v[66:67], v[12:13]
    v_cvt_pk_bf16_f32 v10, v8, v9
    v_lshlrev_b32 v8, 16, v10
    v_and_b32 v9, 0xffff0000, v10
    v_pk_mul_f32 v[8:9], v[8:9], v[14:15]
    v_cvt_pk_bf16_f32 v113, v8, v9
    v_pk_add_f32 v[8:9], v[68:69], v[12:13]
    v_cvt_pk_bf16_f32 v10, v8, v9
    v_lshlrev_b32 v8, 16, v10
    v_and_b32 v9, 0xffff0000, v10
    v_pk_mul_f32 v[8:9], v[8:9], v[14:15]
    v_cvt_pk_bf16_f32 v114, v8, v9
    v_pk_add_f32 v[8:9], v[70:71], v[12:13]
    v_cvt_pk_bf16_f32 v10, v8, v9
    v_lshlrev_b32 v8, 16, v10
    v_and_b32 v9, 0xffff0000, v10
    v_pk_mul_f32 v[8:9], v[8:9], v[14:15]
    v_cvt_pk_bf16_f32 v115, v8, v9
    buffer_store_dwordx4 v[112:115], v3, s[8:11], s71 offen offset:0 sc1
    v_pk_add_f32 v[8:9], v[72:73], v[12:13]
    v_cvt_pk_bf16_f32 v10, v8, v9
    v_lshlrev_b32 v8, 16, v10
    v_and_b32 v9, 0xffff0000, v10
    v_pk_mul_f32 v[8:9], v[8:9], v[14:15]
    v_cvt_pk_bf16_f32 v116, v8, v9
    v_pk_add_f32 v[8:9], v[74:75], v[12:13]
    v_cvt_pk_bf16_f32 v10, v8, v9
    v_lshlrev_b32 v8, 16, v10
    v_and_b32 v9, 0xffff0000, v10
    v_pk_mul_f32 v[8:9], v[8:9], v[14:15]
    v_cvt_pk_bf16_f32 v117, v8, v9
    v_pk_add_f32 v[8:9], v[76:77], v[12:13]
    v_cvt_pk_bf16_f32 v10, v8, v9
    v_lshlrev_b32 v8, 16, v10
    v_and_b32 v9, 0xffff0000, v10
    v_pk_mul_f32 v[8:9], v[8:9], v[14:15]
    v_cvt_pk_bf16_f32 v118, v8, v9
    v_pk_add_f32 v[8:9], v[78:79], v[12:13]
    v_cvt_pk_bf16_f32 v10, v8, v9
    v_lshlrev_b32 v8, 16, v10
    v_and_b32 v9, 0xffff0000, v10
    v_pk_mul_f32 v[8:9], v[8:9], v[14:15]
    v_cvt_pk_bf16_f32 v119, v8, v9
    buffer_store_dwordx4 v[116:119], v3, s[8:11], s71 offen offset:256 sc1
    v_pk_add_f32 v[8:9], v[80:81], v[12:13]
    v_cvt_pk_bf16_f32 v10, v8, v9
    v_lshlrev_b32 v8, 16, v10
    v_and_b32 v9, 0xffff0000, v10
    v_pk_mul_f32 v[8:9], v[8:9], v[14:15]
    v_cvt_pk_bf16_f32 v120, v8, v9
    v_pk_add_f32 v[8:9], v[82:83], v[12:13]
    v_cvt_pk_bf16_f32 v10, v8, v9
    v_lshlrev_b32 v8, 16, v10
    v_and_b32 v9, 0xffff0000, v10
    v_pk_mul_f32 v[8:9], v[8:9], v[14:15]
    v_cvt_pk_bf16_f32 v121, v8, v9
    v_pk_add_f32 v[8:9], v[84:85], v[12:13]
    v_cvt_pk_bf16_f32 v10, v8, v9
    v_lshlrev_b32 v8, 16, v10
    v_and_b32 v9, 0xffff0000, v10
    v_pk_mul_f32 v[8:9], v[8:9], v[14:15]
    v_cvt_pk_bf16_f32 v122, v8, v9
    v_pk_add_f32 v[8:9], v[86:87], v[12:13]
    v_cvt_pk_bf16_f32 v10, v8, v9
    v_lshlrev_b32 v8, 16, v10
    v_and_b32 v9, 0xffff0000, v10
    v_pk_mul_f32 v[8:9], v[8:9], v[14:15]
    v_cvt_pk_bf16_f32 v123, v8, v9
    buffer_store_dwordx4 v[120:123], v3, s[8:11], s71 offen offset:512 sc1
    v_pk_add_f32 v[8:9], v[88:89], v[12:13]
    v_cvt_pk_bf16_f32 v10, v8, v9
    v_lshlrev_b32 v8, 16, v10
    v_and_b32 v9, 0xffff0000, v10
    v_pk_mul_f32 v[8:9], v[8:9], v[14:15]
    v_cvt_pk_bf16_f32 v124, v8, v9
    v_pk_add_f32 v[8:9], v[90:91], v[12:13]
    v_cvt_pk_bf16_f32 v10, v8, v9
    v_lshlrev_b32 v8, 16, v10
    v_and_b32 v9, 0xffff0000, v10
    v_pk_mul_f32 v[8:9], v[8:9], v[14:15]
    v_cvt_pk_bf16_f32 v125, v8, v9
    v_pk_add_f32 v[8:9], v[92:93], v[12:13]
    v_cvt_pk_bf16_f32 v10, v8, v9
    v_lshlrev_b32 v8, 16, v10
    v_and_b32 v9, 0xffff0000, v10
    v_pk_mul_f32 v[8:9], v[8:9], v[14:15]
    v_cvt_pk_bf16_f32 v126, v8, v9
    v_pk_add_f32 v[8:9], v[94:95], v[12:13]
    v_cvt_pk_bf16_f32 v10, v8, v9
    v_lshlrev_b32 v8, 16, v10
    v_and_b32 v9, 0xffff0000, v10
    v_pk_mul_f32 v[8:9], v[8:9], v[14:15]
    v_cvt_pk_bf16_f32 v127, v8, v9
    buffer_store_dwordx4 v[124:127], v3, s[8:11], s71 offen offset:768 sc1
    s_mov_b64 exec, s[72:73]
    v_pk_add_f32 v[8:9], v[96:97], v[12:13]
    v_cvt_pk_bf16_f32 v10, v8, v9
    v_lshlrev_b32 v8, 16, v10
    v_and_b32 v9, 0xffff0000, v10
    v_pk_mul_f32 v[8:9], v[8:9], v[14:15]
    v_cvt_pk_bf16_f32 v128, v8, v9
    v_pk_add_f32 v[8:9], v[98:99], v[12:13]
    v_cvt_pk_bf16_f32 v10, v8, v9
    v_lshlrev_b32 v8, 16, v10
    v_and_b32 v9, 0xffff0000, v10
    v_pk_mul_f32 v[8:9], v[8:9], v[14:15]
    v_cvt_pk_bf16_f32 v129, v8, v9
    v_pk_add_f32 v[8:9], v[100:101], v[12:13]
    v_cvt_pk_bf16_f32 v10, v8, v9
    v_lshlrev_b32 v8, 16, v10
    v_and_b32 v9, 0xffff0000, v10
    v_pk_mul_f32 v[8:9], v[8:9], v[14:15]
    v_cvt_pk_bf16_f32 v130, v8, v9
    v_pk_add_f32 v[8:9], v[102:103], v[12:13]
    v_cvt_pk_bf16_f32 v10, v8, v9
    v_lshlrev_b32 v8, 16, v10
    v_and_b32 v9, 0xffff0000, v10
    v_pk_mul_f32 v[8:9], v[8:9], v[14:15]
    v_cvt_pk_bf16_f32 v131, v8, v9
    buffer_store_dwordx4 v[128:131], v3, s[8:11], s71 offen offset:1024 sc1
    s_mov_b64 exec, -1
    s_lshl_b32 s74, s67, 2
    s_add_u32 s74, s74, 16384
    s_lshl_b32 s67, s66, 6
    s_add_u32 s67, s67, 4096
    v_mov_b32 v1, 0
    v_mov_b32 v4, 1
    v_mov_b32 v5, 1
    v_mov_b32 v6, 1
    v_mov_b32 v7, 1
    s_waitcnt vmcnt(0)
    s_mov_b64 exec, 1
    buffer_store_dwordx4 v[4:7], v1, s[8:11], s74 offen sc1
    s_mov_b64 exec, -1
    buffer_store_dwordx4 v[16:19], v3, s[8:11], s70 offen offset:0 sc1
    buffer_store_dwordx4 v[40:43], v3, s[8:11], s69 offen offset:0 sc1
    buffer_store_dwordx4 v[20:23], v3, s[8:11], s70 offen offset:256 sc1
    buffer_store_dwordx4 v[44:47], v3, s[8:11], s69 offen offset:256 sc1
    buffer_store_dwordx4 v[24:27], v3, s[8:11], s70 offen offset:512 sc1
    buffer_store_dwordx4 v[48:51], v3, s[8:11], s69 offen offset:512 sc1
    buffer_store_dwordx4 v[28:31], v3, s[8:11], s70 offen offset:768 sc1
    buffer_store_dwordx4 v[52:55], v3, s[8:11], s69 offen offset:768 sc1
    s_mov_b64 exec, s[72:73]
    buffer_store_dwordx4 v[32:35], v3, s[8:11], s70 offen offset:1024 sc1
    buffer_store_dwordx4 v[56:59], v3, s[8:11], s69 offen offset:1024 sc1
    s_mov_b64 exec, -1
    s_waitcnt vmcnt(0)
    s_barrier
    s_cmp_lg_u32 s3, 0
    s_cbranch_scc1 L_xf_17
    s_mov_b64 exec, 1
    buffer_store_dword v4, v1, s[8:11], s67 offen sc1
    s_mov_b64 exec, -1
L_xf_17:
L_nob:
    s_add_u32 s66, s66, 64
    s_cmp_ge_u32 s66, 128
    s_cbranch_scc1 L_prodone
    s_cmp_eq_u32 s62, 255
    s_cbranch_scc1 L_stageb
    v_and_b32 v1, 31, v0
    v_lshrrev_b32 v2, 5, v0
    v_and_b32 v3, 3, v0
    v_mul_u32_u24 v3, 4160, v3
    v_lshrrev_b32 v4, 2, v1
    v_lshl_add_u32 v4, v2, 1, v4
    v_lshl_add_u32 v3, v4, 3, v3
    s_mul_i32 s70, s3, 16640
    v_add_u32 v3, s70, v3
    v_sub_u32 v4, 31, v1
    v_mul_u32_u24 v4, 80, v4
    v_lshl_add_u32 v5, v2, 4, v4
    s_mul_i32 s71, s3, 7680
    s_add_u32 s71, s71, 66560
    v_add_u32 v5, s71, v5
    ds_read_b64 v[64:65], v3 offset:0
    ds_read_b64 v[66:67], v3 offset:8
    ds_read_b128 v[68:71], v5 offset:0
    ds_read_b64 v[72:73], v3 offset:32
    ds_read_b64 v[74:75], v3 offset:40
    ds_read_b128 v[76:79], v5 offset:32
    ds_read_b64 v[80:81], v3 offset:64
    ds_read_b64 v[82:83], v3 offset:72
    ds_read_b128 v[84:87], v5 offset:80
    ds_read_b64 v[88:89], v3 offset:96
    ds_read_b64 v[90:91], v3 offset:104
    ds_read_b128 v[92:95], v5 offset:112
    s_waitcnt lgkmcnt(9)
    v_mfma_f32_32x32x16_bf16 v[16:31], v[64:67], v[68:71], 0
    ds_read_b64 v[96:97], v3 offset:128
    ds_read_b64 v[98:99], v3 offset:136
    ds_read_b128 v[100:103], v5 offset:160
    s_waitcnt lgkmcnt(9)
    v_mfma_f32_32x32x16_bf16 v[16:31], v[72:75], v[76:79], v[16:31]
    ds_read_b64 v[64:65], v3 offset:160
    ds_read_b64 v[66:67], v3 offset:168
    ds_read_b128 v[68:71], v5 offset:192
    s_waitcnt lgkmcnt(9)
    v_mfma_f32_32x32x16_bf16 v[16:31], v[80:83], v[84:87], v[16:31]
    ds_read_b64 v[72:73], v3 offset:192
    ds_read_b64 v[74:75], v3 offset:200
    ds_read_b128 v[76:79], v5 offset:240
    s_waitcnt lgkmcnt(9)
    v_mfma_f32_32x32x16_bf16 v[16:31], v[88:91], v[92:95], v[16:31]
    ds_read_b64 v[80:81], v3 offset:224
    ds_read_b64 v[82:83], v3 offset:232
    ds_read_b128 v[84:87], v5 offset:272
    s_waitcnt lgkmcnt(9)
    v_mfma_f32_32x32x16_bf16 v[16:31], v[96:99], v[100:103], v[16:31]
    ds_read_b64 v[88:89], v3 offset:256
    ds_read_b64 v[90:91], v3 offset:264
    ds_read_b128 v[92:95], v5 offset:320
    s_waitcnt lgkmcnt(9)
    v_mfma_f32_32x32x16_bf16 v[16:31], v[64:67], v[68:71], v[16:31]
    ds_read_b64 v[96:97], v3 offset:288
    ds_read_b64 v[98:99], v3 offset:296
    ds_read_b128 v[100:103], v5 offset:352
    s_waitcnt lgkmcnt(9)
    v_mfma_f32_32x32x16_bf16 v[16:31], v[72:75], v[76:79], v[16:31]
    ds_read_b64 v[64:65], v3 offset:320
    ds_read_b64 v[66:67], v3 offset:328
    ds_read_b128 v[68:71], v5 offset:400
    s_waitcnt lgkmcnt(9)
    v_mfma_f32_32x32x16_bf16 v[16:31], v[80:83], v[84:87], v[16:31]
    ds_read_b64 v[72:73], v3 offset:352
    ds_read_b64 v[74:75], v3 offset:360
    ds_read_b128 v[76:79], v5 offset:432
    s_waitcnt lgkmcnt(9)
    v_mfma_f32_32x32x16_bf16 v[16:31], v[88:91], v[92:95], v[16:31]
    ds_read_b64 v[80:81], v3 offset:384
    ds_read_b64 v[82:83], v3 offset:392
    ds_read_b128 v[84:87], v5 offset:480
    s_waitcnt lgkmcnt(9)
    v_mfma_f32_32x32x16_bf16 v[16:31], v[96:99], v[100:103], v[16:31]
    ds_read_b64 v[88:89], v3 offset:416
    ds_read_b64 v[90:91], v3 offset:424
    ds_read_b128 v[92:95], v5 offset:512
    s_waitcnt lgkmcnt(9)
    v_mfma_f32_32x32x16_bf16 v[16:31], v[64:67], v[68:71], v[16:31]
    ds_read_b64 v[96:97], v3 offset:448
    ds_read_b64 v[98:99], v3 offset:456
    ds_read_b128 v[100:103], v5 offset:560
    s_waitcnt lgkmcnt(9)
    v_mfma_f32_32x32x16_bf16 v[16:31], v[72:75], v[76:79], v[16:31]
    ds_read_b64 v[64:65], v3 offset:480
    ds_read_b64 v[66:67], v3 offset:488
    ds_read_b128 v[68:71], v5 offset:592
    s_waitcnt lgkmcnt(9)
    v_mfma_f32_32x32x16_bf16 v[16:31], v[80:83], v[84:87], v[16:31]
    ds_read_b64 v[72:73], v3 offset:512
    ds_read_b64 v[74:75], v3 offset:520
    ds_read_b128 v[76:79], v5 offset:640
    s_waitcnt lgkmcnt(9)
    v_mfma_f32_32x32x16_bf16 v[16:31], v[88:91], v[92:95], v[16:31]
    ds_read_b64 v[80:81], v3 offset:544
    ds_read_b64 v[82:83], v3 offset:552
    ds_read_b128 v[84:87], v5 offset:672
    s_waitcnt lgkmcnt(9)
    v_mfma_f32_32x32x16_bf16 v[16:31], v[96:99], v[100:103], v[16:31]
    ds_read_b64 v[88:89], v3 offset:576
    ds_read_b64 v[90:91], v3 offset:584
    ds_read_b128 v[92:95], v5 offset:720
    s_waitcnt lgkmcnt(9)
    v_mfma_f32_32x32x16_bf16 v[16:31], v[64:67], v[68:71], v[16:31]
    ds_read_b64 v[96:97], v3 offset:608
    ds_read_b64 v[98:99], v3 offset:616
    ds_read_b128 v[100:103], v5 offset:752
    s_waitcnt lgkmcnt(9)
    v_mfma_f32_32x32x16_bf16 v[16:31], v[72:75], v[76:79], v[16:31]
    ds_read_b64 v[64:65], v3 offset:640
    ds_read_b64 v[66:67], v3 offset:648
    ds_read_b128 v[68:71], v5 offset:800
    s_waitcnt lgkmcnt(9)
    v_mfma_f32_32x32x16_bf16 v[16:31], v[80:83], v[84:87], v[16:31]
    ds_read_b64 v[72:73], v3 offset:672
    ds_read_b64 v[74:75], v3 offset:680
    ds_read_b128 v[76:79], v5 offset:832
    s_waitcnt lgkmcnt(9)
    v_mfma_f32_32x32x16_bf16 v[16:31], v[88:91], v[92:95], v[16:31]
    ds_read_b64 v[80:81], v3 offset:704
    ds_read_b64 v[82:83], v3 offset:712
    ds_read_b128 v[84:87], v5 offset:880
    s_waitcnt lgkmcnt(9)
    v_mfma_f32_32x32x16_bf16 v[16:31], v[96:99], v[100:103], v[16:31]
    ds_read_b64 v[88:89], v3 offset:736
    ds_read_b64 v[90:91], v3 offset:744
    ds_read_b128 v[92:95], v5 offset:912
    s_waitcnt lgkmcnt(9)
    v_mfma_f32_32x32x16_bf16 v[16:31], v[64:67], v[68:71], v[16:31]
    ds_read_b64 v[96:97], v3 offset:768
    ds_read_b64 v[98:99], v3 offset:776
    ds_read_b128 v[100:103], v5 offset:960
    s_waitcnt lgkmcnt(9)
    v_mfma_f32_32x32x16_bf16 v[16:31], v[72:75], v[76:79], v[16:31]
    ds_read_b64 v[64:65], v3 offset:800
    ds_read_b64 v[66:67], v3 offset:808
    ds_read_b128 v[68:71], v5 offset:992
    s_waitcnt lgkmcnt(9)
    v_mfma_f32_32x32x16_bf16 v[16:31], v[80:83], v[84:87], v[16:31]
    ds_read_b64 v[72:73], v3 offset:832
    ds_read_b64 v[74:75], v3 offset:840
    ds_read_b128 v[76:79], v5 offset:1040
    s_waitcnt lgkmcnt(9)
    v_mfma_f32_32x32x16_bf16 v[16:31], v[88:91], v[92:95], v[16:31]
    ds_read_b64 v[80:81], v3 offset:864
    ds_read_b64 v[82:83], v3 offset:872
    ds_read_b128 v[84:87], v5 offset:1072
    s_waitcnt lgkmcnt(9)
    v_mfma_f32_32x32x16_bf16 v[16:31], v[96:99], v[100:103], v[16:31]
    ds_read_b64 v[88:89], v3 offset:896
    ds_read_b64 v[90:91], v3 offset:904
    ds_read_b128 v[92:95], v5 offset:1120
    s_waitcnt lgkmcnt(9)
    v_mfma_f32_32x32x16_bf16 v[16:31], v[64:67], v[68:71], v[16:31]
    ds_read_b64 v[96:97], v3 offset:928
    ds_read_b64 v[98:99], v3 offset:936
    ds_read_b128 v[100:103], v5 offset:1152
    s_waitcnt lgkmcnt(9)
    v_mfma_f32_32x32x16_bf16 v[16:31], v[72:75], v[76:79], v[16:31]
    ds_read_b64 v[64:65], v3 offset:960
    ds_read_b64 v[66:67], v3 offset:968
    ds_read_b128 v[68:71], v5 offset:1200
    s_waitcnt lgkmcnt(9)
    v_mfma_f32_32x32x16_bf16 v[16:31], v[80:83], v[84:87], v[16:31]
    ds_read_b64 v[72:73], v3 offset:992
    ds_read_b64 v[74:75], v3 offset:1000
    ds_read_b128 v[76:79], v5 offset:1232
    s_waitcnt lgkmcnt(9)
    v_mfma_f32_32x32x16_bf16 v[16:31], v[88:91], v[92:95], v[16:31]
    ds_read_b64 v[80:81], v3 offset:1024
    ds_read_b64 v[82:83], v3 offset:1032
    ds_read_b128 v[84:87], v5 offset:1280
    s_waitcnt lgkmcnt(9)
    v_mfma_f32_32x32x16_bf16 v[16:31], v[96:99], v[100:103], v[16:31]
    ds_read_b64 v[88:89], v3 offset:1056
    ds_read_b64 v[90:91], v3 offset:1064
    ds_read_b128 v[92:95], v5 offset:1312
    s_waitcnt lgkmcnt(9)
    v_mfma_f32_32x32x16_bf16 v[16:31], v[64:67], v[68:71], v[16:31]
    ds_read_b64 v[96:97], v3 offset:1088
    ds_read_b64 v[98:99], v3 offset:1096
    ds_read_b128 v[100:103], v5 offset:1360
    s_waitcnt lgkmcnt(9)
    v_mfma_f32_32x32x16_bf16 v[16:31], v[72:75], v[76:79], v[16:31]
    ds_read_b64 v[64:65], v3 offset:1120
    ds_read_b64 v[66:67], v3 offset:1128
    ds_read_b128 v[68:71], v5 offset:1392
    s_waitcnt lgkmcnt(9)
    v_mfma_f32_32x32x16_bf16 v[16:31], v[80:83], v[84:87], v[16:31]
    ds_read_b64 v[72:73], v3 offset:1152
    ds_read_b64 v[74:75], v3 offset:1160
    ds_read_b128 v[76:79], v5 offset:1440
    s_waitcnt lgkmcnt(9)
    v_mfma_f32_32x32x16_bf16 v[16:31], v[88:91], v[92:95], v[16:31]
    ds_read_b64 v[80:81], v3 offset:1184
    ds_read_b64 v[82:83], v3 offset:1192
    ds_read_b128 v[84:87], v5 offset:1472
    s_waitcnt lgkmcnt(9)
    v_mfma_f32_32x32x16_bf16 v[16:31], v[96:99], v[100:103], v[16:31]
    ds_read_b64 v[88:89], v3 offset:1216
    ds_read_b64 v[90:91], v3 offset:1224
    ds_read_b128 v[92:95], v5 offset:1520
    s_waitcnt lgkmcnt(9)
    v_mfma_f32_32x32x16_bf16 v[16:31], v[64:67], v[68:71], v[16:31]
    ds_read_b64 v[96:97], v3 offset:1248
    ds_read_b64 v[98:99], v3 offset:1256
    ds_read_b128 v[100:103], v5 offset:1552
    s_waitcnt lgkmcnt(9)
    v_mfma_f32_32x32x16_bf16 v[16:31], v[72:75], v[76:79], v[16:31]
    ds_read_b64 v[64:65], v3 offset:1280
    ds_read_b64 v[66:67], v3 offset:1288
    ds_read_b128 v[68:71], v5 offset:1600
    s_waitcnt lgkmcnt(9)
    v_mfma_f32_32x32x16_bf16 v[16:31], v[80:83], v[84:87], v[16:31]
    ds_read_b64 v[72:73], v3 offset:1312
    ds_read_b64 v[74:75], v3 offset:1320
    ds_read_b128 v[76:79], v5 offset:1632
    s_waitcnt lgkmcnt(9)
    v_mfma_f32_32x32x16_bf16 v[16:31], v[88:91], v[92:95], v[16:31]
    ds_read_b64 v[80:81], v3 offset:1344
    ds_read_b64 v[82:83], v3 offset:1352
    ds_read_b128 v[84:87], v5 offset:1680
    s_waitcnt lgkmcnt(9)
    v_mfma_f32_32x32x16_bf16 v[16:31], v[96:99], v[100:103], v[16:31]
    ds_read_b64 v[88:89], v3 offset:1376
    ds_read_b64 v[90:91], v3 offset:1384
    ds_read_b128 v[92:95], v5 offset:1712
    s_waitcnt lgkmcnt(9)
    v_mfma_f32_32x32x16_bf16 v[16:31], v[64:67], v[68:71], v[16:31]
    ds_read_b64 v[96:97], v3 offset:1408
    ds_read_b64 v[98:99], v3 offset:1416
    ds_read_b128 v[100:103], v5 offset:1760
    s_waitcnt lgkmcnt(9)
    v_mfma_f32_32x32x16_bf16 v[16:31], v[72:75], v[76:79], v[16:31]
    ds_read_b64 v[64:65], v3 offset:1440
    ds_read_b64 v[66:67], v3 offset:1448
    ds_read_b128 v[68:71], v5 offset:1792
    s_waitcnt lgkmcnt(9)
    v_mfma_f32_32x32x16_bf16 v[16:31], v[80:83], v[84:87], v[16:31]
    ds_read_b64 v[72:73], v3 offset:1472
    ds_read_b64 v[74:75], v3 offset:1480
    ds_read_b128 v[76:79], v5 offset:1840
    s_waitcnt lgkmcnt(9)
    v_mfma_f32_32x32x16_bf16 v[16:31], v[88:91], v[92:95], v[16:31]
    ds_read_b64 v[80:81], v3 offset:1504
    ds_read_b64 v[82:83], v3 offset:1512
    ds_read_b128 v[84:87], v5 offset:1872
    s_waitcnt lgkmcnt(9)
    v_mfma_f32_32x32x16_bf16 v[16:31], v[96:99], v[100:103], v[16:31]
    ds_read_b64 v[88:89], v3 offset:1536
    ds_read_b64 v[90:91], v3 offset:1544
    ds_read_b128 v[92:95], v5 offset:1920
    s_waitcnt lgkmcnt(9)
    v_mfma_f32_32x32x16_bf16 v[16:31], v[64:67], v[68:71], v[16:31]
    ds_read_b64 v[96:97], v3 offset:1568
    ds_read_b64 v[98:99], v3 offset:1576
    ds_read_b128 v[100:103], v5 offset:1952
    s_waitcnt lgkmcnt(9)
    v_mfma_f32_32x32x16_bf16 v[16:31], v[72:75], v[76:79], v[16:31]
    ds_read_b64 v[64:65], v3 offset:1600
    ds_read_b64 v[66:67], v3 offset:1608
    ds_read_b128 v[68:71], v5 offset:2000
    s_waitcnt lgkmcnt(9)
    v_mfma_f32_32x32x16_bf16 v[16:31], v[80:83], v[84:87], v[16:31]
    ds_read_b64 v[72:73], v3 offset:1632
    ds_read_b64 v[74:75], v3 offset:1640
    ds_read_b128 v[76:79], v5 offset:2032
    s_waitcnt lgkmcnt(9)
    v_mfma_f32_32x32x16_bf16 v[16:31], v[88:91], v[92:95], v[16:31]
    ds_read_b64 v[80:81], v3 offset:1664
    ds_read_b64 v[82:83], v3 offset:1672
    ds_read_b128 v[84:87], v5 offset:2080
    s_waitcnt lgkmcnt(9)
    v_mfma_f32_32x32x16_bf16 v[16:31], v[96:99], v[100:103], v[16:31]
    ds_read_b64 v[88:89], v3 offset:1696
    ds_read_b64 v[90:91], v3 offset:1704
    ds_read_b128 v[92:95], v5 offset:2112
    s_waitcnt lgkmcnt(9)
    v_mfma_f32_32x32x16_bf16 v[16:31], v[64:67], v[68:71], v[16:31]
    ds_read_b64 v[96:97], v3 offset:1728
    ds_read_b64 v[98:99], v3 offset:1736
    ds_read_b128 v[100:103], v5 offset:2160
    s_waitcnt lgkmcnt(9)
    v_mfma_f32_32x32x16_bf16 v[16:31], v[72:75], v[76:79], v[16:31]
    ds_read_b64 v[64:65], v3 offset:1760
    ds_read_b64 v[66:67], v3 offset:1768
    ds_read_b128 v[68:71], v5 offset:2192
    s_waitcnt lgkmcnt(9)
    v_mfma_f32_32x32x16_bf16 v[16:31], v[80:83], v[84:87], v[16:31]
    ds_read_b64 v[72:73], v3 offset:1792
    ds_read_b64 v[74:75], v3 offset:1800
    ds_read_b128 v[76:79], v5 offset:2240
    s_waitcnt lgkmcnt(9)
    v_mfma_f32_32x32x16_bf16 v[16:31], v[88:91], v[92:95], v[16:31]
    ds_read_b64 v[80:81], v3 offset:1824
    ds_read_b64 v[82:83], v3 offset:1832
    ds_read_b128 v[84:87], v5 offset:2272
    s_waitcnt lgkmcnt(9)
    v_mfma_f32_32x32x16_bf16 v[16:31], v[96:99], v[100:103], v[16:31]
    ds_read_b64 v[88:89], v3 offset:1856
    ds_read_b64 v[90:91], v3 offset:1864
    ds_read_b128 v[92:95], v5 offset:2320
    s_waitcnt lgkmcnt(9)
    v_mfma_f32_32x32x16_bf16 v[16:31], v[64:67], v[68:71], v[16:31]
    ds_read_b64 v[96:97], v3 offset:1888
    ds_read_b64 v[98:99], v3 offset:1896
    ds_read_b128 v[100:103], v5 offset:2352
    s_waitcnt lgkmcnt(9)
    v_mfma_f32_32x32x16_bf16 v[16:31], v[72:75], v[76:79], v[16:31]
    ds_read_b64 v[64:65], v3 offset:1920
    ds_read_b64 v[66:67], v3 offset:1928
    ds_read_b128 v[68:71], v5 offset:2400
    s_waitcnt lgkmcnt(9)
    v_mfma_f32_32x32x16_bf16 v[16:31], v[80:83], v[84:87], v[16:31]
    ds_read_b64 v[72:73], v3 offset:1952
    ds_read_b64 v[74:75], v3 offset:1960
    ds_read_b128 v[76:79], v5 offset:2432
    s_waitcnt lgkmcnt(9)
    v_mfma_f32_32x32x16_bf16 v[16:31], v[88:91], v[92:95], v[16:31]
    ds_read_b64 v[80:81], v3 offset:1984
    ds_read_b64 v[82:83], v3 offset:1992
    ds_read_b128 v[84:87], v5 offset:2480
    s_waitcnt lgkmcnt(9)
    v_mfma_f32_32x32x16_bf16 v[16:31], v[96:99], v[100:103], v[16:31]
    ds_read_b64 v[88:89], v3 offset:2016
    ds_read_b64 v[90:91], v3 offset:2024
    ds_read_b128 v[92:95], v5 offset:2512
    s_waitcnt lgkmcnt(9)
    v_mfma_f32_32x32x16_bf16 v[16:31], v[64:67], v[68:71], v[16:31]
    ds_read_b64 v[96:97], v3 offset:2048
    ds_read_b64 v[98:99], v3 offset:2056
    ds_read_b128 v[100:103], v5 offset:2560
    s_waitcnt lgkmcnt(9)
    v_mfma_f32_32x32x16_bf16 v[16:31], v[72:75], v[76:79], v[16:31]
    ds_read_b64 v[64:65], v3 offset:2080
    ds_read_b64 v[66:67], v3 offset:2088
    ds_read_b128 v[68:71], v5 offset:2592
    s_waitcnt lgkmcnt(9)
    v_mfma_f32_32x32x16_bf16 v[16:31], v[80:83], v[84:87], v[16:31]
    ds_read_b64 v[72:73], v3 offset:2112
    ds_read_b64 v[74:75], v3 offset:2120
    ds_read_b128 v[76:79], v5 offset:2640
    s_waitcnt lgkmcnt(9)
    v_mfma_f32_32x32x16_bf16 v[16:31], v[88:91], v[92:95], v[16:31]
    ds_read_b64 v[80:81], v3 offset:2144
    ds_read_b64 v[82:83], v3 offset:2152
    ds_read_b128 v[84:87], v5 offset:2672
    s_waitcnt lgkmcnt(9)
    v_mfma_f32_32x32x16_bf16 v[16:31], v[96:99], v[100:103], v[16:31]
    ds_read_b64 v[88:89], v3 offset:2176
    ds_read_b64 v[90:91], v3 offset:2184
    ds_read_b128 v[92:95], v5 offset:2720
    s_waitcnt lgkmcnt(9)
    v_mfma_f32_32x32x16_bf16 v[16:31], v[64:67], v[68:71], v[16:31]
    ds_read_b64 v[96:97], v3 offset:2208
    ds_read_b64 v[98:99], v3 offset:2216
    ds_read_b128 v[100:103], v5 offset:2752
    s_waitcnt lgkmcnt(9)
    v_mfma_f32_32x32x16_bf16 v[16:31], v[72:75], v[76:79], v[16:31]
    ds_read_b64 v[64:65], v3 offset:2240
    ds_read_b64 v[66:67], v3 offset:2248
    ds_read_b128 v[68:71], v5 offset:2800
    s_waitcnt lgkmcnt(9)
    v_mfma_f32_32x32x16_bf16 v[16:31], v[80:83], v[84:87], v[16:31]
    ds_read_b64 v[72:73], v3 offset:2272
    ds_read_b64 v[74:75], v3 offset:2280
    ds_read_b128 v[76:79], v5 offset:2832
    s_waitcnt lgkmcnt(9)
    v_mfma_f32_32x32x16_bf16 v[16:31], v[88:91], v[92:95], v[16:31]
    ds_read_b64 v[80:81], v3 offset:2304
    ds_read_b64 v[82:83], v3 offset:2312
    ds_read_b128 v[84:87], v5 offset:2880
    s_waitcnt lgkmcnt(9)
    v_mfma_f32_32x32x16_bf16 v[16:31], v[96:99], v[100:103], v[16:31]
    ds_read_b64 v[88:89], v3 offset:2336
    ds_read_b64 v[90:91], v3 offset:2344
    ds_read_b128 v[92:95], v5 offset:2912
    s_waitcnt lgkmcnt(9)
    v_mfma_f32_32x32x16_bf16 v[16:31], v[64:67], v[68:71], v[16:31]
    ds_read_b64 v[96:97], v3 offset:2368
    ds_read_b64 v[98:99], v3 offset:2376
    ds_read_b128 v[100:103], v5 offset:2960
    s_waitcnt lgkmcnt(9)
    v_mfma_f32_32x32x16_bf16 v[16:31], v[72:75], v[76:79], v[16:31]
    ds_read_b64 v[64:65], v3 offset:2400
    ds_read_b64 v[66:67], v3 offset:2408
    ds_read_b128 v[68:71], v5 offset:2992
    s_waitcnt lgkmcnt(9)
    v_mfma_f32_32x32x16_bf16 v[16:31], v[80:83], v[84:87], v[16:31]
    ds_read_b64 v[72:73], v3 offset:2432
    ds_read_b64 v[74:75], v3 offset:2440
    ds_read_b128 v[76:79], v5 offset:3040
    s_waitcnt lgkmcnt(9)
    v_mfma_f32_32x32x16_bf16 v[16:31], v[88:91], v[92:95], v[16:31]
    ds_read_b64 v[80:81], v3 offset:2464
    ds_read_b64 v[82:83], v3 offset:2472
    ds_read_b128 v[84:87], v5 offset:3072
    s_waitcnt lgkmcnt(9)
    v_mfma_f32_32x32x16_bf16 v[16:31], v[96:99], v[100:103], v[16:31]
    ds_read_b64 v[88:89], v3 offset:2496
    ds_read_b64 v[90:91], v3 offset:2504
    ds_read_b128 v[92:95], v5 offset:3120
    s_waitcnt lgkmcnt(9)
    v_mfma_f32_32x32x16_bf16 v[16:31], v[64:67], v[68:71], v[16:31]
    ds_read_b64 v[96:97], v3 offset:2528
    ds_read_b64 v[98:99], v3 offset:2536
    ds_read_b128 v[100:103], v5 offset:3152
    s_waitcnt lgkmcnt(9)
    v_mfma_f32_32x32x16_bf16 v[16:31], v[72:75], v[76:79], v[16:31]
    ds_read_b64 v[64:65], v3 offset:2560
    ds_read_b64 v[66:67], v3 offset:2568
    ds_read_b128 v[68:71], v5 offset:3200
    s_waitcnt lgkmcnt(9)
    v_mfma_f32_32x32x16_bf16 v[16:31], v[80:83], v[84:87], v[16:31]
    ds_read_b64 v[72:73], v3 offset:2592
    ds_read_b64 v[74:75], v3 offset:2600
    ds_read_b128 v[76:79], v5 offset:3232
    s_waitcnt lgkmcnt(9)
    v_mfma_f32_32x32x16_bf16 v[16:31], v[88:91], v[92:95], v[16:31]
    ds_read_b64 v[80:81], v3 offset:2624
    ds_read_b64 v[82:83], v3 offset:2632
    ds_read_b128 v[84:87], v5 offset:3280
    s_waitcnt lgkmcnt(9)
    v_mfma_f32_32x32x16_bf16 v[16:31], v[96:99], v[100:103], v[16:31]
    ds_read_b64 v[88:89], v3 offset:2656
    ds_read_b64 v[90:91], v3 offset:2664
    ds_read_b128 v[92:95], v5 offset:3312
    s_waitcnt lgkmcnt(9)
    v_mfma_f32_32x32x16_bf16 v[16:31], v[64:67], v[68:71], v[16:31]
    ds_read_b64 v[96:97], v3 offset:2688
    ds_read_b64 v[98:99], v3 offset:2696
    ds_read_b128 v[100:103], v5 offset:3360
    s_waitcnt lgkmcnt(9)
    v_mfma_f32_32x32x16_bf16 v[16:31], v[72:75], v[76:79], v[16:31]
    ds_read_b64 v[64:65], v3 offset:2720
    ds_read_b64 v[66:67], v3 offset:2728
    ds_read_b128 v[68:71], v5 offset:3392
    s_waitcnt lgkmcnt(9)
    v_mfma_f32_32x32x16_bf16 v[16:31], v[80:83], v[84:87], v[16:31]
    ds_read_b64 v[72:73], v3 offset:2752
    ds_read_b64 v[74:75], v3 offset:2760
    ds_read_b128 v[76:79], v5 offset:3440
    s_waitcnt lgkmcnt(9)
    v_mfma_f32_32x32x16_bf16 v[16:31], v[88:91], v[92:95], v[16:31]
    ds_read_b64 v[80:81], v3 offset:2784
    ds_read_b64 v[82:83], v3 offset:2792
    ds_read_b128 v[84:87], v5 offset:3472
    s_waitcnt lgkmcnt(9)
    v_mfma_f32_32x32x16_bf16 v[16:31], v[96:99], v[100:103], v[16:31]
    ds_read_b64 v[88:89], v3 offset:2816
    ds_read_b64 v[90:91], v3 offset:2824
    ds_read_b128 v[92:95], v5 offset:3520
    s_waitcnt lgkmcnt(9)
    v_mfma_f32_32x32x16_bf16 v[16:31], v[64:67], v[68:71], v[16:31]
    ds_read_b64 v[96:97], v3 offset:2848
    ds_read_b64 v[98:99], v3 offset:2856
    ds_read_b128 v[100:103], v5 offset:3552
    s_waitcnt lgkmcnt(9)
    v_mfma_f32_32x32x16_bf16 v[16:31], v[72:75], v[76:79], v[16:31]
    ds_read_b64 v[64:65], v3 offset:2880
    ds_read_b64 v[66:67], v3 offset:2888
    ds_read_b128 v[68:71], v5 offset:3600
    s_waitcnt lgkmcnt(9)
    v_mfma_f32_32x32x16_bf16 v[16:31], v[80:83], v[84:87], v[16:31]
    ds_read_b64 v[72:73], v3 offset:2912
    ds_read_b64 v[74:75], v3 offset:2920
    ds_read_b128 v[76:79], v5 offset:3632
    s_waitcnt lgkmcnt(9)
    v_mfma_f32_32x32x16_bf16 v[16:31], v[88:91], v[92:95], v[16:31]
    ds_read_b64 v[80:81], v3 offset:2944
    ds_read_b64 v[82:83], v3 offset:2952
    ds_read_b128 v[84:87], v5 offset:3680
    s_waitcnt lgkmcnt(9)
    v_mfma_f32_32x32x16_bf16 v[16:31], v[96:99], v[100:103], v[16:31]
    ds_read_b64 v[88:89], v3 offset:2976
    ds_read_b64 v[90:91], v3 offset:2984
    ds_read_b128 v[92:95], v5 offset:3712
    s_waitcnt lgkmcnt(9)
    v_mfma_f32_32x32x16_bf16 v[16:31], v[64:67], v[68:71], v[16:31]
    ds_read_b64 v[96:97], v3 offset:3008
    ds_read_b64 v[98:99], v3 offset:3016
    ds_read_b128 v[100:103], v5 offset:3760
    s_waitcnt lgkmcnt(9)
    v_mfma_f32_32x32x16_bf16 v[16:31], v[72:75], v[76:79], v[16:31]
    ds_read_b64 v[64:65], v3 offset:3040
    ds_read_b64 v[66:67], v3 offset:3048
    ds_read_b128 v[68:71], v5 offset:3792
    s_waitcnt lgkmcnt(9)
    v_mfma_f32_32x32x16_bf16 v[16:31], v[80:83], v[84:87], v[16:31]
    ds_read_b64 v[72:73], v3 offset:3072
    ds_read_b64 v[74:75], v3 offset:3080
    ds_read_b128 v[76:79], v5 offset:3840
    s_waitcnt lgkmcnt(9)
    v_mfma_f32_32x32x16_bf16 v[16:31], v[88:91], v[92:95], v[16:31]
    ds_read_b64 v[80:81], v3 offset:3104
    ds_read_b64 v[82:83], v3 offset:3112
    ds_read_b128 v[84:87], v5 offset:3872
    s_waitcnt lgkmcnt(9)
    v_mfma_f32_32x32x16_bf16 v[16:31], v[96:99], v[100:103], v[16:31]
    ds_read_b64 v[88:89], v3 offset:3136
    ds_read_b64 v[90:91], v3 offset:3144
    ds_read_b128 v[92:95], v5 offset:3920
    s_waitcnt lgkmcnt(9)
    v_mfma_f32_32x32x16_bf16 v[16:31], v[64:67], v[68:71], v[16:31]
    ds_read_b64 v[96:97], v3 offset:3168
    ds_read_b64 v[98:99], v3 offset:3176
    ds_read_b128 v[100:103], v5 offset:3952
    s_waitcnt lgkmcnt(9)
    v_mfma_f32_32x32x16_bf16 v[16:31], v[72:75], v[76:79], v[16:31]
    ds_read_b64 v[64:65], v3 offset:3200
    ds_read_b64 v[66:67], v3 offset:3208
    ds_read_b128 v[68:71], v5 offset:4000
    s_waitcnt lgkmcnt(9)
    v_mfma_f32_32x32x16_bf16 v[16:31], v[80:83], v[84:87], v[16:31]
    ds_read_b64 v[72:73], v3 offset:3232
    ds_read_b64 v[74:75], v3 offset:3240
    ds_read_b128 v[76:79], v5 offset:4032
    s_waitcnt lgkmcnt(9)
    v_mfma_f32_32x32x16_bf16 v[16:31], v[88:91], v[92:95], v[16:31]
    ds_read_b64 v[80:81], v3 offset:3264
    ds_read_b64 v[82:83], v3 offset:3272
    ds_read_b128 v[84:87], v5 offset:4080
    s_waitcnt lgkmcnt(9)
    v_mfma_f32_32x32x16_bf16 v[16:31], v[96:99], v[100:103], v[16:31]
    ds_read_b64 v[88:89], v3 offset:3296
    ds_read_b64 v[90:91], v3 offset:3304
    ds_read_b128 v[92:95], v5 offset:4112
    s_waitcnt lgkmcnt(9)
    v_mfma_f32_32x32x16_bf16 v[16:31], v[64:67], v[68:71], v[16:31]
    ds_read_b64 v[96:97], v3 offset:3328
    ds_read_b64 v[98:99], v3 offset:3336
    ds_read_b128 v[100:103], v5 offset:4160
    s_waitcnt lgkmcnt(9)
    v_mfma_f32_32x32x16_bf16 v[16:31], v[72:75], v[76:79], v[16:31]
    ds_read_b64 v[64:65], v3 offset:3360
    ds_read_b64 v[66:67], v3 offset:3368
    ds_read_b128 v[68:71], v5 offset:4192
    s_waitcnt lgkmcnt(9)
    v_mfma_f32_32x32x16_bf16 v[16:31], v[80:83], v[84:87], v[16:31]
    ds_read_b64 v[72:73], v3 offset:3392
    ds_read_b64 v[74:75], v3 offset:3400
    ds_read_b128 v[76:79], v5 offset:4240
    s_waitcnt lgkmcnt(9)
    v_mfma_f32_32x32x16_bf16 v[16:31], v[88:91], v[92:95], v[16:31]
    ds_read_b64 v[80:81], v3 offset:3424
    ds_read_b64 v[82:83], v3 offset:3432
    ds_read_b128 v[84:87], v5 offset:4272
    s_waitcnt lgkmcnt(9)
    v_mfma_f32_32x32x16_bf16 v[16:31], v[96:99], v[100:103], v[16:31]
    ds_read_b64 v[88:89], v3 offset:3456
    ds_read_b64 v[90:91], v3 offset:3464
    ds_read_b128 v[92:95], v5 offset:4320
    s_waitcnt lgkmcnt(9)
    v_mfma_f32_32x32x16_bf16 v[16:31], v[64:67], v[68:71], v[16:31]
    ds_read_b64 v[96:97], v3 offset:3488
    ds_read_b64 v[98:99], v3 offset:3496
    ds_read_b128 v[100:103], v5 offset:4352
    s_waitcnt lgkmcnt(9)
    v_mfma_f32_32x32x16_bf16 v[16:31], v[72:75], v[76:79], v[16:31]
    ds_read_b64 v[64:65], v3 offset:3520
    ds_read_b64 v[66:67], v3 offset:3528
    ds_read_b128 v[68:71], v5 offset:4400
    s_waitcnt lgkmcnt(9)
    v_mfma_f32_32x32x16_bf16 v[16:31], v[80:83], v[84:87], v[16:31]
    ds_read_b64 v[72:73], v3 offset:3552
    ds_read_b64 v[74:75], v3 offset:3560
    ds_read_b128 v[76:79], v5 offset:4432
    s_waitcnt lgkmcnt(9)
    v_mfma_f32_32x32x16_bf16 v[16:31], v[88:91], v[92:95], v[16:31]
    ds_read_b64 v[80:81], v3 offset:3584
    ds_read_b64 v[82:83], v3 offset:3592
    ds_read_b128 v[84:87], v5 offset:4480
    s_waitcnt lgkmcnt(9)
    v_mfma_f32_32x32x16_bf16 v[16:31], v[96:99], v[100:103], v[16:31]
    ds_read_b64 v[88:89], v3 offset:3616
    ds_read_b64 v[90:91], v3 offset:3624
    ds_read_b128 v[92:95], v5 offset:4512
    s_waitcnt lgkmcnt(9)
    v_mfma_f32_32x32x16_bf16 v[16:31], v[64:67], v[68:71], v[16:31]
    ds_read_b64 v[96:97], v3 offset:3648
    ds_read_b64 v[98:99], v3 offset:3656
    ds_read_b128 v[100:103], v5 offset:4560
    s_waitcnt lgkmcnt(9)
    v_mfma_f32_32x32x16_bf16 v[16:31], v[72:75], v[76:79], v[16:31]
    ds_read_b64 v[64:65], v3 offset:3680
    ds_read_b64 v[66:67], v3 offset:3688
    ds_read_b128 v[68:71], v5 offset:4592
    s_waitcnt lgkmcnt(9)
    v_mfma_f32_32x32x16_bf16 v[16:31], v[80:83], v[84:87], v[16:31]
    ds_read_b64 v[72:73], v3 offset:3712
    ds_read_b64 v[74:75], v3 offset:3720
    ds_read_b128 v[76:79], v5 offset:4640
    s_waitcnt lgkmcnt(9)
    v_mfma_f32_32x32x16_bf16 v[16:31], v[88:91], v[92:95], v[16:31]
    ds_read_b64 v[80:81], v3 offset:3744
    ds_read_b64 v[82:83], v3 offset:3752
    ds_read_b128 v[84:87], v5 offset:4672
    s_waitcnt lgkmcnt(9)
    v_mfma_f32_32x32x16_bf16 v[16:31], v[96:99], v[100:103], v[16:31]
    ds_read_b64 v[88:89], v3 offset:3776
    ds_read_b64 v[90:91], v3 offset:3784
    ds_read_b128 v[92:95], v5 offset:4720
    s_waitcnt lgkmcnt(9)
    v_mfma_f32_32x32x16_bf16 v[16:31], v[64:67], v[68:71], v[16:31]
    ds_read_b64 v[96:97], v3 offset:3808
    ds_read_b64 v[98:99], v3 offset:3816
    ds_read_b128 v[100:103], v5 offset:4752
    s_waitcnt lgkmcnt(9)
    v_mfma_f32_32x32x16_bf16 v[16:31], v[72:75], v[76:79], v[16:31]
    ds_read_b64 v[64:65], v3 offset:3840
    ds_read_b64 v[66:67], v3 offset:3848
    ds_read_b128 v[68:71], v5 offset:4800
    s_waitcnt lgkmcnt(9)
    v_mfma_f32_32x32x16_bf16 v[16:31], v[80:83], v[84:87], v[16:31]
    ds_read_b64 v[72:73], v3 offset:3872
    ds_read_b64 v[74:75], v3 offset:3880
    ds_read_b128 v[76:79], v5 offset:4832
    s_waitcnt lgkmcnt(9)
    v_mfma_f32_32x32x16_bf16 v[16:31], v[88:91], v[92:95], v[16:31]
    ds_read_b64 v[80:81], v3 offset:3904
    ds_read_b64 v[82:83], v3 offset:3912
    ds_read_b128 v[84:87], v5 offset:4880
    s_waitcnt lgkmcnt(9)
    v_mfma_f32_32x32x16_bf16 v[16:31], v[96:99], v[100:103], v[16:31]
    ds_read_b64 v[88:89], v3 offset:3936
    ds_read_b64 v[90:91], v3 offset:3944
    ds_read_b128 v[92:95], v5 offset:4912
    s_waitcnt lgkmcnt(9)
    v_mfma_f32_32x32x16_bf16 v[16:31], v[64:67], v[68:71], v[16:31]
    ds_read_b64 v[96:97], v3 offset:3968
    ds_read_b64 v[98:99], v3 offset:3976
    ds_read_b128 v[100:103], v5 offset:4960
    s_waitcnt lgkmcnt(9)
    v_mfma_f32_32x32x16_bf16 v[16:31], v[72:75], v[76:79], v[16:31]
    ds_read_b64 v[64:65], v3 offset:4000
    ds_read_b64 v[66:67], v3 offset:4008
    ds_read_b128 v[68:71], v5 offset:4992
    s_waitcnt lgkmcnt(9)
    v_mfma_f32_32x32x16_bf16 v[16:31], v[80:83], v[84:87], v[16:31]
    ds_read_b64 v[72:73], v3 offset:4032
    ds_read_b64 v[74:75], v3 offset:4040
    ds_read_b128 v[76:79], v5 offset:5040
    s_waitcnt lgkmcnt(9)
    v_mfma_f32_32x32x16_bf16 v[16:31], v[88:91], v[92:95], v[16:31]
    ds_read_b64 v[80:81], v3 offset:4064
    ds_read_b64 v[82:83], v3 offset:4072
    ds_read_b128 v[84:87], v5 offset:5072
    s_waitcnt lgkmcnt(9)
    v_mfma_f32_32x32x16_bf16 v[16:31], v[96:99], v[100:103], v[16:31]
    s_waitcnt lgkmcnt(6)
    v_mfma_f32_32x32x16_bf16 v[16:31], v[64:67], v[68:71], v[16:31]
    s_waitcnt lgkmcnt(3)
    v_mfma_f32_32x32x16_bf16 v[16:31], v[72:75], v[76:79], v[16:31]
    s_waitcnt lgkmcnt(0)
    v_mfma_f32_32x32x16_bf16 v[16:31], v[80:83], v[84:87], v[16:31]
    v_sub_u32 v6, 1, v2
    v_lshl_add_u32 v6, v6, 3, v4
    v_add_u32 v6, s71, v6
    ds_read_b64 v[112:113], v6 offset:48
    ds_read_b64 v[114:115], v6 offset:32
    ds_read_b64 v[116:117], v6 offset:16
    ds_read_b64 v[118:119], v6 offset:0
    v_mul_u32_u24 v7, 272, v1
    v_lshl_add_u32 v7, v2, 3, v7
    s_lshl_b32 s68, s3, 5
    s_add_u32 s68, s68, 138240
    v_add_u32 v7, s68, v7
    v_lshrrev_b32 v12, 4, v0
    v_and_b32 v13, 15, v0
    v_mul_u32_u24 v14, 272, v12
    v_lshl_add_u32 v14, v13, 4, v14
    s_mul_i32 s68, s3, 2176
    s_add_u32 s68, s68, 138240
    v_add_u32 v14, s68, v14
    v_lshrrev_b32 v12, 3, v0
    v_mul_u32_u24 v15, 18432, v12
    v_and_b32 v13, 7, v0
    v_lshl_add_u32 v15, v13, 4, v15
    s_mul_i32 s68, s3, 294912
    s_lshl_b32 s69, s62, 7
    s_add_u32 s68, s68, s69
    s_add_u32 s68, s68, 2228224
    s_waitcnt lgkmcnt(0)
    v_and_b32 v8, 0xffff0000, v113
    v_lshlrev_b32 v9, 16, v113
    v_and_b32 v10, 0xffff0000, v112
    v_lshlrev_b32 v11, 16, v112
    v_fmac_f32 v16, s96, v8
    v_fmac_f32 v17, s96, v9
    v_fmac_f32 v18, s96, v10
    v_fmac_f32 v19, s96, v11
    v_cvt_pk_bf16_f32 v128, v16, v17
    v_cvt_pk_bf16_f32 v129, v18, v19
    ds_write_b64 v7, v[128:129] offset:0
    v_and_b32 v8, 0xffff0000, v115
    v_lshlrev_b32 v9, 16, v115
    v_and_b32 v10, 0xffff0000, v114
    v_lshlrev_b32 v11, 16, v114
    v_fmac_f32 v20, s96, v8
    v_fmac_f32 v21, s96, v9
    v_fmac_f32 v22, s96, v10
    v_fmac_f32 v23, s96, v11
    v_cvt_pk_bf16_f32 v130, v20, v21
    v_cvt_pk_bf16_f32 v131, v22, v23
    ds_write_b64 v7, v[130:131] offset:16
    v_and_b32 v8, 0xffff0000, v117
    v_lshlrev_b32 v9, 16, v117
    v_and_b32 v10, 0xffff0000, v116
    v_lshlrev_b32 v11, 16, v116
    v_fmac_f32 v24, s96, v8
    v_fmac_f32 v25, s96, v9
    v_fmac_f32 v26, s96, v10
    v_fmac_f32 v27, s96, v11
    v_cvt_pk_bf16_f32 v132, v24, v25
    v_cvt_pk_bf16_f32 v133, v26, v27
    ds_write_b64 v7, v[132:133] offset:128
    v_and_b32 v8, 0xffff0000, v119
    v_lshlrev_b32 v9, 16, v119
    v_and_b32 v10, 0xffff0000, v118
    v_lshlrev_b32 v11, 16, v118
    v_fmac_f32 v28, s96, v8
    v_fmac_f32 v29, s96, v9
    v_fmac_f32 v30, s96, v10
    v_fmac_f32 v31, s96, v11
    v_cvt_pk_bf16_f32 v134, v28, v29
    v_cvt_pk_bf16_f32 v135, v30, v31
    ds_write_b64 v7, v[134:135] offset:144
    s_waitcnt lgkmcnt(0)
    s_barrier
    ds_read_b128 v[16:19], v14 offset:0
    ds_read_b128 v[20:23], v14 offset:1088
    s_waitcnt lgkmcnt(1)
    buffer_store_dwordx4 v[16:19], v15, s[8:11], s68 offen sc1
    s_add_u32 s68, s68, 147456
    s_waitcnt lgkmcnt(0)
    buffer_store_dwordx4 v[20:23], v15, s[8:11], s68 offen sc1
    s_waitcnt vmcnt(0)
    s_barrier
    s_cmp_lg_u32 s3, 0
    s_cbranch_scc1 L_cf_18
    v_mov_b32 v1, 32800
    v_mov_b32 v2, 1
    s_mov_b64 exec, 1
    buffer_store_dword v2, v1, s[8:11], s69 offen sc1
    s_mov_b64 exec, -1
L_cf_18:
    s_branch L_stageb
L_prodone:
L_main:
    s_cmp_eq_u32 s4, 0
    s_cbranch_scc1 L_chain
    s_cmp_eq_u32 s4, 1
    s_cbranch_scc1 L_kv
    s_cmp_eq_u32 s4, 2
    s_cbranch_scc1 L_qo
    s_cmp_eq_u32 s4, 3
    s_cbranch_scc1 L_qo
    s_cmp_eq_u32 s4, 4
    s_cbranch_scc1 L_chain
    s_cmp_eq_u32 s4, 5
    s_cbranch_scc1 L_kv
    s_cmp_eq_u32 s4, 6
    s_cbranch_scc1 L_qo
    s_cmp_eq_u32 s4, 7
    s_cbranch_scc1 L_qo
    s_cmp_ge_u32 s4, 3
    s_cbranch_scc1 L_19
    s_sleep 127
    s_sleep 127
    s_mov_b32 s60, 1048576
    v_and_b32 v14, 7, v0
    v_lshlrev_b32 v14, 5, v14
    s_lshl_b32 s63, s7, 3
    s_cmp_lg_u32 s3, 0
    s_cbranch_scc1 L_cenw_22
L_cen_20:
    buffer_load_dwordx2 v[12:13], v14, s[12:15], s63 offen sc1
    s_waitcnt vmcnt(0)
    v_lshrrev_b32 v13, 8, v13
    s_nop 1
    v_add_u32_dpp v13, v13, v13 quad_perm:[1,0,3,2] row_mask:0xf bank_mask:0xf
    s_nop 1
    v_add_u32_dpp v13, v13, v13 quad_perm:[2,3,0,1] row_mask:0xf bank_mask:0xf
    s_nop 1
    v_add_u32_dpp v13, v13, v13 row_half_mirror row_mask:0xf bank_mask:0xf
    s_nop 0
    v_readfirstlane_b32 s64, v13
    s_nop 0
    s_cmp_ge_u32 s64, 256
    s_cbranch_scc1 L_cenw_22
    s_sleep 8
    s_sub_u32 s60, s60, 1
    s_cbranch_scc1 L_abort
    s_branch L_cen_20
L_cenw_22:
    s_barrier
    buffer_load_dwordx2 v[12:13], v14, s[12:15], s63 offen sc1
    s_waitcnt vmcnt(0)
    v_not_b32 v12, v12
    v_xor_b32 v13, 0x2000, v13
    v_or_b32 v12, v12, v13
    v_cmp_ne_u32 vcc, 0, v12
    s_cbranch_vccz L_cend_21
    v_lshrrev_b32 v13, 8, v13
    v_cmp_ne_u32 vcc, 0, v13
    s_branch L_renumber
L_cend_21:
L_19:
    s_endpgm
L_kv:
    s_lshr_b32 s66, s4, 2
    s_mul_i32 s71, s3, 40960
    v_lshlrev_b32 v4, 4, v0
    v_lshrrev_b32 v8, 3, v0
    v_mul_u32_u24 v1, 1152, v8
    v_lshrrev_b32 v8, 4, v0
    s_lshl_b32 s63, s3, 2
    v_add_u32 v9, s63, v8
    v_xor_b32 v9, v9, v0
    v_and_b32 v9, 7, v9
    v_lshl_add_u32 v1, v9, 4, v1
    v_bfe_u32 v9, v0, 3, 1
    v_mul_u32_u24 v2, 9216, v9
    v_and_b32 v9, 7, v0
    v_lshl_add_u32 v2, v9, 7, v2
    s_cmp_eq_u32 s66, 0
    s_cselect_b32 s63, 2, 8
    v_lshlrev_b32 v5, s63, v9
    s_cselect_b32 s94, 7, 2
    s_cselect_b32 s63, 5, 11
    s_lshl_b32 s95, s3, s63
    s_lshl_b32 s63, s66, 13
    s_add_u32 s95, s95, s63
    s_add_u32 s95, s95, 16384
    v_bfe_u32 v9, v0, 1, 3
    v_xor_b32 v9, v9, v8
    v_lshl_add_u32 v2, v9, 4, v2
    v_xor_b32 v3, 64, v2
    s_mov_b32 s48, s34
    s_mov_b32 s49, s35
    s_mov_b32 s50, 4718592
    s_mov_b32 s51, 0x20000
    s_mov_b32 s52, s36
    s_mov_b32 s53, s37
    s_mov_b32 s54, 4718592
    s_mov_b32 s55, 0x20000
    v_lshrrev_b32 v11, 3, v0
    v_and_b32 v13, 7, v0
    v_lshlrev_b32 v10, 13, v11
    v_lshl_add_u32 v10, v13, 4, v10
    v_mul_u32_u24 v11, 1152, v11
    v_lshl_add_u32 v11, v13, 4, v11
    v_lshrrev_b32 v12, 1, v0
    v_mul_u32_u24 v12, 1152, v12
    v_and_b32 v13, 1, v0
    v_lshl_add_u32 v12, v13, 4, v12
    v_lshrrev_b32 v13, 4, v0
    v_bfe_u32 v14, v0, 2, 2
    v_and_b32 v15, 3, v0
    v_lshl_add_u32 v16, v13, 3, v14
    v_lshlrev_b32 v16, 7, v16
    v_lshl_add_u32 v16, v15, 3, v16
    s_and_b32 s63, s3, 2
    s_mul_i32 s63, s63, 40960
    s_and_b32 s64, s3, 1
    s_lshl_b32 s65, s64, 6
    s_add_u32 s63, s63, s65
    s_add_u32 s63, s63, 0
    v_add_u32 v16, s63, v16
    v_add_u32 v17, 40960, v16
    s_lshl_b32 s72, s5, 8
    s_lshr_b32 s63, s3, 1
    s_lshl_b32 s63, s63, 7
    s_add_u32 s72, s72, s63
    s_lshl_b32 s63, s64, 18
    s_add_u32 s73, s72, s63
    s_lshl_b32 s63, s64, 19
    s_add_u32 s72, s72, s63
    s_barrier
    s_add_u32 m0, s71, 0
    s_add_u32 s63, s72, 0
    buffer_load_dwordx4 v10, s[48:51], s63 offen  lds
    s_add_u32 m0, s71, 1024
    s_add_u32 s63, s72, 65536
    buffer_load_dwordx4 v10, s[48:51], s63 offen  lds
    s_add_u32 m0, s71, 2048
    s_add_u32 s63, s72, 131072
    buffer_load_dwordx4 v10, s[48:51], s63 offen  lds
    s_add_u32 m0, s71, 3072
    s_add_u32 s63, s72, 196608
    buffer_load_dwordx4 v10, s[48:51], s63 offen  lds
    s_add_u32 m0, s71, 4096
    s_add_u32 s63, s72, 262144
    buffer_load_dwordx4 v10, s[48:51], s63 offen  lds
    s_add_u32 m0, s71, 5120
    s_add_u32 s63, s72, 327680
    buffer_load_dwordx4 v10, s[48:51], s63 offen  lds
    s_add_u32 m0, s71, 6144
    s_add_u32 s63, s72, 393216
    buffer_load_dwordx4 v10, s[48:51], s63 offen  lds
    s_add_u32 m0, s71, 7168
    s_add_u32 s63, s72, 458752
    buffer_load_dwordx4 v10, s[48:51], s63 offen  lds
    s_add_u32 m0, s71, 8192
    s_add_u32 s63, s72, 1048576
    buffer_load_dwordx4 v10, s[48:51], s63 offen  lds
    s_add_u32 m0, s71, 9216
    s_add_u32 s63, s72, 1114112
    buffer_load_dwordx4 v10, s[48:51], s63 offen  lds
    s_add_u32 m0, s71, 10240
    s_add_u32 s63, s72, 1179648
    buffer_load_dwordx4 v10, s[48:51], s63 offen  lds
    s_add_u32 m0, s71, 11264
    s_add_u32 s63, s72, 1245184
    buffer_load_dwordx4 v10, s[48:51], s63 offen  lds
    s_add_u32 m0, s71, 12288
    s_add_u32 s63, s72, 1310720
    buffer_load_dwordx4 v10, s[48:51], s63 offen  lds
    s_add_u32 m0, s71, 13312
    s_add_u32 s63, s72, 1376256
    buffer_load_dwordx4 v10, s[48:51], s63 offen  lds
    s_add_u32 m0, s71, 14336
    s_add_u32 s63, s72, 1441792
    buffer_load_dwordx4 v10, s[48:51], s63 offen  lds
    s_add_u32 m0, s71, 15360
    s_add_u32 s63, s72, 1507328
    buffer_load_dwordx4 v10, s[48:51], s63 offen  lds
    s_add_u32 m0, s71, 16384
    s_add_u32 s63, s72, 2097152
    buffer_load_dwordx4 v10, s[48:51], s63 offen  lds
    s_add_u32 m0, s71, 17408
    s_add_u32 s63, s72, 2162688
    buffer_load_dwordx4 v10, s[48:51], s63 offen  lds
    s_add_u32 m0, s71, 18432
    s_add_u32 s63, s72, 2228224
    buffer_load_dwordx4 v10, s[48:51], s63 offen  lds
    s_add_u32 m0, s71, 19456
    s_add_u32 s63, s72, 2293760
    buffer_load_dwordx4 v10, s[48:51], s63 offen  lds
    s_add_u32 m0, s71, 20480
    s_add_u32 s63, s72, 2359296
    buffer_load_dwordx4 v10, s[48:51], s63 offen  lds
    s_add_u32 m0, s71, 21504
    s_add_u32 s63, s72, 2424832
    buffer_load_dwordx4 v10, s[48:51], s63 offen  lds
    s_add_u32 m0, s71, 22528
    s_add_u32 s63, s72, 2490368
    buffer_load_dwordx4 v10, s[48:51], s63 offen  lds
    s_add_u32 m0, s71, 23552
    s_add_u32 s63, s72, 2555904
    buffer_load_dwordx4 v10, s[48:51], s63 offen  lds
    s_waitcnt vmcnt(16)
    s_barrier
    ds_read_b64_tr_b16 a[0:1], v16 offset:0
    ds_read_b64_tr_b16 a[2:3], v16 offset:512
    ds_read_b64_tr_b16 a[4:5], v16 offset:32
    ds_read_b64_tr_b16 a[6:7], v16 offset:544
    ds_read_b64_tr_b16 a[8:9], v16 offset:4096
    ds_read_b64_tr_b16 a[10:11], v16 offset:4608
    ds_read_b64_tr_b16 a[12:13], v16 offset:4128
    ds_read_b64_tr_b16 a[14:15], v16 offset:4640
    ds_read_b64_tr_b16 a[16:17], v17 offset:0
    ds_read_b64_tr_b16 a[18:19], v17 offset:512
    ds_read_b64_tr_b16 a[20:21], v17 offset:32
    ds_read_b64_tr_b16 a[22:23], v17 offset:544
    s_waitcnt lgkmcnt(4)
    ds_read_b64_tr_b16 a[24:25], v17 offset:4096
    ds_read_b64_tr_b16 a[26:27], v17 offset:4608
    ds_read_b64_tr_b16 a[28:29], v17 offset:4128
    ds_read_b64_tr_b16 a[30:31], v17 offset:4640
    s_add_u32 m0, s71, 24576
    s_add_u32 s63, s72, 3145728
    buffer_load_dwordx4 v10, s[48:51], s63 offen  lds
    s_add_u32 m0, s71, 25600
    s_add_u32 s63, s72, 3211264
    buffer_load_dwordx4 v10, s[48:51], s63 offen  lds
    s_add_u32 m0, s71, 26624
    s_add_u32 s63, s72, 3276800
    buffer_load_dwordx4 v10, s[48:51], s63 offen  lds
    s_add_u32 m0, s71, 27648
    s_add_u32 s63, s72, 3342336
    buffer_load_dwordx4 v10, s[48:51], s63 offen  lds
    s_add_u32 m0, s71, 28672
    s_add_u32 s63, s72, 3407872
    buffer_load_dwordx4 v10, s[48:51], s63 offen  lds
    s_add_u32 m0, s71, 29696
    s_add_u32 s63, s72, 3473408
    buffer_load_dwordx4 v10, s[48:51], s63 offen  lds
    s_add_u32 m0, s71, 30720
    s_add_u32 s63, s72, 3538944
    buffer_load_dwordx4 v10, s[48:51], s63 offen  lds
    s_add_u32 m0, s71, 31744
    s_add_u32 s63, s72, 3604480
    buffer_load_dwordx4 v10, s[48:51], s63 offen  lds
    s_waitcnt lgkmcnt(0)
    s_waitcnt vmcnt(16)
    s_barrier
    ds_read_b64_tr_b16 a[32:33], v16 offset:8192
    ds_read_b64_tr_b16 a[34:35], v16 offset:8704
    ds_read_b64_tr_b16 a[36:37], v16 offset:8224
    ds_read_b64_tr_b16 a[38:39], v16 offset:8736
    ds_read_b64_tr_b16 a[40:41], v16 offset:12288
    ds_read_b64_tr_b16 a[42:43], v16 offset:12800
    ds_read_b64_tr_b16 a[44:45], v16 offset:12320
    ds_read_b64_tr_b16 a[46:47], v16 offset:12832
    ds_read_b64_tr_b16 a[48:49], v17 offset:8192
    ds_read_b64_tr_b16 a[50:51], v17 offset:8704
    ds_read_b64_tr_b16 a[52:53], v17 offset:8224
    ds_read_b64_tr_b16 a[54:55], v17 offset:8736
    s_waitcnt lgkmcnt(4)
    ds_read_b64_tr_b16 a[56:57], v17 offset:12288
    ds_read_b64_tr_b16 a[58:59], v17 offset:12800
    ds_read_b64_tr_b16 a[60:61], v17 offset:12320
    ds_read_b64_tr_b16 a[62:63], v17 offset:12832
    s_add_u32 m0, s71, 32768
    s_add_u32 s63, s73, 4194304
    buffer_load_dwordx4 v10, s[48:51], s63 offen  lds
    s_add_u32 m0, s71, 33792
    s_add_u32 s63, s73, 4259840
    buffer_load_dwordx4 v10, s[48:51], s63 offen  lds
    s_add_u32 m0, s71, 34816
    s_add_u32 s63, s73, 4325376
    buffer_load_dwordx4 v10, s[48:51], s63 offen  lds
    s_add_u32 m0, s71, 35840
    s_add_u32 s63, s73, 4390912
    buffer_load_dwordx4 v10, s[48:51], s63 offen  lds
    s_waitcnt lgkmcnt(0)
    s_waitcnt vmcnt(12)
    s_barrier
    ds_read_b64_tr_b16 a[64:65], v16 offset:16384
    ds_read_b64_tr_b16 a[66:67], v16 offset:16896
    ds_read_b64_tr_b16 a[68:69], v16 offset:16416
    ds_read_b64_tr_b16 a[70:71], v16 offset:16928
    ds_read_b64_tr_b16 a[72:73], v16 offset:20480
    ds_read_b64_tr_b16 a[74:75], v16 offset:20992
    ds_read_b64_tr_b16 a[76:77], v16 offset:20512
    ds_read_b64_tr_b16 a[78:79], v16 offset:21024
    ds_read_b64_tr_b16 a[80:81], v17 offset:16384
    ds_read_b64_tr_b16 a[82:83], v17 offset:16896
    ds_read_b64_tr_b16 a[84:85], v17 offset:16416
    ds_read_b64_tr_b16 a[86:87], v17 offset:16928
    s_waitcnt lgkmcnt(4)
    ds_read_b64_tr_b16 a[88:89], v17 offset:20480
    ds_read_b64_tr_b16 a[90:91], v17 offset:20992
    ds_read_b64_tr_b16 a[92:93], v17 offset:20512
    ds_read_b64_tr_b16 a[94:95], v17 offset:21024
    s_add_u32 m0, s71, 0
    s_add_u32 s63, s72, 0
    buffer_load_dwordx4 v10, s[52:55], s63 offen  lds
    s_add_u32 m0, s71, 1024
    s_add_u32 s63, s72, 65536
    buffer_load_dwordx4 v10, s[52:55], s63 offen  lds
    s_add_u32 m0, s71, 2048
    s_add_u32 s63, s72, 131072
    buffer_load_dwordx4 v10, s[52:55], s63 offen  lds
    s_add_u32 m0, s71, 3072
    s_add_u32 s63, s72, 196608
    buffer_load_dwordx4 v10, s[52:55], s63 offen  lds
    s_add_u32 m0, s71, 4096
    s_add_u32 s63, s72, 262144
    buffer_load_dwordx4 v10, s[52:55], s63 offen  lds
    s_add_u32 m0, s71, 5120
    s_add_u32 s63, s72, 327680
    buffer_load_dwordx4 v10, s[52:55], s63 offen  lds
    s_add_u32 m0, s71, 6144
    s_add_u32 s63, s72, 393216
    buffer_load_dwordx4 v10, s[52:55], s63 offen  lds
    s_add_u32 m0, s71, 7168
    s_add_u32 s63, s72, 458752
    buffer_load_dwordx4 v10, s[52:55], s63 offen  lds
    s_waitcnt lgkmcnt(0)
    s_waitcnt vmcnt(12)
    s_barrier
    ds_read_b64_tr_b16 a[96:97], v16 offset:24576
    ds_read_b64_tr_b16 a[98:99], v16 offset:25088
    ds_read_b64_tr_b16 a[100:101], v16 offset:24608
    ds_read_b64_tr_b16 a[102:103], v16 offset:25120
    ds_read_b64_tr_b16 a[104:105], v16 offset:28672
    ds_read_b64_tr_b16 a[106:107], v16 offset:29184
    ds_read_b64_tr_b16 a[108:109], v16 offset:28704
    ds_read_b64_tr_b16 a[110:111], v16 offset:29216
    ds_read_b64_tr_b16 a[112:113], v17 offset:24576
    ds_read_b64_tr_b16 a[114:115], v17 offset:25088
    ds_read_b64_tr_b16 a[116:117], v17 offset:24608
    ds_read_b64_tr_b16 a[118:119], v17 offset:25120
    s_waitcnt lgkmcnt(4)
    ds_read_b64_tr_b16 a[120:121], v17 offset:28672
    ds_read_b64_tr_b16 a[122:123], v17 offset:29184
    ds_read_b64_tr_b16 a[124:125], v17 offset:28704
    ds_read_b64_tr_b16 a[126:127], v17 offset:29216
    s_add_u32 m0, s71, 8192
    s_add_u32 s63, s72, 1048576
    buffer_load_dwordx4 v10, s[52:55], s63 offen  lds
    s_add_u32 m0, s71, 9216
    s_add_u32 s63, s72, 1114112
    buffer_load_dwordx4 v10, s[52:55], s63 offen  lds
    s_add_u32 m0, s71, 10240
    s_add_u32 s63, s72, 1179648
    buffer_load_dwordx4 v10, s[52:55], s63 offen  lds
    s_add_u32 m0, s71, 11264
    s_add_u32 s63, s72, 1245184
    buffer_load_dwordx4 v10, s[52:55], s63 offen  lds
    s_add_u32 m0, s71, 12288
    s_add_u32 s63, s72, 1310720
    buffer_load_dwordx4 v10, s[52:55], s63 offen  lds
    s_add_u32 m0, s71, 13312
    s_add_u32 s63, s72, 1376256
    buffer_load_dwordx4 v10, s[52:55], s63 offen  lds
    s_add_u32 m0, s71, 14336
    s_add_u32 s63, s72, 1441792
    buffer_load_dwordx4 v10, s[52:55], s63 offen  lds
    s_add_u32 m0, s71, 15360
    s_add_u32 s63, s72, 1507328
    buffer_load_dwordx4 v10, s[52:55], s63 offen  lds
    s_waitcnt lgkmcnt(0)
    s_waitcnt vmcnt(16)
    s_barrier
    ds_read_b64_tr_b16 a[128:129], v16 offset:32768
    ds_read_b64_tr_b16 a[130:131], v16 offset:33280
    ds_read_b64_tr_b16 a[136:137], v17 offset:32768
    ds_read_b64_tr_b16 a[138:139], v17 offset:33280
    ds_read_b64_tr_b16 a[132:133], v16 offset:32800
    ds_read_b64_tr_b16 a[134:135], v16 offset:33312
    ds_read_b64_tr_b16 a[140:141], v17 offset:32800
    ds_read_b64_tr_b16 a[142:143], v17 offset:33312
    s_add_u32 m0, s71, 16384
    s_add_u32 s63, s72, 2097152
    buffer_load_dwordx4 v10, s[52:55], s63 offen  lds
    s_add_u32 m0, s71, 17408
    s_add_u32 s63, s72, 2162688
    buffer_load_dwordx4 v10, s[52:55], s63 offen  lds
    s_add_u32 m0, s71, 18432
    s_add_u32 s63, s72, 2228224
    buffer_load_dwordx4 v10, s[52:55], s63 offen  lds
    s_add_u32 m0, s71, 19456
    s_add_u32 s63, s72, 2293760
    buffer_load_dwordx4 v10, s[52:55], s63 offen  lds
    s_add_u32 m0, s71, 20480
    s_add_u32 s63, s72, 2359296
    buffer_load_dwordx4 v10, s[52:55], s63 offen  lds
    s_add_u32 m0, s71, 21504
    s_add_u32 s63, s72, 2424832
    buffer_load_dwordx4 v10, s[52:55], s63 offen  lds
    s_add_u32 m0, s71, 22528
    s_add_u32 s63, s72, 2490368
    buffer_load_dwordx4 v10, s[52:55], s63 offen  lds
    s_add_u32 m0, s71, 23552
    s_add_u32 s63, s72, 2555904
    buffer_load_dwordx4 v10, s[52:55], s63 offen  lds
    s_waitcnt lgkmcnt(0)
    s_waitcnt vmcnt(16)
    s_barrier
    ds_read_b64_tr_b16 a[144:145], v16 offset:0
    ds_read_b64_tr_b16 a[146:147], v16 offset:512
    ds_read_b64_tr_b16 a[148:149], v16 offset:32
    ds_read_b64_tr_b16 a[150:151], v16 offset:544
    ds_read_b64_tr_b16 a[152:153], v16 offset:4096
    ds_read_b64_tr_b16 a[154:155], v16 offset:4608
    ds_read_b64_tr_b16 a[156:157], v16 offset:4128
    ds_read_b64_tr_b16 a[158:159], v16 offset:4640
    ds_read_b64_tr_b16 a[160:161], v17 offset:0
    ds_read_b64_tr_b16 a[162:163], v17 offset:512
    ds_read_b64_tr_b16 a[164:165], v17 offset:32
    ds_read_b64_tr_b16 a[166:167], v17 offset:544
    s_waitcnt lgkmcnt(4)
    ds_read_b64_tr_b16 a[168:169], v17 offset:4096
    ds_read_b64_tr_b16 a[170:171], v17 offset:4608
    ds_read_b64_tr_b16 a[172:173], v17 offset:4128
    ds_read_b64_tr_b16 a[174:175], v17 offset:4640
    s_add_u32 m0, s71, 24576
    s_add_u32 s63, s72, 3145728
    buffer_load_dwordx4 v10, s[52:55], s63 offen  lds
    s_add_u32 m0, s71, 25600
    s_add_u32 s63, s72, 3211264
    buffer_load_dwordx4 v10, s[52:55], s63 offen  lds
    s_add_u32 m0, s71, 26624
    s_add_u32 s63, s72, 3276800
    buffer_load_dwordx4 v10, s[52:55], s63 offen  lds
    s_add_u32 m0, s71, 27648
    s_add_u32 s63, s72, 3342336
    buffer_load_dwordx4 v10, s[52:55], s63 offen  lds
    s_add_u32 m0, s71, 28672
    s_add_u32 s63, s72, 3407872
    buffer_load_dwordx4 v10, s[52:55], s63 offen  lds
    s_add_u32 m0, s71, 29696
    s_add_u32 s63, s72, 3473408
    buffer_load_dwordx4 v10, s[52:55], s63 offen  lds
    s_add_u32 m0, s71, 30720
    s_add_u32 s63, s72, 3538944
    buffer_load_dwordx4 v10, s[52:55], s63 offen  lds
    s_add_u32 m0, s71, 31744
    s_add_u32 s63, s72, 3604480
    buffer_load_dwordx4 v10, s[52:55], s63 offen  lds
    s_waitcnt lgkmcnt(0)
    s_waitcnt vmcnt(16)
    s_barrier
    ds_read_b64_tr_b16 a[176:177], v16 offset:8192
    ds_read_b64_tr_b16 a[178:179], v16 offset:8704
    ds_read_b64_tr_b16 a[180:181], v16 offset:8224
    ds_read_b64_tr_b16 a[182:183], v16 offset:8736
    ds_read_b64_tr_b16 a[184:185], v16 offset:12288
    ds_read_b64_tr_b16 a[186:187], v16 offset:12800
    ds_read_b64_tr_b16 a[188:189], v16 offset:12320
    ds_read_b64_tr_b16 a[190:191], v16 offset:12832
    ds_read_b64_tr_b16 a[192:193], v17 offset:8192
    ds_read_b64_tr_b16 a[194:195], v17 offset:8704
    ds_read_b64_tr_b16 a[196:197], v17 offset:8224
    ds_read_b64_tr_b16 a[198:199], v17 offset:8736
    s_waitcnt lgkmcnt(4)
    ds_read_b64_tr_b16 a[200:201], v17 offset:12288
    ds_read_b64_tr_b16 a[202:203], v17 offset:12800
    ds_read_b64_tr_b16 a[204:205], v17 offset:12320
    ds_read_b64_tr_b16 a[206:207], v17 offset:12832
    s_add_u32 m0, s71, 32768
    s_add_u32 s63, s73, 4194304
    buffer_load_dwordx4 v10, s[52:55], s63 offen  lds
    s_add_u32 m0, s71, 33792
    s_add_u32 s63, s73, 4259840
    buffer_load_dwordx4 v10, s[52:55], s63 offen  lds
    s_add_u32 m0, s71, 34816
    s_add_u32 s63, s73, 4325376
    buffer_load_dwordx4 v10, s[52:55], s63 offen  lds
    s_add_u32 m0, s71, 35840
    s_add_u32 s63, s73, 4390912
    buffer_load_dwordx4 v10, s[52:55], s63 offen  lds
    s_waitcnt lgkmcnt(0)
    s_waitcnt vmcnt(12)
    s_barrier
    ds_read_b64_tr_b16 a[208:209], v16 offset:16384
    ds_read_b64_tr_b16 a[210:211], v16 offset:16896
    ds_read_b64_tr_b16 a[212:213], v16 offset:16416
    ds_read_b64_tr_b16 a[214:215], v16 offset:16928
    ds_read_b64_tr_b16 a[216:217], v16 offset:20480
    ds_read_b64_tr_b16 a[218:219], v16 offset:20992
    ds_read_b64_tr_b16 a[220:221], v16 offset:20512
    ds_read_b64_tr_b16 a[222:223], v16 offset:21024
    ds_read_b64_tr_b16 a[224:225], v17 offset:16384
    ds_read_b64_tr_b16 a[226:227], v17 offset:16896
    ds_read_b64_tr_b16 a[228:229], v17 offset:16416
    ds_read_b64_tr_b16 a[230:231], v17 offset:16928
    s_waitcnt lgkmcnt(4)
    ds_read_b64_tr_b16 a[232:233], v17 offset:20480
    ds_read_b64_tr_b16 a[234:235], v17 offset:20992
    ds_read_b64_tr_b16 a[236:237], v17 offset:20512
    ds_read_b64_tr_b16 a[238:239], v17 offset:21024
    s_waitcnt lgkmcnt(0)
    s_cmp_ge_u32 s4, 3
    s_cbranch_scc1 L_cend_24
    s_mov_b32 s60, 1048576
    s_lshl_b32 s63, s7, 3
    s_add_u32 s64, s44, s63
    s_addc_u32 s65, s45, 0
    s_load_dwordx2 s[78:79], s[64:65], 0
    s_load_dwordx2 s[80:81], s[64:65], 32
    s_load_dwordx2 s[82:83], s[64:65], 64
    s_load_dwordx2 s[84:85], s[64:65], 96
    s_load_dwordx2 s[86:87], s[64:65], 128
    s_load_dwordx2 s[88:89], s[64:65], 160
    s_load_dwordx2 s[90:91], s[64:65], 192
    s_load_dwordx2 s[92:93], s[64:65], 224
L_cen_23:
    s_waitcnt lgkmcnt(0)
    s_mov_b32 s63, 0
    s_mov_b32 vcc_lo, 0
    s_mov_b32 vcc_hi, 0
    s_not_b32 s78, s78
    s_or_b32 vcc_hi, vcc_hi, s78
    s_and_b32 s78, s79, 0xff
    s_or_b32 vcc_hi, vcc_hi, s78
    s_lshr_b32 s79, s79, 8
    s_add_u32 s63, s63, s79
    s_xor_b32 s79, s79, 32
    s_or_b32 vcc_lo, vcc_lo, s79
    s_not_b32 s80, s80
    s_or_b32 vcc_hi, vcc_hi, s80
    s_and_b32 s80, s81, 0xff
    s_or_b32 vcc_hi, vcc_hi, s80
    s_lshr_b32 s81, s81, 8
    s_add_u32 s63, s63, s81
    s_xor_b32 s81, s81, 32
    s_or_b32 vcc_lo, vcc_lo, s81
    s_not_b32 s82, s82
    s_or_b32 vcc_hi, vcc_hi, s82
    s_and_b32 s82, s83, 0xff
    s_or_b32 vcc_hi, vcc_hi, s82
    s_lshr_b32 s83, s83, 8
    s_add_u32 s63, s63, s83
    s_xor_b32 s83, s83, 32
    s_or_b32 vcc_lo, vcc_lo, s83
    s_not_b32 s84, s84
    s_or_b32 vcc_hi, vcc_hi, s84
    s_and_b32 s84, s85, 0xff
    s_or_b32 vcc_hi, vcc_hi, s84
    s_lshr_b32 s85, s85, 8
    s_add_u32 s63, s63, s85
    s_xor_b32 s85, s85, 32
    s_or_b32 vcc_lo, vcc_lo, s85
    s_not_b32 s86, s86
    s_or_b32 vcc_hi, vcc_hi, s86
    s_and_b32 s86, s87, 0xff
    s_or_b32 vcc_hi, vcc_hi, s86
    s_lshr_b32 s87, s87, 8
    s_add_u32 s63, s63, s87
    s_xor_b32 s87, s87, 32
    s_or_b32 vcc_lo, vcc_lo, s87
    s_not_b32 s88, s88
    s_or_b32 vcc_hi, vcc_hi, s88
    s_and_b32 s88, s89, 0xff
    s_or_b32 vcc_hi, vcc_hi, s88
    s_lshr_b32 s89, s89, 8
    s_add_u32 s63, s63, s89
    s_xor_b32 s89, s89, 32
    s_or_b32 vcc_lo, vcc_lo, s89
    s_not_b32 s90, s90
    s_or_b32 vcc_hi, vcc_hi, s90
    s_and_b32 s90, s91, 0xff
    s_or_b32 vcc_hi, vcc_hi, s90
    s_lshr_b32 s91, s91, 8
    s_add_u32 s63, s63, s91
    s_xor_b32 s91, s91, 32
    s_or_b32 vcc_lo, vcc_lo, s91
    s_not_b32 s92, s92
    s_or_b32 vcc_hi, vcc_hi, s92
    s_and_b32 s92, s93, 0xff
    s_or_b32 vcc_hi, vcc_hi, s92
    s_lshr_b32 s93, s93, 8
    s_add_u32 s63, s63, s93
    s_xor_b32 s93, s93, 32
    s_or_b32 vcc_lo, vcc_lo, s93
    s_or_b32 vcc_hi, vcc_hi, vcc_lo
    s_cbranch_scc0 L_cend_24
    s_cmp_ge_u32 s63, 256
    s_cbranch_scc1 L_renumber
    s_sleep 16
    s_sub_u32 s60, s60, 1
    s_cbranch_scc1 L_abort
    s_load_dwordx2 s[78:79], s[64:65], 0 glc
    s_load_dwordx2 s[80:81], s[64:65], 32 glc
    s_load_dwordx2 s[82:83], s[64:65], 64 glc
    s_load_dwordx2 s[84:85], s[64:65], 96 glc
    s_load_dwordx2 s[86:87], s[64:65], 128 glc
    s_load_dwordx2 s[88:89], s[64:65], 160 glc
    s_load_dwordx2 s[90:91], s[64:65], 192 glc
    s_load_dwordx2 s[92:93], s[64:65], 224 glc
    s_branch L_cen_23
L_cend_24:
    s_waitcnt vmcnt(4)
    s_barrier
    ds_read_b64_tr_b16 a[240:241], v16 offset:24576
    ds_read_b64_tr_b16 a[242:243], v16 offset:25088
    ds_read_b64_tr_b16 a[244:245], v16 offset:24608
    ds_read_b64_tr_b16 a[246:247], v16 offset:25120
    ds_read_b64_tr_b16 a[248:249], v16 offset:28672
    ds_read_b64_tr_b16 a[250:251], v16 offset:29184
    ds_read_b64_tr_b16 a[252:253], v16 offset:28704
    ds_read_b64_tr_b16 a[254:255], v16 offset:29216
    ds_read_b64_tr_b16 v[224:225], v17 offset:24576
    ds_read_b64_tr_b16 v[226:227], v17 offset:25088
    ds_read_b64_tr_b16 v[228:229], v17 offset:24608
    ds_read_b64_tr_b16 v[230:231], v17 offset:25120
    s_waitcnt lgkmcnt(4)
    ds_read_b64_tr_b16 v[232:233], v17 offset:28672
    ds_read_b64_tr_b16 v[234:235], v17 offset:29184
    ds_read_b64_tr_b16 v[236:237], v17 offset:28704
    ds_read_b64_tr_b16 v[238:239], v17 offset:29216
    s_waitcnt lgkmcnt(0)
    s_waitcnt vmcnt(0)
    s_barrier
    ds_read_b64_tr_b16 v[240:241], v16 offset:32768
    ds_read_b64_tr_b16 v[242:243], v16 offset:33280
    ds_read_b64_tr_b16 v[248:249], v17 offset:32768
    ds_read_b64_tr_b16 v[250:251], v17 offset:33280
    ds_read_b64_tr_b16 v[244:245], v16 offset:32800
    ds_read_b64_tr_b16 v[246:247], v16 offset:33312
    ds_read_b64_tr_b16 v[252:253], v17 offset:32800
    ds_read_b64_tr_b16 v[254:255], v17 offset:33312
    s_waitcnt lgkmcnt(0)
    s_barrier
    s_mov_b32 s67, 0
    s_mov_b32 s68, 0
    s_mov_b32 s69, 0
    s_lshl_b32 s65, s67, s94
    s_add_u32 s65, s65, s95
    s_mov_b32 s60, 1048576
L_poll_25:
    buffer_load_dword v8, v5, s[8:11], s65 offen sc1
    s_waitcnt vmcnt(0)
    v_cmp_eq_u32 vcc, 0, v8
    s_cbranch_vccz L_pdone_26
    s_sleep 2
    s_sub_u32 s60, s60, 1
    s_cbranch_scc1 L_abort
    s_branch L_poll_25
L_pdone_26:
    s_mul_i32 s63, s66, 6291456
    s_mul_i32 s64, s67, 36864
    s_add_u32 s63, s63, s64
    s_mul_i32 s64, s3, 9216
    s_add_u32 s63, s63, s64
    s_add_u32 s63, s63, 10485760
    s_add_u32 s64, s64, s68
    s_add_u32 m0, s64, 0
    s_nop 0
    buffer_load_dwordx4 v1, s[8:11], s63 offen offset:0 sc1 lds
    s_add_u32 m0, s64, 896
    s_nop 0
    buffer_load_dwordx4 v1, s[8:11], s63 offen offset:128 sc1 lds
    s_add_u32 m0, s64, 1792
    s_nop 0
    buffer_load_dwordx4 v1, s[8:11], s63 offen offset:256 sc1 lds
    s_add_u32 m0, s64, 2688
    s_nop 0
    buffer_load_dwordx4 v1, s[8:11], s63 offen offset:384 sc1 lds
    s_add_u32 m0, s64, 3584
    s_nop 0
    buffer_load_dwordx4 v1, s[8:11], s63 offen offset:512 sc1 lds
    s_add_u32 m0, s64, 4480
    s_nop 0
    buffer_load_dwordx4 v1, s[8:11], s63 offen offset:640 sc1 lds
    s_add_u32 m0, s64, 5376
    s_nop 0
    buffer_load_dwordx4 v1, s[8:11], s63 offen offset:768 sc1 lds
    s_add_u32 m0, s64, 6272
    s_nop 0
    buffer_load_dwordx4 v1, s[8:11], s63 offen offset:896 sc1 lds
    s_add_u32 m0, s64, 7168
    s_nop 0
    buffer_load_dwordx4 v1, s[8:11], s63 offen offset:1024 sc1 lds
    s_getpc_b64 s[64:65]
    s_lshl_b32 s63, s3, 13
    v_lshlrev_b32 v24, 7, v0
    v_add_u32 v24, s63, v24
    v_min_u32 v24, 6144, v24
    global_load_dword v24, v24, s[64:65]
    s_mov_b32 s76, 1
    s_lshl_b32 s65, s76, s94
    s_add_u32 s65, s65, s95
    buffer_load_dword v8, v5, s[8:11], s65 offen sc1
    s_waitcnt vmcnt(0)
    s_lshl_b32 s80, s66, 5
    s_add_u32 s80, s80, s5
    s_lshl_b32 s80, s80, 2
    s_add_u32 s80, s80, s3
    s_lshl_b32 s80, s80, 6
    s_add_u32 s80, s80, s67
    s_lshl_b32 s80, s80, 2
    s_lshl_b32 s81, s66, 5
    s_add_u32 s81, s81, s5
    s_mul_i32 s81, s81, 2101248
    s_mul_i32 s79, s67, 24576
    s_add_u32 s81, s81, s79
    s_add_u32 s81, s81, 67108864
    s_lshr_b32 s80, s80, 2
    s_lshl_b32 s79, s3, 12
    s_add_u32 s81, s81, s79
    v_mov_b32 v10, 1
    v_mov_b32 v11, 0
L_kv_loop:
    s_barrier
    ds_read_b128 v[16:19], v2 offset:0
    ds_read_b128 v[20:23], v2 offset:18432
    ds_read_b128 v[24:27], v3 offset:0
    ds_read_b128 v[28:31], v3 offset:18432
    ds_read_b128 v[32:35], v2 offset:1024
    ds_read_b128 v[36:39], v2 offset:19456
    s_add_u32 s74, s67, 1
    s_min_u32 s74, s74, 63
    s_sub_u32 s75, 36864, s68
    v_cmp_eq_u32 vcc, 0, v8
    s_mul_i32 s72, s66, 6291456
    s_mul_i32 s73, s74, 36864
    s_add_u32 s72, s72, s73
    s_mul_i32 s73, s3, 9216
    s_add_u32 s72, s72, s73
    s_add_u32 s72, s72, 10485760
    s_add_u32 s73, s73, s75
    s_cbranch_vccnz L_kv_nopf
    s_mov_b32 s70, 1
    s_waitcnt lgkmcnt(4)
    v_mfma_f32_16x16x32_bf16 v[48:51], a[0:3], v[16:19], 0
    ds_read_b128 v[40:43], v3 offset:1024
    v_mfma_f32_16x16x32_bf16 v[52:55], a[4:7], v[16:19], 0
    s_add_u32 m0, s73, 0
    s_nop 0
    buffer_load_dwordx4 v1, s[8:11], s72 offen offset:0 sc1 lds
    v_mfma_f32_16x16x32_bf16 v[64:67], v[16:19], a[144:147], 0
    v_mfma_f32_16x16x32_bf16 v[72:75], v[16:19], a[148:151], 0
    v_mfma_f32_16x16x32_bf16 v[56:59], a[0:3], v[20:23], 0
    ds_read_b128 v[44:47], v3 offset:19456
    v_mfma_f32_16x16x32_bf16 v[60:63], a[4:7], v[20:23], 0
    v_mfma_f32_16x16x32_bf16 v[68:71], v[20:23], a[144:147], 0
    v_mfma_f32_16x16x32_bf16 v[76:79], v[20:23], a[148:151], 0
    s_waitcnt lgkmcnt(4)
    v_mfma_f32_16x16x32_bf16 v[48:51], a[8:11], v[24:27], v[48:51]
    ds_read_b128 v[16:19], v2 offset:2048
    v_mfma_f32_16x16x32_bf16 v[52:55], a[12:15], v[24:27], v[52:55]
    s_add_u32 m0, s73, 896
    s_nop 0
    buffer_load_dwordx4 v1, s[8:11], s72 offen offset:128 sc1 lds
    v_mfma_f32_16x16x32_bf16 v[64:67], v[24:27], a[152:155], v[64:67]
    v_mfma_f32_16x16x32_bf16 v[72:75], v[24:27], a[156:159], v[72:75]
    v_mfma_f32_16x16x32_bf16 v[56:59], a[8:11], v[28:31], v[56:59]
    ds_read_b128 v[20:23], v2 offset:20480
    v_mfma_f32_16x16x32_bf16 v[60:63], a[12:15], v[28:31], v[60:63]
    v_mfma_f32_16x16x32_bf16 v[68:71], v[28:31], a[152:155], v[68:71]
    v_mfma_f32_16x16x32_bf16 v[76:79], v[28:31], a[156:159], v[76:79]
    s_waitcnt lgkmcnt(4)
    v_mfma_f32_16x16x32_bf16 v[48:51], a[16:19], v[32:35], v[48:51]
    ds_read_b128 v[24:27], v3 offset:2048
    v_mfma_f32_16x16x32_bf16 v[52:55], a[20:23], v[32:35], v[52:55]
    s_add_u32 m0, s73, 1792
    s_nop 0
    buffer_load_dwordx4 v1, s[8:11], s72 offen offset:256 sc1 lds
    v_mfma_f32_16x16x32_bf16 v[64:67], v[32:35], a[160:163], v[64:67]
    v_mfma_f32_16x16x32_bf16 v[72:75], v[32:35], a[164:167], v[72:75]
    v_mfma_f32_16x16x32_bf16 v[56:59], a[16:19], v[36:39], v[56:59]
    ds_read_b128 v[28:31], v3 offset:20480
    v_mfma_f32_16x16x32_bf16 v[60:63], a[20:23], v[36:39], v[60:63]
    v_mfma_f32_16x16x32_bf16 v[68:71], v[36:39], a[160:163], v[68:71]
    v_mfma_f32_16x16x32_bf16 v[76:79], v[36:39], a[164:167], v[76:79]
    s_waitcnt lgkmcnt(4)
    v_mfma_f32_16x16x32_bf16 v[48:51], a[24:27], v[40:43], v[48:51]
    ds_read_b128 v[32:35], v2 offset:3072
    v_mfma_f32_16x16x32_bf16 v[52:55], a[28:31], v[40:43], v[52:55]
    s_add_u32 m0, s73, 2688
    s_nop 0
    buffer_load_dwordx4 v1, s[8:11], s72 offen offset:384 sc1 lds
    v_mfma_f32_16x16x32_bf16 v[64:67], v[40:43], a[168:171], v[64:67]
    v_mfma_f32_16x16x32_bf16 v[72:75], v[40:43], a[172:175], v[72:75]
    v_mfma_f32_16x16x32_bf16 v[56:59], a[24:27], v[44:47], v[56:59]
    ds_read_b128 v[36:39], v2 offset:21504
    v_mfma_f32_16x16x32_bf16 v[60:63], a[28:31], v[44:47], v[60:63]
    v_mfma_f32_16x16x32_bf16 v[68:71], v[44:47], a[168:171], v[68:71]
    v_mfma_f32_16x16x32_bf16 v[76:79], v[44:47], a[172:175], v[76:79]
    s_waitcnt lgkmcnt(4)
    v_mfma_f32_16x16x32_bf16 v[48:51], a[32:35], v[16:19], v[48:51]
    ds_read_b128 v[40:43], v3 offset:3072
    v_mfma_f32_16x16x32_bf16 v[52:55], a[36:39], v[16:19], v[52:55]
    s_add_u32 m0, s73, 3584
    s_nop 0
    buffer_load_dwordx4 v1, s[8:11], s72 offen offset:512 sc1 lds
    v_mfma_f32_16x16x32_bf16 v[64:67], v[16:19], a[176:179], v[64:67]
    v_mfma_f32_16x16x32_bf16 v[72:75], v[16:19], a[180:183], v[72:75]
    v_mfma_f32_16x16x32_bf16 v[56:59], a[32:35], v[20:23], v[56:59]
    ds_read_b128 v[44:47], v3 offset:21504
    v_mfma_f32_16x16x32_bf16 v[60:63], a[36:39], v[20:23], v[60:63]
    v_mfma_f32_16x16x32_bf16 v[68:71], v[20:23], a[176:179], v[68:71]
    v_mfma_f32_16x16x32_bf16 v[76:79], v[20:23], a[180:183], v[76:79]
    s_waitcnt lgkmcnt(4)
    v_mfma_f32_16x16x32_bf16 v[48:51], a[40:43], v[24:27], v[48:51]
    ds_read_b128 v[16:19], v2 offset:4096
    v_mfma_f32_16x16x32_bf16 v[52:55], a[44:47], v[24:27], v[52:55]
    s_add_u32 m0, s73, 4480
    s_nop 0
    buffer_load_dwordx4 v1, s[8:11], s72 offen offset:640 sc1 lds
    v_mfma_f32_16x16x32_bf16 v[64:67], v[24:27], a[184:187], v[64:67]
    v_mfma_f32_16x16x32_bf16 v[72:75], v[24:27], a[188:191], v[72:75]
    v_mfma_f32_16x16x32_bf16 v[56:59], a[40:43], v[28:31], v[56:59]
    ds_read_b128 v[20:23], v2 offset:22528
    v_mfma_f32_16x16x32_bf16 v[60:63], a[44:47], v[28:31], v[60:63]
    v_mfma_f32_16x16x32_bf16 v[68:71], v[28:31], a[184:187], v[68:71]
    v_mfma_f32_16x16x32_bf16 v[76:79], v[28:31], a[188:191], v[76:79]
    s_cmp_eq_u32 s69, 0
    s_cbranch_scc1 L_fl_27
    s_waitcnt vmcnt(6)
    s_mov_b64 exec, 1
    buffer_store_dword v10, v11, s[8:11], s69 offen sc1
    s_mov_b64 exec, -1
    s_mov_b32 s69, 0
L_fl_27:
    s_waitcnt lgkmcnt(4)
    v_mfma_f32_16x16x32_bf16 v[48:51], a[48:51], v[32:35], v[48:51]
    ds_read_b128 v[24:27], v3 offset:4096
    v_mfma_f32_16x16x32_bf16 v[52:55], a[52:55], v[32:35], v[52:55]
    s_add_u32 m0, s73, 5376
    s_nop 0
    buffer_load_dwordx4 v1, s[8:11], s72 offen offset:768 sc1 lds
    v_mfma_f32_16x16x32_bf16 v[64:67], v[32:35], a[192:195], v[64:67]
    v_mfma_f32_16x16x32_bf16 v[72:75], v[32:35], a[196:199], v[72:75]
    v_mfma_f32_16x16x32_bf16 v[56:59], a[48:51], v[36:39], v[56:59]
    ds_read_b128 v[28:31], v3 offset:22528
    v_mfma_f32_16x16x32_bf16 v[60:63], a[52:55], v[36:39], v[60:63]
    v_mfma_f32_16x16x32_bf16 v[68:71], v[36:39], a[192:195], v[68:71]
    v_mfma_f32_16x16x32_bf16 v[76:79], v[36:39], a[196:199], v[76:79]
    s_waitcnt lgkmcnt(4)
    v_mfma_f32_16x16x32_bf16 v[48:51], a[56:59], v[40:43], v[48:51]
    ds_read_b128 v[32:35], v2 offset:5120
    v_mfma_f32_16x16x32_bf16 v[52:55], a[60:63], v[40:43], v[52:55]
    s_add_u32 m0, s73, 6272
    s_nop 0
    buffer_load_dwordx4 v1, s[8:11], s72 offen offset:896 sc1 lds
    v_mfma_f32_16x16x32_bf16 v[64:67], v[40:43], a[200:203], v[64:67]
    v_mfma_f32_16x16x32_bf16 v[72:75], v[40:43], a[204:207], v[72:75]
    v_mfma_f32_16x16x32_bf16 v[56:59], a[56:59], v[44:47], v[56:59]
    ds_read_b128 v[36:39], v2 offset:23552
    v_mfma_f32_16x16x32_bf16 v[60:63], a[60:63], v[44:47], v[60:63]
    v_mfma_f32_16x16x32_bf16 v[68:71], v[44:47], a[200:203], v[68:71]
    v_mfma_f32_16x16x32_bf16 v[76:79], v[44:47], a[204:207], v[76:79]
    s_waitcnt lgkmcnt(4)
    v_mfma_f32_16x16x32_bf16 v[48:51], a[64:67], v[16:19], v[48:51]
    ds_read_b128 v[40:43], v3 offset:5120
    v_mfma_f32_16x16x32_bf16 v[52:55], a[68:71], v[16:19], v[52:55]
    s_add_u32 m0, s73, 7168
    s_nop 0
    buffer_load_dwordx4 v1, s[8:11], s72 offen offset:1024 sc1 lds
    v_mfma_f32_16x16x32_bf16 v[64:67], v[16:19], a[208:211], v[64:67]
    v_mfma_f32_16x16x32_bf16 v[72:75], v[16:19], a[212:215], v[72:75]
    v_mfma_f32_16x16x32_bf16 v[56:59], a[64:67], v[20:23], v[56:59]
    ds_read_b128 v[44:47], v3 offset:23552
    v_mfma_f32_16x16x32_bf16 v[60:63], a[68:71], v[20:23], v[60:63]
    v_mfma_f32_16x16x32_bf16 v[68:71], v[20:23], a[208:211], v[68:71]
    v_mfma_f32_16x16x32_bf16 v[76:79], v[20:23], a[212:215], v[76:79]
    s_waitcnt lgkmcnt(4)
    v_mfma_f32_16x16x32_bf16 v[48:51], a[72:75], v[24:27], v[48:51]
    ds_read_b128 v[16:19], v2 offset:6144
    v_mfma_f32_16x16x32_bf16 v[52:55], a[76:79], v[24:27], v[52:55]
    v_mfma_f32_16x16x32_bf16 v[64:67], v[24:27], a[216:219], v[64:67]
    v_mfma_f32_16x16x32_bf16 v[72:75], v[24:27], a[220:223], v[72:75]
    v_mfma_f32_16x16x32_bf16 v[56:59], a[72:75], v[28:31], v[56:59]
    ds_read_b128 v[20:23], v2 offset:24576
    v_mfma_f32_16x16x32_bf16 v[60:63], a[76:79], v[28:31], v[60:63]
    v_mfma_f32_16x16x32_bf16 v[68:71], v[28:31], a[216:219], v[68:71]
    v_mfma_f32_16x16x32_bf16 v[76:79], v[28:31], a[220:223], v[76:79]
    s_waitcnt lgkmcnt(4)
    v_mfma_f32_16x16x32_bf16 v[48:51], a[80:83], v[32:35], v[48:51]
    ds_read_b128 v[24:27], v3 offset:6144
    v_mfma_f32_16x16x32_bf16 v[52:55], a[84:87], v[32:35], v[52:55]
    v_mfma_f32_16x16x32_bf16 v[64:67], v[32:35], a[224:227], v[64:67]
    v_mfma_f32_16x16x32_bf16 v[72:75], v[32:35], a[228:231], v[72:75]
    v_mfma_f32_16x16x32_bf16 v[56:59], a[80:83], v[36:39], v[56:59]
    ds_read_b128 v[28:31], v3 offset:24576
    v_mfma_f32_16x16x32_bf16 v[60:63], a[84:87], v[36:39], v[60:63]
    v_mfma_f32_16x16x32_bf16 v[68:71], v[36:39], a[224:227], v[68:71]
    v_mfma_f32_16x16x32_bf16 v[76:79], v[36:39], a[228:231], v[76:79]
    s_waitcnt lgkmcnt(4)
    v_mfma_f32_16x16x32_bf16 v[48:51], a[88:91], v[40:43], v[48:51]
    ds_read_b128 v[32:35], v2 offset:7168
    v_mfma_f32_16x16x32_bf16 v[52:55], a[92:95], v[40:43], v[52:55]
    v_mfma_f32_16x16x32_bf16 v[64:67], v[40:43], a[232:235], v[64:67]
    v_mfma_f32_16x16x32_bf16 v[72:75], v[40:43], a[236:239], v[72:75]
    v_mfma_f32_16x16x32_bf16 v[56:59], a[88:91], v[44:47], v[56:59]
    ds_read_b128 v[36:39], v2 offset:25600
    v_mfma_f32_16x16x32_bf16 v[60:63], a[92:95], v[44:47], v[60:63]
    v_mfma_f32_16x16x32_bf16 v[68:71], v[44:47], a[232:235], v[68:71]
    v_mfma_f32_16x16x32_bf16 v[76:79], v[44:47], a[236:239], v[76:79]
    s_add_u32 s76, s67, 2
    s_min_u32 s76, s76, 63
    s_lshl_b32 s65, s76, s94
    s_add_u32 s65, s65, s95
    buffer_load_dword v8, v5, s[8:11], s65 offen sc1
    s_waitcnt lgkmcnt(4)
    v_mfma_f32_16x16x32_bf16 v[48:51], a[96:99], v[16:19], v[48:51]
    ds_read_b128 v[40:43], v3 offset:7168
    v_mfma_f32_16x16x32_bf16 v[52:55], a[100:103], v[16:19], v[52:55]
    v_mfma_f32_16x16x32_bf16 v[64:67], v[16:19], a[240:243], v[64:67]
    v_mfma_f32_16x16x32_bf16 v[72:75], v[16:19], a[244:247], v[72:75]
    v_mfma_f32_16x16x32_bf16 v[56:59], a[96:99], v[20:23], v[56:59]
    ds_read_b128 v[44:47], v3 offset:25600
    v_mfma_f32_16x16x32_bf16 v[60:63], a[100:103], v[20:23], v[60:63]
    v_mfma_f32_16x16x32_bf16 v[68:71], v[20:23], a[240:243], v[68:71]
    v_mfma_f32_16x16x32_bf16 v[76:79], v[20:23], a[244:247], v[76:79]
    s_waitcnt lgkmcnt(4)
    v_mfma_f32_16x16x32_bf16 v[48:51], a[104:107], v[24:27], v[48:51]
    ds_read_b128 v[16:19], v2 offset:8192
    v_mfma_f32_16x16x32_bf16 v[52:55], a[108:111], v[24:27], v[52:55]
    v_mfma_f32_16x16x32_bf16 v[64:67], v[24:27], a[248:251], v[64:67]
    v_mfma_f32_16x16x32_bf16 v[72:75], v[24:27], a[252:255], v[72:75]
    v_mfma_f32_16x16x32_bf16 v[56:59], a[104:107], v[28:31], v[56:59]
    ds_read_b128 v[20:23], v2 offset:26624
    v_mfma_f32_16x16x32_bf16 v[60:63], a[108:111], v[28:31], v[60:63]
    v_mfma_f32_16x16x32_bf16 v[68:71], v[28:31], a[248:251], v[68:71]
    v_mfma_f32_16x16x32_bf16 v[76:79], v[28:31], a[252:255], v[76:79]
    s_waitcnt lgkmcnt(4)
    v_mfma_f32_16x16x32_bf16 v[48:51], a[112:115], v[32:35], v[48:51]
    ds_read_b128 v[24:27], v3 offset:8192
    v_mfma_f32_16x16x32_bf16 v[52:55], a[116:119], v[32:35], v[52:55]
    v_mfma_f32_16x16x32_bf16 v[64:67], v[32:35], v[224:227], v[64:67]
    v_mfma_f32_16x16x32_bf16 v[72:75], v[32:35], v[228:231], v[72:75]
    v_mfma_f32_16x16x32_bf16 v[56:59], a[112:115], v[36:39], v[56:59]
    ds_read_b128 v[28:31], v3 offset:26624
    v_mfma_f32_16x16x32_bf16 v[60:63], a[116:119], v[36:39], v[60:63]
    v_mfma_f32_16x16x32_bf16 v[68:71], v[36:39], v[224:227], v[68:71]
    v_mfma_f32_16x16x32_bf16 v[76:79], v[36:39], v[228:231], v[76:79]
    s_branch L_kv_epi
L_kv_nopf:
    s_waitcnt lgkmcnt(4)
    v_mfma_f32_16x16x32_bf16 v[48:51], a[0:3], v[16:19], 0
    ds_read_b128 v[40:43], v3 offset:1024
    v_mfma_f32_16x16x32_bf16 v[52:55], a[4:7], v[16:19], 0
    v_mfma_f32_16x16x32_bf16 v[64:67], v[16:19], a[144:147], 0
    v_mfma_f32_16x16x32_bf16 v[72:75], v[16:19], a[148:151], 0
    v_mfma_f32_16x16x32_bf16 v[56:59], a[0:3], v[20:23], 0
    ds_read_b128 v[44:47], v3 offset:19456
    v_mfma_f32_16x16x32_bf16 v[60:63], a[4:7], v[20:23], 0
    v_mfma_f32_16x16x32_bf16 v[68:71], v[20:23], a[144:147], 0
    v_mfma_f32_16x16x32_bf16 v[76:79], v[20:23], a[148:151], 0
    s_waitcnt lgkmcnt(4)
    v_mfma_f32_16x16x32_bf16 v[48:51], a[8:11], v[24:27], v[48:51]
    ds_read_b128 v[16:19], v2 offset:2048
    v_mfma_f32_16x16x32_bf16 v[52:55], a[12:15], v[24:27], v[52:55]
    v_mfma_f32_16x16x32_bf16 v[64:67], v[24:27], a[152:155], v[64:67]
    v_mfma_f32_16x16x32_bf16 v[72:75], v[24:27], a[156:159], v[72:75]
    v_mfma_f32_16x16x32_bf16 v[56:59], a[8:11], v[28:31], v[56:59]
    ds_read_b128 v[20:23], v2 offset:20480
    v_mfma_f32_16x16x32_bf16 v[60:63], a[12:15], v[28:31], v[60:63]
    v_mfma_f32_16x16x32_bf16 v[68:71], v[28:31], a[152:155], v[68:71]
    v_mfma_f32_16x16x32_bf16 v[76:79], v[28:31], a[156:159], v[76:79]
    s_waitcnt lgkmcnt(4)
    v_mfma_f32_16x16x32_bf16 v[48:51], a[16:19], v[32:35], v[48:51]
    ds_read_b128 v[24:27], v3 offset:2048
    v_mfma_f32_16x16x32_bf16 v[52:55], a[20:23], v[32:35], v[52:55]
    v_mfma_f32_16x16x32_bf16 v[64:67], v[32:35], a[160:163], v[64:67]
    v_mfma_f32_16x16x32_bf16 v[72:75], v[32:35], a[164:167], v[72:75]
    v_mfma_f32_16x16x32_bf16 v[56:59], a[16:19], v[36:39], v[56:59]
    ds_read_b128 v[28:31], v3 offset:20480
    v_mfma_f32_16x16x32_bf16 v[60:63], a[20:23], v[36:39], v[60:63]
    v_mfma_f32_16x16x32_bf16 v[68:71], v[36:39], a[160:163], v[68:71]
    v_mfma_f32_16x16x32_bf16 v[76:79], v[36:39], a[164:167], v[76:79]
    s_waitcnt lgkmcnt(4)
    v_mfma_f32_16x16x32_bf16 v[48:51], a[24:27], v[40:43], v[48:51]
    ds_read_b128 v[32:35], v2 offset:3072
    v_mfma_f32_16x16x32_bf16 v[52:55], a[28:31], v[40:43], v[52:55]
    v_mfma_f32_16x16x32_bf16 v[64:67], v[40:43], a[168:171], v[64:67]
    v_mfma_f32_16x16x32_bf16 v[72:75], v[40:43], a[172:175], v[72:75]
    v_mfma_f32_16x16x32_bf16 v[56:59], a[24:27], v[44:47], v[56:59]
    ds_read_b128 v[36:39], v2 offset:21504
    v_mfma_f32_16x16x32_bf16 v[60:63], a[28:31], v[44:47], v[60:63]
    v_mfma_f32_16x16x32_bf16 v[68:71], v[44:47], a[168:171], v[68:71]
    v_mfma_f32_16x16x32_bf16 v[76:79], v[44:47], a[172:175], v[76:79]
    s_waitcnt lgkmcnt(4)
    v_mfma_f32_16x16x32_bf16 v[48:51], a[32:35], v[16:19], v[48:51]
    ds_read_b128 v[40:43], v3 offset:3072
    v_mfma_f32_16x16x32_bf16 v[52:55], a[36:39], v[16:19], v[52:55]
    v_mfma_f32_16x16x32_bf16 v[64:67], v[16:19], a[176:179], v[64:67]
    v_mfma_f32_16x16x32_bf16 v[72:75], v[16:19], a[180:183], v[72:75]
    v_mfma_f32_16x16x32_bf16 v[56:59], a[32:35], v[20:23], v[56:59]
    ds_read_b128 v[44:47], v3 offset:21504
    v_mfma_f32_16x16x32_bf16 v[60:63], a[36:39], v[20:23], v[60:63]
    v_mfma_f32_16x16x32_bf16 v[68:71], v[20:23], a[176:179], v[68:71]
    v_mfma_f32_16x16x32_bf16 v[76:79], v[20:23], a[180:183], v[76:79]
    s_add_u32 s76, s67, 1
    s_min_u32 s76, s76, 63
    s_lshl_b32 s65, s76, s94
    s_add_u32 s65, s65, s95
    buffer_load_dword v9, v5, s[8:11], s65 offen sc1
    s_waitcnt lgkmcnt(4)
    v_mfma_f32_16x16x32_bf16 v[48:51], a[40:43], v[24:27], v[48:51]
    ds_read_b128 v[16:19], v2 offset:4096
    v_mfma_f32_16x16x32_bf16 v[52:55], a[44:47], v[24:27], v[52:55]
    v_mfma_f32_16x16x32_bf16 v[64:67], v[24:27], a[184:187], v[64:67]
    v_mfma_f32_16x16x32_bf16 v[72:75], v[24:27], a[188:191], v[72:75]
    v_mfma_f32_16x16x32_bf16 v[56:59], a[40:43], v[28:31], v[56:59]
    ds_read_b128 v[20:23], v2 offset:22528
    v_mfma_f32_16x16x32_bf16 v[60:63], a[44:47], v[28:31], v[60:63]
    v_mfma_f32_16x16x32_bf16 v[68:71], v[28:31], a[184:187], v[68:71]
    v_mfma_f32_16x16x32_bf16 v[76:79], v[28:31], a[188:191], v[76:79]
    s_cmp_eq_u32 s69, 0
    s_cbranch_scc1 L_fl_28
    s_waitcnt vmcnt(1)
    s_mov_b64 exec, 1
    buffer_store_dword v10, v11, s[8:11], s69 offen sc1
    s_mov_b64 exec, -1
    s_mov_b32 s69, 0
L_fl_28:
    s_waitcnt lgkmcnt(4)
    v_mfma_f32_16x16x32_bf16 v[48:51], a[48:51], v[32:35], v[48:51]
    ds_read_b128 v[24:27], v3 offset:4096
    v_mfma_f32_16x16x32_bf16 v[52:55], a[52:55], v[32:35], v[52:55]
    v_mfma_f32_16x16x32_bf16 v[64:67], v[32:35], a[192:195], v[64:67]
    v_mfma_f32_16x16x32_bf16 v[72:75], v[32:35], a[196:199], v[72:75]
    v_mfma_f32_16x16x32_bf16 v[56:59], a[48:51], v[36:39], v[56:59]
    ds_read_b128 v[28:31], v3 offset:22528
    v_mfma_f32_16x16x32_bf16 v[60:63], a[52:55], v[36:39], v[60:63]
    v_mfma_f32_16x16x32_bf16 v[68:71], v[36:39], a[192:195], v[68:71]
    v_mfma_f32_16x16x32_bf16 v[76:79], v[36:39], a[196:199], v[76:79]
    s_waitcnt lgkmcnt(4)
    v_mfma_f32_16x16x32_bf16 v[48:51], a[56:59], v[40:43], v[48:51]
    ds_read_b128 v[32:35], v2 offset:5120
    v_mfma_f32_16x16x32_bf16 v[52:55], a[60:63], v[40:43], v[52:55]
    v_mfma_f32_16x16x32_bf16 v[64:67], v[40:43], a[200:203], v[64:67]
    v_mfma_f32_16x16x32_bf16 v[72:75], v[40:43], a[204:207], v[72:75]
    v_mfma_f32_16x16x32_bf16 v[56:59], a[56:59], v[44:47], v[56:59]
    ds_read_b128 v[36:39], v2 offset:23552
    v_mfma_f32_16x16x32_bf16 v[60:63], a[60:63], v[44:47], v[60:63]
    v_mfma_f32_16x16x32_bf16 v[68:71], v[44:47], a[200:203], v[68:71]
    v_mfma_f32_16x16x32_bf16 v[76:79], v[44:47], a[204:207], v[76:79]
    s_waitcnt lgkmcnt(4)
    v_mfma_f32_16x16x32_bf16 v[48:51], a[64:67], v[16:19], v[48:51]
    ds_read_b128 v[40:43], v3 offset:5120
    v_mfma_f32_16x16x32_bf16 v[52:55], a[68:71], v[16:19], v[52:55]
    v_mfma_f32_16x16x32_bf16 v[64:67], v[16:19], a[208:211], v[64:67]
    v_mfma_f32_16x16x32_bf16 v[72:75], v[16:19], a[212:215], v[72:75]
    v_mfma_f32_16x16x32_bf16 v[56:59], a[64:67], v[20:23], v[56:59]
    ds_read_b128 v[44:47], v3 offset:23552
    v_mfma_f32_16x16x32_bf16 v[60:63], a[68:71], v[20:23], v[60:63]
    v_mfma_f32_16x16x32_bf16 v[68:71], v[20:23], a[208:211], v[68:71]
    v_mfma_f32_16x16x32_bf16 v[76:79], v[20:23], a[212:215], v[76:79]
    s_waitcnt lgkmcnt(4)
    v_mfma_f32_16x16x32_bf16 v[48:51], a[72:75], v[24:27], v[48:51]
    ds_read_b128 v[16:19], v2 offset:6144
    v_mfma_f32_16x16x32_bf16 v[52:55], a[76:79], v[24:27], v[52:55]
    v_mfma_f32_16x16x32_bf16 v[64:67], v[24:27], a[216:219], v[64:67]
    v_mfma_f32_16x16x32_bf16 v[72:75], v[24:27], a[220:223], v[72:75]
    v_mfma_f32_16x16x32_bf16 v[56:59], a[72:75], v[28:31], v[56:59]
    ds_read_b128 v[20:23], v2 offset:24576
    v_mfma_f32_16x16x32_bf16 v[60:63], a[76:79], v[28:31], v[60:63]
    v_mfma_f32_16x16x32_bf16 v[68:71], v[28:31], a[216:219], v[68:71]
    v_mfma_f32_16x16x32_bf16 v[76:79], v[28:31], a[220:223], v[76:79]
    s_waitcnt vmcnt(0)
    v_cmp_eq_u32 vcc, 0, v9
    s_cbranch_vccnz L_kv_nopf2
    s_mov_b32 s70, 1
    s_waitcnt lgkmcnt(4)
    v_mfma_f32_16x16x32_bf16 v[48:51], a[80:83], v[32:35], v[48:51]
    ds_read_b128 v[24:27], v3 offset:6144
    v_mfma_f32_16x16x32_bf16 v[52:55], a[84:87], v[32:35], v[52:55]
    s_add_u32 m0, s73, 0
    s_nop 0
    buffer_load_dwordx4 v1, s[8:11], s72 offen offset:0 sc1 lds
    v_mfma_f32_16x16x32_bf16 v[64:67], v[32:35], a[224:227], v[64:67]
    v_mfma_f32_16x16x32_bf16 v[72:75], v[32:35], a[228:231], v[72:75]
    v_mfma_f32_16x16x32_bf16 v[56:59], a[80:83], v[36:39], v[56:59]
    ds_read_b128 v[28:31], v3 offset:24576
    v_mfma_f32_16x16x32_bf16 v[60:63], a[84:87], v[36:39], v[60:63]
    s_add_u32 m0, s73, 896
    s_nop 0
    buffer_load_dwordx4 v1, s[8:11], s72 offen offset:128 sc1 lds
    v_mfma_f32_16x16x32_bf16 v[68:71], v[36:39], a[224:227], v[68:71]
    v_mfma_f32_16x16x32_bf16 v[76:79], v[36:39], a[228:231], v[76:79]
    s_waitcnt lgkmcnt(4)
    v_mfma_f32_16x16x32_bf16 v[48:51], a[88:91], v[40:43], v[48:51]
    ds_read_b128 v[32:35], v2 offset:7168
    v_mfma_f32_16x16x32_bf16 v[52:55], a[92:95], v[40:43], v[52:55]
    s_add_u32 m0, s73, 1792
    s_nop 0
    buffer_load_dwordx4 v1, s[8:11], s72 offen offset:256 sc1 lds
    v_mfma_f32_16x16x32_bf16 v[64:67], v[40:43], a[232:235], v[64:67]
    v_mfma_f32_16x16x32_bf16 v[72:75], v[40:43], a[236:239], v[72:75]
    v_mfma_f32_16x16x32_bf16 v[56:59], a[88:91], v[44:47], v[56:59]
    ds_read_b128 v[36:39], v2 offset:25600
    v_mfma_f32_16x16x32_bf16 v[60:63], a[92:95], v[44:47], v[60:63]
    s_add_u32 m0, s73, 2688
    s_nop 0
    buffer_load_dwordx4 v1, s[8:11], s72 offen offset:384 sc1 lds
    v_mfma_f32_16x16x32_bf16 v[68:71], v[44:47], a[232:235], v[68:71]
    v_mfma_f32_16x16x32_bf16 v[76:79], v[44:47], a[236:239], v[76:79]
    s_waitcnt lgkmcnt(4)
    v_mfma_f32_16x16x32_bf16 v[48:51], a[96:99], v[16:19], v[48:51]
    ds_read_b128 v[40:43], v3 offset:7168
    v_mfma_f32_16x16x32_bf16 v[52:55], a[100:103], v[16:19], v[52:55]
    s_add_u32 m0, s73, 3584
    s_nop 0
    buffer_load_dwordx4 v1, s[8:11], s72 offen offset:512 sc1 lds
    v_mfma_f32_16x16x32_bf16 v[64:67], v[16:19], a[240:243], v[64:67]
    v_mfma_f32_16x16x32_bf16 v[72:75], v[16:19], a[244:247], v[72:75]
    v_mfma_f32_16x16x32_bf16 v[56:59], a[96:99], v[20:23], v[56:59]
    ds_read_b128 v[44:47], v3 offset:25600
    v_mfma_f32_16x16x32_bf16 v[60:63], a[100:103], v[20:23], v[60:63]
    s_add_u32 m0, s73, 4480
    s_nop 0
    buffer_load_dwordx4 v1, s[8:11], s72 offen offset:640 sc1 lds
    v_mfma_f32_16x16x32_bf16 v[68:71], v[20:23], a[240:243], v[68:71]
    v_mfma_f32_16x16x32_bf16 v[76:79], v[20:23], a[244:247], v[76:79]
    s_waitcnt lgkmcnt(4)
    v_mfma_f32_16x16x32_bf16 v[48:51], a[104:107], v[24:27], v[48:51]
    ds_read_b128 v[16:19], v2 offset:8192
    v_mfma_f32_16x16x32_bf16 v[52:55], a[108:111], v[24:27], v[52:55]
    s_add_u32 m0, s73, 5376
    s_nop 0
    buffer_load_dwordx4 v1, s[8:11], s72 offen offset:768 sc1 lds
    v_mfma_f32_16x16x32_bf16 v[64:67], v[24:27], a[248:251], v[64:67]
    v_mfma_f32_16x16x32_bf16 v[72:75], v[24:27], a[252:255], v[72:75]
    v_mfma_f32_16x16x32_bf16 v[56:59], a[104:107], v[28:31], v[56:59]
    ds_read_b128 v[20:23], v2 offset:26624
    v_mfma_f32_16x16x32_bf16 v[60:63], a[108:111], v[28:31], v[60:63]
    s_add_u32 m0, s73, 6272
    s_nop 0
    buffer_load_dwordx4 v1, s[8:11], s72 offen offset:896 sc1 lds
    v_mfma_f32_16x16x32_bf16 v[68:71], v[28:31], a[248:251], v[68:71]
    v_mfma_f32_16x16x32_bf16 v[76:79], v[28:31], a[252:255], v[76:79]
    s_waitcnt lgkmcnt(4)
    v_mfma_f32_16x16x32_bf16 v[48:51], a[112:115], v[32:35], v[48:51]
    ds_read_b128 v[24:27], v3 offset:8192
    v_mfma_f32_16x16x32_bf16 v[52:55], a[116:119], v[32:35], v[52:55]
    s_add_u32 m0, s73, 7168
    s_nop 0
    buffer_load_dwordx4 v1, s[8:11], s72 offen offset:1024 sc1 lds
    v_mfma_f32_16x16x32_bf16 v[64:67], v[32:35], v[224:227], v[64:67]
    v_mfma_f32_16x16x32_bf16 v[72:75], v[32:35], v[228:231], v[72:75]
    v_mfma_f32_16x16x32_bf16 v[56:59], a[112:115], v[36:39], v[56:59]
    ds_read_b128 v[28:31], v3 offset:26624
    v_mfma_f32_16x16x32_bf16 v[60:63], a[116:119], v[36:39], v[60:63]
    v_mfma_f32_16x16x32_bf16 v[68:71], v[36:39], v[224:227], v[68:71]
    v_mfma_f32_16x16x32_bf16 v[76:79], v[36:39], v[228:231], v[76:79]
    s_add_u32 s76, s67, 2
    s_min_u32 s76, s76, 63
    s_lshl_b32 s65, s76, s94
    s_add_u32 s65, s65, s95
    buffer_load_dword v8, v5, s[8:11], s65 offen sc1
    s_branch L_kv_epi
L_kv_nopf2:
    s_mov_b32 s70, 0
    s_waitcnt lgkmcnt(4)
    v_mfma_f32_16x16x32_bf16 v[48:51], a[80:83], v[32:35], v[48:51]
    ds_read_b128 v[24:27], v3 offset:6144
    v_mfma_f32_16x16x32_bf16 v[52:55], a[84:87], v[32:35], v[52:55]
    v_mfma_f32_16x16x32_bf16 v[64:67], v[32:35], a[224:227], v[64:67]
    v_mfma_f32_16x16x32_bf16 v[72:75], v[32:35], a[228:231], v[72:75]
    v_mfma_f32_16x16x32_bf16 v[56:59], a[80:83], v[36:39], v[56:59]
    ds_read_b128 v[28:31], v3 offset:24576
    v_mfma_f32_16x16x32_bf16 v[60:63], a[84:87], v[36:39], v[60:63]
    v_mfma_f32_16x16x32_bf16 v[68:71], v[36:39], a[224:227], v[68:71]
    v_mfma_f32_16x16x32_bf16 v[76:79], v[36:39], a[228:231], v[76:79]
    s_waitcnt lgkmcnt(4)
    v_mfma_f32_16x16x32_bf16 v[48:51], a[88:91], v[40:43], v[48:51]
    ds_read_b128 v[32:35], v2 offset:7168
    v_mfma_f32_16x16x32_bf16 v[52:55], a[92:95], v[40:43], v[52:55]
    v_mfma_f32_16x16x32_bf16 v[64:67], v[40:43], a[232:235], v[64:67]
    v_mfma_f32_16x16x32_bf16 v[72:75], v[40:43], a[236:239], v[72:75]
    v_mfma_f32_16x16x32_bf16 v[56:59], a[88:91], v[44:47], v[56:59]
    ds_read_b128 v[36:39], v2 offset:25600
    v_mfma_f32_16x16x32_bf16 v[60:63], a[92:95], v[44:47], v[60:63]
    v_mfma_f32_16x16x32_bf16 v[68:71], v[44:47], a[232:235], v[68:71]
    v_mfma_f32_16x16x32_bf16 v[76:79], v[44:47], a[236:239], v[76:79]
    s_waitcnt lgkmcnt(4)
    v_mfma_f32_16x16x32_bf16 v[48:51], a[96:99], v[16:19], v[48:51]
    ds_read_b128 v[40:43], v3 offset:7168
    v_mfma_f32_16x16x32_bf16 v[52:55], a[100:103], v[16:19], v[52:55]
    v_mfma_f32_16x16x32_bf16 v[64:67], v[16:19], a[240:243], v[64:67]
    v_mfma_f32_16x16x32_bf16 v[72:75], v[16:19], a[244:247], v[72:75]
    v_mfma_f32_16x16x32_bf16 v[56:59], a[96:99], v[20:23], v[56:59]
    ds_read_b128 v[44:47], v3 offset:25600
    v_mfma_f32_16x16x32_bf16 v[60:63], a[100:103], v[20:23], v[60:63]
    v_mfma_f32_16x16x32_bf16 v[68:71], v[20:23], a[240:243], v[68:71]
    v_mfma_f32_16x16x32_bf16 v[76:79], v[20:23], a[244:247], v[76:79]
    s_waitcnt lgkmcnt(4)
    v_mfma_f32_16x16x32_bf16 v[48:51], a[104:107], v[24:27], v[48:51]
    ds_read_b128 v[16:19], v2 offset:8192
    v_mfma_f32_16x16x32_bf16 v[52:55], a[108:111], v[24:27], v[52:55]
    v_mfma_f32_16x16x32_bf16 v[64:67], v[24:27], a[248:251], v[64:67]
    v_mfma_f32_16x16x32_bf16 v[72:75], v[24:27], a[252:255], v[72:75]
    v_mfma_f32_16x16x32_bf16 v[56:59], a[104:107], v[28:31], v[56:59]
    ds_read_b128 v[20:23], v2 offset:26624
    v_mfma_f32_16x16x32_bf16 v[60:63], a[108:111], v[28:31], v[60:63]
    v_mfma_f32_16x16x32_bf16 v[68:71], v[28:31], a[248:251], v[68:71]
    v_mfma_f32_16x16x32_bf16 v[76:79], v[28:31], a[252:255], v[76:79]
    s_waitcnt lgkmcnt(4)
    v_mfma_f32_16x16x32_bf16 v[48:51], a[112:115], v[32:35], v[48:51]
    ds_read_b128 v[24:27], v3 offset:8192
    v_mfma_f32_16x16x32_bf16 v[52:55], a[116:119], v[32:35], v[52:55]
    v_mfma_f32_16x16x32_bf16 v[64:67], v[32:35], v[224:227], v[64:67]
    v_mfma_f32_16x16x32_bf16 v[72:75], v[32:35], v[228:231], v[72:75]
    v_mfma_f32_16x16x32_bf16 v[56:59], a[112:115], v[36:39], v[56:59]
    ds_read_b128 v[28:31], v3 offset:26624
    v_mfma_f32_16x16x32_bf16 v[60:63], a[116:119], v[36:39], v[60:63]
    v_mfma_f32_16x16x32_bf16 v[68:71], v[36:39], v[224:227], v[68:71]
    v_mfma_f32_16x16x32_bf16 v[76:79], v[36:39], v[228:231], v[76:79]
    s_add_u32 s76, s67, 1
    s_min_u32 s76, s76, 63
    s_lshl_b32 s65, s76, s94
    s_add_u32 s65, s65, s95
    buffer_load_dword v9, v5, s[8:11], s65 offen sc1
L_kv_epi:
    s_waitcnt lgkmcnt(4)
    v_mfma_f32_16x16x32_bf16 v[48:51], a[120:123], v[40:43], v[48:51]
    s_add_u32 s78, s80, s67
    v_mfma_f32_16x16x32_bf16 v[52:55], a[124:127], v[40:43], v[52:55]
    s_lshl_b32 s69, s78, 2
    s_waitcnt lgkmcnt(2)
    v_mfma_f32_16x16x32_bf16 v[48:51], a[128:131], v[16:19], v[48:51]
    s_add_u32 s69, s69, 65536
    v_mfma_f32_16x16x32_bf16 v[52:55], a[132:135], v[16:19], v[52:55]
    s_mul_i32 s78, s67, 24576
    s_waitcnt lgkmcnt(0)
    v_mfma_f32_16x16x32_bf16 v[48:51], a[136:139], v[24:27], v[48:51]
    s_add_u32 s78, s78, s81
    v_mfma_f32_16x16x32_bf16 v[52:55], a[140:143], v[24:27], v[52:55]
    s_sub_u32 s79, s75, s68
    v_mfma_f32_16x16x32_bf16 v[56:59], a[120:123], v[44:47], v[56:59]
    v_add_u32 v2, s79, v2
    v_mfma_f32_16x16x32_bf16 v[60:63], a[124:127], v[44:47], v[60:63]
    v_add_u32 v3, s79, v3
    v_mfma_f32_16x16x32_bf16 v[56:59], a[128:131], v[20:23], v[56:59]
    v_mfma_f32_16x16x32_bf16 v[60:63], a[132:135], v[20:23], v[60:63]
    v_mfma_f32_16x16x32_bf16 v[56:59], a[136:139], v[28:31], v[56:59]
    v_mfma_f32_16x16x32_bf16 v[60:63], a[140:143], v[28:31], v[60:63]
    v_mfma_f32_16x16x32_bf16 v[64:67], v[40:43], v[232:235], v[64:67]
    v_cvt_pk_bf16_f32 v80, v48, v49
    v_cvt_pk_bf16_f32 v81, v50, v51
    v_mfma_f32_16x16x32_bf16 v[68:71], v[44:47], v[232:235], v[68:71]
    v_cvt_pk_bf16_f32 v82, v52, v53
    v_cvt_pk_bf16_f32 v83, v54, v55
    v_mfma_f32_16x16x32_bf16 v[64:67], v[16:19], v[240:243], v[64:67]
    buffer_store_dwordx4 v[80:83], v4, s[8:11], s78 offen offset:0 sc1
    v_mfma_f32_16x16x32_bf16 v[68:71], v[20:23], v[240:243], v[68:71]
    v_cvt_pk_bf16_f32 v84, v56, v57
    v_cvt_pk_bf16_f32 v85, v58, v59
    v_mfma_f32_16x16x32_bf16 v[64:67], v[24:27], v[248:251], v[64:67]
    v_cvt_pk_bf16_f32 v86, v60, v61
    v_cvt_pk_bf16_f32 v87, v62, v63
    v_mfma_f32_16x16x32_bf16 v[68:71], v[28:31], v[248:251], v[68:71]
    buffer_store_dwordx4 v[84:87], v4, s[8:11], s78 offen offset:1024 sc1
    v_mfma_f32_16x16x32_bf16 v[72:75], v[40:43], v[236:239], v[72:75]
    v_mfma_f32_16x16x32_bf16 v[76:79], v[44:47], v[236:239], v[76:79]
    v_mfma_f32_16x16x32_bf16 v[72:75], v[16:19], v[244:247], v[72:75]
    v_cvt_pk_bf16_f32 v88, v64, v65
    v_cvt_pk_bf16_f32 v89, v66, v67
    v_mfma_f32_16x16x32_bf16 v[76:79], v[20:23], v[244:247], v[76:79]
    v_cvt_pk_bf16_f32 v90, v68, v69
    v_cvt_pk_bf16_f32 v91, v70, v71
    v_mfma_f32_16x16x32_bf16 v[72:75], v[24:27], v[252:255], v[72:75]
    buffer_store_dwordx4 v[88:91], v4, s[8:11], s78 offen offset:2048 sc1
    v_mfma_f32_16x16x32_bf16 v[76:79], v[28:31], v[252:255], v[76:79]
    s_nop 3
    v_cvt_pk_bf16_f32 v92, v72, v73
    v_cvt_pk_bf16_f32 v93, v74, v75
    s_nop 1
    v_cvt_pk_bf16_f32 v94, v76, v77
    v_cvt_pk_bf16_f32 v95, v78, v79
    buffer_store_dwordx4 v[92:95], v4, s[8:11], s78 offen offset:3072 sc1
    s_cmp_eq_u32 s67, 63
    s_cbranch_scc1 L_kv_done
    s_mov_b32 s67, s74
    s_mov_b32 s68, s75
    s_waitcnt vmcnt(4)
    s_cmp_eq_u32 s70, 1
    s_cbranch_scc1 L_kv_loop
    v_mov_b32 v8, 0
    v_cmp_eq_u32 vcc, 0, v9
    s_cbranch_vccnz L_kv_spin
    s_add_u32 m0, s73, 0
    s_nop 0
    buffer_load_dwordx4 v1, s[8:11], s72 offen offset:0 sc1 lds
    s_add_u32 m0, s73, 896
    s_nop 0
    buffer_load_dwordx4 v1, s[8:11], s72 offen offset:128 sc1 lds
    s_add_u32 m0, s73, 1792
    s_nop 0
    buffer_load_dwordx4 v1, s[8:11], s72 offen offset:256 sc1 lds
    s_add_u32 m0, s73, 2688
    s_nop 0
    buffer_load_dwordx4 v1, s[8:11], s72 offen offset:384 sc1 lds
    s_add_u32 m0, s73, 3584
    s_nop 0
    buffer_load_dwordx4 v1, s[8:11], s72 offen offset:512 sc1 lds
    s_add_u32 m0, s73, 4480
    s_nop 0
    buffer_load_dwordx4 v1, s[8:11], s72 offen offset:640 sc1 lds
    s_add_u32 m0, s73, 5376
    s_nop 0
    buffer_load_dwordx4 v1, s[8:11], s72 offen offset:768 sc1 lds
    s_add_u32 m0, s73, 6272
    s_nop 0
    buffer_load_dwordx4 v1, s[8:11], s72 offen offset:896 sc1 lds
    s_add_u32 m0, s73, 7168
    s_nop 0
    buffer_load_dwordx4 v1, s[8:11], s72 offen offset:1024 sc1 lds
    s_cmp_eq_u32 s69, 0
    s_cbranch_scc1 L_fl_29
    s_waitcnt vmcnt(9)
    s_mov_b64 exec, 1
    buffer_store_dword v10, v11, s[8:11], s69 offen sc1
    s_mov_b64 exec, -1
    s_mov_b32 s69, 0
L_fl_29:
    s_waitcnt vmcnt(1)
    s_branch L_kv_loop
L_kv_spin:
    s_cmp_eq_u32 s69, 0
    s_cbranch_scc1 L_fl_30
    s_waitcnt vmcnt(0)
    s_mov_b64 exec, 1
    buffer_store_dword v10, v11, s[8:11], s69 offen sc1
    s_mov_b64 exec, -1
    s_mov_b32 s69, 0
L_fl_30:
    s_lshl_b32 s65, s67, s94
    s_add_u32 s65, s65, s95
    s_mov_b32 s60, 1048576
L_poll_31:
    buffer_load_dword v9, v5, s[8:11], s65 offen sc1
    s_waitcnt vmcnt(0)
    v_cmp_eq_u32 vcc, 0, v9
    s_cbranch_vccz L_pdone_32
    s_sleep 2
    s_sub_u32 s60, s60, 1
    s_cbranch_scc1 L_abort
    s_branch L_poll_31
L_pdone_32:
    s_add_u32 m0, s73, 0
    s_nop 0
    buffer_load_dwordx4 v1, s[8:11], s72 offen offset:0 sc1 lds
    s_add_u32 m0, s73, 896
    s_nop 0
    buffer_load_dwordx4 v1, s[8:11], s72 offen offset:128 sc1 lds
    s_add_u32 m0, s73, 1792
    s_nop 0
    buffer_load_dwordx4 v1, s[8:11], s72 offen offset:256 sc1 lds
    s_add_u32 m0, s73, 2688
    s_nop 0
    buffer_load_dwordx4 v1, s[8:11], s72 offen offset:384 sc1 lds
    s_add_u32 m0, s73, 3584
    s_nop 0
    buffer_load_dwordx4 v1, s[8:11], s72 offen offset:512 sc1 lds
    s_add_u32 m0, s73, 4480
    s_nop 0
    buffer_load_dwordx4 v1, s[8:11], s72 offen offset:640 sc1 lds
    s_add_u32 m0, s73, 5376
    s_nop 0
    buffer_load_dwordx4 v1, s[8:11], s72 offen offset:768 sc1 lds
    s_add_u32 m0, s73, 6272
    s_nop 0
    buffer_load_dwordx4 v1, s[8:11], s72 offen offset:896 sc1 lds
    s_add_u32 m0, s73, 7168
    s_nop 0
    buffer_load_dwordx4 v1, s[8:11], s72 offen offset:1024 sc1 lds
    s_waitcnt vmcnt(0)
    s_branch L_kv_loop
L_kv_done:
    s_cmp_eq_u32 s69, 0
    s_cbranch_scc1 L_fl_33
    s_waitcnt vmcnt(0)
    s_mov_b64 exec, 1
    buffer_store_dword v10, v11, s[8:11], s69 offen sc1
    s_mov_b64 exec, -1
    s_mov_b32 s69, 0
L_fl_33:
    s_endpgm
L_qo:
    s_lshr_b32 s66, s4, 2
    s_mul_i32 s71, s3, 40960
    v_lshlrev_b32 v4, 4, v0
    v_lshrrev_b32 v8, 3, v0
    v_mul_u32_u24 v1, 1152, v8
    v_lshrrev_b32 v8, 4, v0
    s_lshl_b32 s63, s3, 2
    v_add_u32 v9, s63, v8
    v_xor_b32 v9, v9, v0
    v_and_b32 v9, 7, v9
    v_lshl_add_u32 v1, v9, 4, v1
    v_bfe_u32 v9, v0, 3, 1
    v_mul_u32_u24 v2, 9216, v9
    v_and_b32 v9, 7, v0
    v_lshl_add_u32 v2, v9, 7, v2
    s_cmp_eq_u32 s66, 0
    s_cselect_b32 s63, 2, 8
    v_lshlrev_b32 v5, s63, v9
    s_cselect_b32 s94, 7, 2
    s_cselect_b32 s63, 5, 11
    s_lshl_b32 s95, s3, s63
    s_lshl_b32 s63, s66, 13
    s_add_u32 s95, s95, s63
    s_add_u32 s95, s95, 16384
    v_bfe_u32 v9, v0, 1, 3
    v_xor_b32 v9, v9, v8
    v_lshl_add_u32 v2, v9, 4, v2
    v_xor_b32 v3, 64, v2
    s_mov_b32 s48, s32
    s_mov_b32 s49, s33
    s_mov_b32 s50, 4718592
    s_mov_b32 s51, 0x20000
    s_mov_b32 s52, s38
    s_mov_b32 s53, s39
    s_mov_b32 s54, 4718592
    s_mov_b32 s55, 0x20000
    s_mov_b32 s56, s42
    s_mov_b32 s57, s43
    s_mov_b32 s58, 2359296
    s_mov_b32 s59, 0x20000
    v_lshrrev_b32 v31, 3, v0
    v_and_b32 v33, 7, v0
    v_lshlrev_b32 v30, 13, v31
    v_lshl_add_u32 v30, v33, 4, v30
    v_mul_u32_u24 v31, 1152, v31
    v_lshl_add_u32 v31, v33, 4, v31
    v_lshrrev_b32 v32, 1, v0
    v_mul_u32_u24 v32, 1152, v32
    v_and_b32 v33, 1, v0
    v_lshl_add_u32 v32, v33, 4, v32
    v_lshrrev_b32 v33, 4, v0
    v_bfe_u32 v34, v0, 2, 2
    v_and_b32 v35, 3, v0
    v_lshl_add_u32 v40, v33, 3, v34
    v_lshlrev_b32 v40, 7, v40
    v_lshl_add_u32 v40, v35, 3, v40
    s_and_b32 s63, s3, 2
    s_mul_i32 s63, s63, 40960
    s_and_b32 s64, s3, 1
    s_lshl_b32 s65, s64, 6
    s_add_u32 s63, s63, s65
    s_add_u32 s63, s63, 0
    v_add_u32 v40, s63, v40
    v_add_u32 v41, 40960, v40
    s_lshl_b32 s72, s5, 8
    s_lshr_b32 s63, s3, 1
    s_lshl_b32 s63, s63, 7
    s_add_u32 s72, s72, s63
    s_lshl_b32 s63, s64, 18
    s_add_u32 s76, s72, s63
    s_lshl_b32 s63, s64, 19
    s_add_u32 s72, s72, s63
    v_lshl_add_u32 v37, v33, 2, v34
    v_lshlrev_b32 v38, 5, v37
    v_lshl_add_u32 v38, v35, 3, v38
    v_add_u32 v38, s71, v38
    v_lshlrev_b32 v37, 7, v37
    v_lshl_add_u32 v37, v35, 3, v37
    v_add_u32 v37, s71, v37
    s_mul_i32 s73, s5, 147456
    s_lshl_b32 s74, s3, 5
    s_add_u32 s74, s74, s73
    s_lshl_b32 s75, s3, 8
    s_add_u32 s73, s73, s75
    s_barrier
    s_add_u32 m0, s71, 0
    s_add_u32 s63, s72, 0
    buffer_load_dwordx4 v30, s[48:51], s63 offen  lds
    s_add_u32 m0, s71, 1024
    s_add_u32 s63, s72, 65536
    buffer_load_dwordx4 v30, s[48:51], s63 offen  lds
    s_add_u32 m0, s71, 2048
    s_add_u32 s63, s72, 131072
    buffer_load_dwordx4 v30, s[48:51], s63 offen  lds
    s_add_u32 m0, s71, 3072
    s_add_u32 s63, s72, 196608
    buffer_load_dwordx4 v30, s[48:51], s63 offen  lds
    s_add_u32 m0, s71, 4096
    s_add_u32 s63, s72, 262144
    buffer_load_dwordx4 v30, s[48:51], s63 offen  lds
    s_add_u32 m0, s71, 5120
    s_add_u32 s63, s72, 327680
    buffer_load_dwordx4 v30, s[48:51], s63 offen  lds
    s_add_u32 m0, s71, 6144
    s_add_u32 s63, s72, 393216
    buffer_load_dwordx4 v30, s[48:51], s63 offen  lds
    s_add_u32 m0, s71, 7168
    s_add_u32 s63, s72, 458752
    buffer_load_dwordx4 v30, s[48:51], s63 offen  lds
    s_add_u32 m0, s71, 8192
    s_add_u32 s63, s72, 1048576
    buffer_load_dwordx4 v30, s[48:51], s63 offen  lds
    s_add_u32 m0, s71, 9216
    s_add_u32 s63, s72, 1114112
    buffer_load_dwordx4 v30, s[48:51], s63 offen  lds
    s_add_u32 m0, s71, 10240
    s_add_u32 s63, s72, 1179648
    buffer_load_dwordx4 v30, s[48:51], s63 offen  lds
    s_add_u32 m0, s71, 11264
    s_add_u32 s63, s72, 1245184
    buffer_load_dwordx4 v30, s[48:51], s63 offen  lds
    s_add_u32 m0, s71, 12288
    s_add_u32 s63, s72, 1310720
    buffer_load_dwordx4 v30, s[48:51], s63 offen  lds
    s_add_u32 m0, s71, 13312
    s_add_u32 s63, s72, 1376256
    buffer_load_dwordx4 v30, s[48:51], s63 offen  lds
    s_add_u32 m0, s71, 14336
    s_add_u32 s63, s72, 1441792
    buffer_load_dwordx4 v30, s[48:51], s63 offen  lds
    s_add_u32 m0, s71, 15360
    s_add_u32 s63, s72, 1507328
    buffer_load_dwordx4 v30, s[48:51], s63 offen  lds
    s_add_u32 m0, s71, 16384
    s_add_u32 s63, s72, 2097152
    buffer_load_dwordx4 v30, s[48:51], s63 offen  lds
    s_add_u32 m0, s71, 17408
    s_add_u32 s63, s72, 2162688
    buffer_load_dwordx4 v30, s[48:51], s63 offen  lds
    s_add_u32 m0, s71, 18432
    s_add_u32 s63, s72, 2228224
    buffer_load_dwordx4 v30, s[48:51], s63 offen  lds
    s_add_u32 m0, s71, 19456
    s_add_u32 s63, s72, 2293760
    buffer_load_dwordx4 v30, s[48:51], s63 offen  lds
    s_add_u32 m0, s71, 20480
    s_add_u32 s63, s72, 2359296
    buffer_load_dwordx4 v30, s[48:51], s63 offen  lds
    s_add_u32 m0, s71, 21504
    s_add_u32 s63, s72, 2424832
    buffer_load_dwordx4 v30, s[48:51], s63 offen  lds
    s_add_u32 m0, s71, 22528
    s_add_u32 s63, s72, 2490368
    buffer_load_dwordx4 v30, s[48:51], s63 offen  lds
    s_add_u32 m0, s71, 23552
    s_add_u32 s63, s72, 2555904
    buffer_load_dwordx4 v30, s[48:51], s63 offen  lds
    s_waitcnt vmcnt(16)
    s_barrier
    ds_read_b64_tr_b16 a[0:1], v40 offset:0
    ds_read_b64_tr_b16 a[2:3], v40 offset:512
    ds_read_b64_tr_b16 a[4:5], v40 offset:32
    ds_read_b64_tr_b16 a[6:7], v40 offset:544
    ds_read_b64_tr_b16 a[8:9], v40 offset:4096
    ds_read_b64_tr_b16 a[10:11], v40 offset:4608
    ds_read_b64_tr_b16 a[12:13], v40 offset:4128
    ds_read_b64_tr_b16 a[14:15], v40 offset:4640
    ds_read_b64_tr_b16 a[16:17], v41 offset:0
    ds_read_b64_tr_b16 a[18:19], v41 offset:512
    ds_read_b64_tr_b16 a[20:21], v41 offset:32
    ds_read_b64_tr_b16 a[22:23], v41 offset:544
    s_waitcnt lgkmcnt(4)
    ds_read_b64_tr_b16 a[24:25], v41 offset:4096
    ds_read_b64_tr_b16 a[26:27], v41 offset:4608
    ds_read_b64_tr_b16 a[28:29], v41 offset:4128
    ds_read_b64_tr_b16 a[30:31], v41 offset:4640
    s_add_u32 m0, s71, 24576
    s_add_u32 s63, s72, 3145728
    buffer_load_dwordx4 v30, s[48:51], s63 offen  lds
    s_add_u32 m0, s71, 25600
    s_add_u32 s63, s72, 3211264
    buffer_load_dwordx4 v30, s[48:51], s63 offen  lds
    s_add_u32 m0, s71, 26624
    s_add_u32 s63, s72, 3276800
    buffer_load_dwordx4 v30, s[48:51], s63 offen  lds
    s_add_u32 m0, s71, 27648
    s_add_u32 s63, s72, 3342336
    buffer_load_dwordx4 v30, s[48:51], s63 offen  lds
    s_add_u32 m0, s71, 28672
    s_add_u32 s63, s72, 3407872
    buffer_load_dwordx4 v30, s[48:51], s63 offen  lds
    s_add_u32 m0, s71, 29696
    s_add_u32 s63, s72, 3473408
    buffer_load_dwordx4 v30, s[48:51], s63 offen  lds
    s_add_u32 m0, s71, 30720
    s_add_u32 s63, s72, 3538944
    buffer_load_dwordx4 v30, s[48:51], s63 offen  lds
    s_add_u32 m0, s71, 31744
    s_add_u32 s63, s72, 3604480
    buffer_load_dwordx4 v30, s[48:51], s63 offen  lds
    s_waitcnt lgkmcnt(0)
    s_waitcnt vmcnt(16)
    s_barrier
    ds_read_b64_tr_b16 a[32:33], v40 offset:8192
    ds_read_b64_tr_b16 a[34:35], v40 offset:8704
    ds_read_b64_tr_b16 a[36:37], v40 offset:8224
    ds_read_b64_tr_b16 a[38:39], v40 offset:8736
    ds_read_b64_tr_b16 a[40:41], v40 offset:12288
    ds_read_b64_tr_b16 a[42:43], v40 offset:12800
    ds_read_b64_tr_b16 a[44:45], v40 offset:12320
    ds_read_b64_tr_b16 a[46:47], v40 offset:12832
    ds_read_b64_tr_b16 a[48:49], v41 offset:8192
    ds_read_b64_tr_b16 a[50:51], v41 offset:8704
    ds_read_b64_tr_b16 a[52:53], v41 offset:8224
    ds_read_b64_tr_b16 a[54:55], v41 offset:8736
    s_waitcnt lgkmcnt(4)
    ds_read_b64_tr_b16 a[56:57], v41 offset:12288
    ds_read_b64_tr_b16 a[58:59], v41 offset:12800
    ds_read_b64_tr_b16 a[60:61], v41 offset:12320
    ds_read_b64_tr_b16 a[62:63], v41 offset:12832
    s_add_u32 m0, s71, 32768
    s_add_u32 s63, s76, 4194304
    buffer_load_dwordx4 v30, s[48:51], s63 offen  lds
    s_add_u32 m0, s71, 33792
    s_add_u32 s63, s76, 4259840
    buffer_load_dwordx4 v30, s[48:51], s63 offen  lds
    s_add_u32 m0, s71, 34816
    s_add_u32 s63, s76, 4325376
    buffer_load_dwordx4 v30, s[48:51], s63 offen  lds
    s_add_u32 m0, s71, 35840
    s_add_u32 s63, s76, 4390912
    buffer_load_dwordx4 v30, s[48:51], s63 offen  lds
    s_waitcnt lgkmcnt(0)
    s_waitcnt vmcnt(12)
    s_barrier
    ds_read_b64_tr_b16 a[64:65], v40 offset:16384
    ds_read_b64_tr_b16 a[66:67], v40 offset:16896
    ds_read_b64_tr_b16 a[68:69], v40 offset:16416
    ds_read_b64_tr_b16 a[70:71], v40 offset:16928
    ds_read_b64_tr_b16 a[72:73], v40 offset:20480
    ds_read_b64_tr_b16 a[74:75], v40 offset:20992
    ds_read_b64_tr_b16 a[76:77], v40 offset:20512
    ds_read_b64_tr_b16 a[78:79], v40 offset:21024
    ds_read_b64_tr_b16 a[80:81], v41 offset:16384
    ds_read_b64_tr_b16 a[82:83], v41 offset:16896
    ds_read_b64_tr_b16 a[84:85], v41 offset:16416
    ds_read_b64_tr_b16 a[86:87], v41 offset:16928
    s_waitcnt lgkmcnt(4)
    ds_read_b64_tr_b16 a[88:89], v41 offset:20480
    ds_read_b64_tr_b16 a[90:91], v41 offset:20992
    ds_read_b64_tr_b16 a[92:93], v41 offset:20512
    ds_read_b64_tr_b16 a[94:95], v41 offset:21024
    s_add_u32 m0, s71, 0
    s_add_u32 s63, s73, 0
    buffer_load_dwordx4 v31, s[52:55], s63 offen  lds
    s_add_u32 m0, s71, 1024
    s_add_u32 s63, s73, 9216
    buffer_load_dwordx4 v31, s[52:55], s63 offen  lds
    s_add_u32 m0, s71, 2048
    s_add_u32 s63, s73, 18432
    buffer_load_dwordx4 v31, s[52:55], s63 offen  lds
    s_add_u32 m0, s71, 3072
    s_add_u32 s63, s73, 27648
    buffer_load_dwordx4 v31, s[52:55], s63 offen  lds
    s_add_u32 m0, s71, 4096
    s_add_u32 s63, s73, 128
    buffer_load_dwordx4 v31, s[52:55], s63 offen  lds
    s_add_u32 m0, s71, 5120
    s_add_u32 s63, s73, 9344
    buffer_load_dwordx4 v31, s[52:55], s63 offen  lds
    s_add_u32 m0, s71, 6144
    s_add_u32 s63, s73, 18560
    buffer_load_dwordx4 v31, s[52:55], s63 offen  lds
    s_add_u32 m0, s71, 7168
    s_add_u32 s63, s73, 27776
    buffer_load_dwordx4 v31, s[52:55], s63 offen  lds
    s_waitcnt lgkmcnt(0)
    s_waitcnt vmcnt(12)
    s_barrier
    ds_read_b64_tr_b16 a[96:97], v40 offset:24576
    ds_read_b64_tr_b16 a[98:99], v40 offset:25088
    ds_read_b64_tr_b16 a[100:101], v40 offset:24608
    ds_read_b64_tr_b16 a[102:103], v40 offset:25120
    ds_read_b64_tr_b16 a[104:105], v40 offset:28672
    ds_read_b64_tr_b16 a[106:107], v40 offset:29184
    ds_read_b64_tr_b16 a[108:109], v40 offset:28704
    ds_read_b64_tr_b16 a[110:111], v40 offset:29216
    ds_read_b64_tr_b16 a[112:113], v41 offset:24576
    ds_read_b64_tr_b16 a[114:115], v41 offset:25088
    ds_read_b64_tr_b16 a[116:117], v41 offset:24608
    ds_read_b64_tr_b16 a[118:119], v41 offset:25120
    s_waitcnt lgkmcnt(4)
    ds_read_b64_tr_b16 a[120:121], v41 offset:28672
    ds_read_b64_tr_b16 a[122:123], v41 offset:29184
    ds_read_b64_tr_b16 a[124:125], v41 offset:28704
    ds_read_b64_tr_b16 a[126:127], v41 offset:29216
    s_add_u32 m0, s71, 8192
    s_add_u32 s63, s73, 36864
    buffer_load_dwordx4 v31, s[52:55], s63 offen  lds
    s_add_u32 m0, s71, 9216
    s_add_u32 s63, s73, 46080
    buffer_load_dwordx4 v31, s[52:55], s63 offen  lds
    s_add_u32 m0, s71, 10240
    s_add_u32 s63, s73, 55296
    buffer_load_dwordx4 v31, s[52:55], s63 offen  lds
    s_add_u32 m0, s71, 11264
    s_add_u32 s63, s73, 64512
    buffer_load_dwordx4 v31, s[52:55], s63 offen  lds
    s_add_u32 m0, s71, 12288
    s_add_u32 s63, s73, 36992
    buffer_load_dwordx4 v31, s[52:55], s63 offen  lds
    s_add_u32 m0, s71, 13312
    s_add_u32 s63, s73, 46208
    buffer_load_dwordx4 v31, s[52:55], s63 offen  lds
    s_add_u32 m0, s71, 14336
    s_add_u32 s63, s73, 55424
    buffer_load_dwordx4 v31, s[52:55], s63 offen  lds
    s_add_u32 m0, s71, 15360
    s_add_u32 s63, s73, 64640
    buffer_load_dwordx4 v31, s[52:55], s63 offen  lds
    s_waitcnt lgkmcnt(0)
    s_waitcnt vmcnt(16)
    s_barrier
    ds_read_b64_tr_b16 a[128:129], v40 offset:32768
    ds_read_b64_tr_b16 a[130:131], v40 offset:33280
    ds_read_b64_tr_b16 a[136:137], v41 offset:32768
    ds_read_b64_tr_b16 a[138:139], v41 offset:33280
    ds_read_b64_tr_b16 a[132:133], v40 offset:32800
    ds_read_b64_tr_b16 a[134:135], v40 offset:33312
    ds_read_b64_tr_b16 a[140:141], v41 offset:32800
    ds_read_b64_tr_b16 a[142:143], v41 offset:33312
    s_add_u32 m0, s71, 16384
    s_add_u32 s63, s73, 73728
    buffer_load_dwordx4 v31, s[52:55], s63 offen  lds
    s_add_u32 m0, s71, 17408
    s_add_u32 s63, s73, 82944
    buffer_load_dwordx4 v31, s[52:55], s63 offen  lds
    s_add_u32 m0, s71, 18432
    s_add_u32 s63, s73, 92160
    buffer_load_dwordx4 v31, s[52:55], s63 offen  lds
    s_add_u32 m0, s71, 19456
    s_add_u32 s63, s73, 101376
    buffer_load_dwordx4 v31, s[52:55], s63 offen  lds
    s_add_u32 m0, s71, 20480
    s_add_u32 s63, s73, 73856
    buffer_load_dwordx4 v31, s[52:55], s63 offen  lds
    s_add_u32 m0, s71, 21504
    s_add_u32 s63, s73, 83072
    buffer_load_dwordx4 v31, s[52:55], s63 offen  lds
    s_add_u32 m0, s71, 22528
    s_add_u32 s63, s73, 92288
    buffer_load_dwordx4 v31, s[52:55], s63 offen  lds
    s_add_u32 m0, s71, 23552
    s_add_u32 s63, s73, 101504
    buffer_load_dwordx4 v31, s[52:55], s63 offen  lds
    s_waitcnt lgkmcnt(0)
    s_waitcnt vmcnt(16)
    s_barrier
    ds_read_b64_tr_b16 a[144:145], v37 offset:0
    ds_read_b64_tr_b16 a[146:147], v37 offset:2048
    ds_read_b64_tr_b16 a[160:161], v37 offset:32
    ds_read_b64_tr_b16 a[162:163], v37 offset:2080
    ds_read_b64_tr_b16 a[176:177], v37 offset:64
    ds_read_b64_tr_b16 a[178:179], v37 offset:2112
    ds_read_b64_tr_b16 a[192:193], v37 offset:96
    ds_read_b64_tr_b16 a[194:195], v37 offset:2144
    ds_read_b64_tr_b16 a[208:209], v37 offset:4096
    ds_read_b64_tr_b16 a[210:211], v37 offset:6144
    ds_read_b64_tr_b16 a[224:225], v37 offset:4128
    ds_read_b64_tr_b16 a[226:227], v37 offset:6176
    s_waitcnt lgkmcnt(4)
    ds_read_b64_tr_b16 a[240:241], v37 offset:4160
    ds_read_b64_tr_b16 a[242:243], v37 offset:6208
    ds_read_b64_tr_b16 v[224:225], v37 offset:4192
    ds_read_b64_tr_b16 v[226:227], v37 offset:6240
    s_add_u32 m0, s71, 24576
    s_add_u32 s63, s73, 110592
    buffer_load_dwordx4 v31, s[52:55], s63 offen  lds
    s_add_u32 m0, s71, 25600
    s_add_u32 s63, s73, 119808
    buffer_load_dwordx4 v31, s[52:55], s63 offen  lds
    s_add_u32 m0, s71, 26624
    s_add_u32 s63, s73, 129024
    buffer_load_dwordx4 v31, s[52:55], s63 offen  lds
    s_add_u32 m0, s71, 27648
    s_add_u32 s63, s73, 138240
    buffer_load_dwordx4 v31, s[52:55], s63 offen  lds
    s_add_u32 m0, s71, 28672
    s_add_u32 s63, s73, 110720
    buffer_load_dwordx4 v31, s[52:55], s63 offen  lds
    s_add_u32 m0, s71, 29696
    s_add_u32 s63, s73, 119936
    buffer_load_dwordx4 v31, s[52:55], s63 offen  lds
    s_add_u32 m0, s71, 30720
    s_add_u32 s63, s73, 129152
    buffer_load_dwordx4 v31, s[52:55], s63 offen  lds
    s_add_u32 m0, s71, 31744
    s_add_u32 s63, s73, 138368
    buffer_load_dwordx4 v31, s[52:55], s63 offen  lds
    s_waitcnt lgkmcnt(0)
    s_waitcnt vmcnt(16)
    s_barrier
    ds_read_b64_tr_b16 a[148:149], v37 offset:8192
    ds_read_b64_tr_b16 a[150:151], v37 offset:10240
    ds_read_b64_tr_b16 a[164:165], v37 offset:8224
    ds_read_b64_tr_b16 a[166:167], v37 offset:10272
    ds_read_b64_tr_b16 a[180:181], v37 offset:8256
    ds_read_b64_tr_b16 a[182:183], v37 offset:10304
    ds_read_b64_tr_b16 a[196:197], v37 offset:8288
    ds_read_b64_tr_b16 a[198:199], v37 offset:10336
    ds_read_b64_tr_b16 a[212:213], v37 offset:12288
    ds_read_b64_tr_b16 a[214:215], v37 offset:14336
    ds_read_b64_tr_b16 a[228:229], v37 offset:12320
    ds_read_b64_tr_b16 a[230:231], v37 offset:14368
    s_waitcnt lgkmcnt(4)
    ds_read_b64_tr_b16 a[244:245], v37 offset:12352
    ds_read_b64_tr_b16 a[246:247], v37 offset:14400
    ds_read_b64_tr_b16 v[228:229], v37 offset:12384
    ds_read_b64_tr_b16 v[230:231], v37 offset:14432
    s_add_u32 m0, s71, 32768
    s_add_u32 s63, s74, 1024
    buffer_load_dwordx4 v32, s[52:55], s63 offen  lds
    s_add_u32 m0, s71, 33792
    s_add_u32 s63, s74, 37888
    buffer_load_dwordx4 v32, s[52:55], s63 offen  lds
    s_add_u32 m0, s71, 34816
    s_add_u32 s63, s74, 74752
    buffer_load_dwordx4 v32, s[52:55], s63 offen  lds
    s_add_u32 m0, s71, 35840
    s_add_u32 s63, s74, 111616
    buffer_load_dwordx4 v32, s[52:55], s63 offen  lds
    s_waitcnt lgkmcnt(0)
    s_waitcnt vmcnt(12)
    s_barrier
    ds_read_b64_tr_b16 a[152:153], v37 offset:16384
    ds_read_b64_tr_b16 a[154:155], v37 offset:18432
    ds_read_b64_tr_b16 a[168:169], v37 offset:16416
    ds_read_b64_tr_b16 a[170:171], v37 offset:18464
    ds_read_b64_tr_b16 a[184:185], v37 offset:16448
    ds_read_b64_tr_b16 a[186:187], v37 offset:18496
    ds_read_b64_tr_b16 a[200:201], v37 offset:16480
    ds_read_b64_tr_b16 a[202:203], v37 offset:18528
    ds_read_b64_tr_b16 a[216:217], v37 offset:20480
    ds_read_b64_tr_b16 a[218:219], v37 offset:22528
    ds_read_b64_tr_b16 a[232:233], v37 offset:20512
    ds_read_b64_tr_b16 a[234:235], v37 offset:22560
    s_waitcnt lgkmcnt(4)
    ds_read_b64_tr_b16 a[248:249], v37 offset:20544
    ds_read_b64_tr_b16 a[250:251], v37 offset:22592
    ds_read_b64_tr_b16 v[232:233], v37 offset:20576
    ds_read_b64_tr_b16 v[234:235], v37 offset:22624
    s_waitcnt lgkmcnt(0)
    s_cmp_ge_u32 s4, 3
    s_cbranch_scc1 L_cend_35
    s_mov_b32 s60, 1048576
    s_lshl_b32 s63, s7, 3
    s_add_u32 s64, s44, s63
    s_addc_u32 s65, s45, 0
    s_load_dwordx2 s[78:79], s[64:65], 0
    s_load_dwordx2 s[80:81], s[64:65], 32
    s_load_dwordx2 s[82:83], s[64:65], 64
    s_load_dwordx2 s[84:85], s[64:65], 96
    s_load_dwordx2 s[86:87], s[64:65], 128
    s_load_dwordx2 s[88:89], s[64:65], 160
    s_load_dwordx2 s[90:91], s[64:65], 192
    s_load_dwordx2 s[92:93], s[64:65], 224
L_cen_34:
    s_waitcnt lgkmcnt(0)
    s_mov_b32 s63, 0
    s_mov_b32 vcc_lo, 0
    s_mov_b32 vcc_hi, 0
    s_not_b32 s78, s78
    s_or_b32 vcc_hi, vcc_hi, s78
    s_and_b32 s78, s79, 0xff
    s_or_b32 vcc_hi, vcc_hi, s78
    s_lshr_b32 s79, s79, 8
    s_add_u32 s63, s63, s79
    s_xor_b32 s79, s79, 32
    s_or_b32 vcc_lo, vcc_lo, s79
    s_not_b32 s80, s80
    s_or_b32 vcc_hi, vcc_hi, s80
    s_and_b32 s80, s81, 0xff
    s_or_b32 vcc_hi, vcc_hi, s80
    s_lshr_b32 s81, s81, 8
    s_add_u32 s63, s63, s81
    s_xor_b32 s81, s81, 32
    s_or_b32 vcc_lo, vcc_lo, s81
    s_not_b32 s82, s82
    s_or_b32 vcc_hi, vcc_hi, s82
    s_and_b32 s82, s83, 0xff
    s_or_b32 vcc_hi, vcc_hi, s82
    s_lshr_b32 s83, s83, 8
    s_add_u32 s63, s63, s83
    s_xor_b32 s83, s83, 32
    s_or_b32 vcc_lo, vcc_lo, s83
    s_not_b32 s84, s84
    s_or_b32 vcc_hi, vcc_hi, s84
    s_and_b32 s84, s85, 0xff
    s_or_b32 vcc_hi, vcc_hi, s84
    s_lshr_b32 s85, s85, 8
    s_add_u32 s63, s63, s85
    s_xor_b32 s85, s85, 32
    s_or_b32 vcc_lo, vcc_lo, s85
    s_not_b32 s86, s86
    s_or_b32 vcc_hi, vcc_hi, s86
    s_and_b32 s86, s87, 0xff
    s_or_b32 vcc_hi, vcc_hi, s86
    s_lshr_b32 s87, s87, 8
    s_add_u32 s63, s63, s87
    s_xor_b32 s87, s87, 32
    s_or_b32 vcc_lo, vcc_lo, s87
    s_not_b32 s88, s88
    s_or_b32 vcc_hi, vcc_hi, s88
    s_and_b32 s88, s89, 0xff
    s_or_b32 vcc_hi, vcc_hi, s88
    s_lshr_b32 s89, s89, 8
    s_add_u32 s63, s63, s89
    s_xor_b32 s89, s89, 32
    s_or_b32 vcc_lo, vcc_lo, s89
    s_not_b32 s90, s90
    s_or_b32 vcc_hi, vcc_hi, s90
    s_and_b32 s90, s91, 0xff
    s_or_b32 vcc_hi, vcc_hi, s90
    s_lshr_b32 s91, s91, 8
    s_add_u32 s63, s63, s91
    s_xor_b32 s91, s91, 32
    s_or_b32 vcc_lo, vcc_lo, s91
    s_not_b32 s92, s92
    s_or_b32 vcc_hi, vcc_hi, s92
    s_and_b32 s92, s93, 0xff
    s_or_b32 vcc_hi, vcc_hi, s92
    s_lshr_b32 s93, s93, 8
    s_add_u32 s63, s63, s93
    s_xor_b32 s93, s93, 32
    s_or_b32 vcc_lo, vcc_lo, s93
    s_or_b32 vcc_hi, vcc_hi, vcc_lo
    s_cbranch_scc0 L_cend_35
    s_cmp_ge_u32 s63, 256
    s_cbranch_scc1 L_renumber
    s_sleep 16
    s_sub_u32 s60, s60, 1
    s_cbranch_scc1 L_abort
    s_load_dwordx2 s[78:79], s[64:65], 0 glc
    s_load_dwordx2 s[80:81], s[64:65], 32 glc
    s_load_dwordx2 s[82:83], s[64:65], 64 glc
    s_load_dwordx2 s[84:85], s[64:65], 96 glc
    s_load_dwordx2 s[86:87], s[64:65], 128 glc
    s_load_dwordx2 s[88:89], s[64:65], 160 glc
    s_load_dwordx2 s[90:91], s[64:65], 192 glc
    s_load_dwordx2 s[92:93], s[64:65], 224 glc
    s_branch L_cen_34
L_cend_35:
    s_waitcnt vmcnt(4)
    s_barrier
    ds_read_b64_tr_b16 a[156:157], v37 offset:24576
    ds_read_b64_tr_b16 a[158:159], v37 offset:26624
    ds_read_b64_tr_b16 a[172:173], v37 offset:24608
    ds_read_b64_tr_b16 a[174:175], v37 offset:26656
    ds_read_b64_tr_b16 a[188:189], v37 offset:24640
    ds_read_b64_tr_b16 a[190:191], v37 offset:26688
    ds_read_b64_tr_b16 a[204:205], v37 offset:24672
    ds_read_b64_tr_b16 a[206:207], v37 offset:26720
    ds_read_b64_tr_b16 a[220:221], v37 offset:28672
    ds_read_b64_tr_b16 a[222:223], v37 offset:30720
    ds_read_b64_tr_b16 a[236:237], v37 offset:28704
    ds_read_b64_tr_b16 a[238:239], v37 offset:30752
    s_waitcnt lgkmcnt(4)
    ds_read_b64_tr_b16 a[252:253], v37 offset:28736
    ds_read_b64_tr_b16 a[254:255], v37 offset:30784
    ds_read_b64_tr_b16 v[236:237], v37 offset:28768
    ds_read_b64_tr_b16 v[238:239], v37 offset:30816
    s_waitcnt lgkmcnt(0)
    s_waitcnt vmcnt(0)
    s_barrier
    ds_read_b64_tr_b16 v[240:241], v38 offset:32768
    ds_read_b64_tr_b16 v[242:243], v38 offset:33280
    ds_read_b64_tr_b16 v[244:245], v38 offset:33792
    ds_read_b64_tr_b16 v[246:247], v38 offset:34304
    ds_read_b64_tr_b16 v[248:249], v38 offset:34816
    ds_read_b64_tr_b16 v[250:251], v38 offset:35328
    ds_read_b64_tr_b16 v[252:253], v38 offset:35840
    ds_read_b64_tr_b16 v[254:255], v38 offset:36352
    s_waitcnt lgkmcnt(0)
    v_and_b32 v40, 15, v0
    v_add_u32 v6, 73728, v4
    v_lshlrev_b32 v8, 14, v33
    v_lshl_add_u32 v8, v40, 2, v8
    v_mul_u32_u24 v7, 131584, v33
    v_lshl_add_u32 v7, v40, 4, v7
    v_lshlrev_b32 v9, 10, v33
    v_lshl_add_u32 v9, v40, 4, v9
    v_xor_b32 v10, 64, v1
    v_and_b32 v42, 1, v33
    v_lshlrev_b32 v42, 4, v42
    v_lshlrev_b32 v11, 4, v42
    v_lshl_add_u32 v11, v40, 2, v11
    s_lshl_b32 s63, s3, 9
    s_add_u32 s63, s63, 90112
    v_add_u32 v11, s63, v11
    v_lshlrev_b32 v12, 4, v40
    s_lshl_b32 s63, s3, 8
    s_add_u32 s63, s63, 92160
    v_add_u32 v12, s63, v12
    v_lshlrev_b32 v13, 1, v0
    v_mov_b32 v14, 0
    s_and_b32 s63, s3, 1
    s_lshl_b32 s63, s63, 4
    v_lshlrev_b32 v42, 2, v33
    v_sub_u32 v42, v40, v42
    v_add_u32 v42, s63, v42
    v_mov_b32 v43, 0xf149f2ca
    v_mov_b32 v44, 0x3f80
    v_mov_b32 v45, 0x3f800000
    v_and_b32 v46, 1, v0
    v_cmp_eq_u32 vcc, 1, v46
    s_nop 1
    v_cndmask_b32 v44, v44, v45, vcc
    v_lshrrev_b32 v46, 1, v40
    s_mov_b32 s83, 0x3e0293ee
    v_cmp_gt_i32 vcc, 0, v42
    s_nop 1
    v_cndmask_b32 v16, 0, v43, vcc
    v_cmp_gt_i32 vcc, 1, v42
    s_nop 1
    v_cndmask_b32 v17, 0, v43, vcc
    v_cmp_gt_i32 vcc, 2, v42
    s_nop 1
    v_cndmask_b32 v18, 0, v43, vcc
    v_cmp_gt_i32 vcc, 3, v42
    s_nop 1
    v_cndmask_b32 v19, 0, v43, vcc
    v_cmp_gt_i32 vcc, 16, v42
    s_nop 1
    v_cndmask_b32 v20, 0, v43, vcc
    v_cmp_gt_i32 vcc, 17, v42
    s_nop 1
    v_cndmask_b32 v21, 0, v43, vcc
    v_cmp_gt_i32 vcc, 18, v42
    s_nop 1
    v_cndmask_b32 v22, 0, v43, vcc
    v_cmp_gt_i32 vcc, 19, v42
    s_nop 1
    v_cndmask_b32 v23, 0, v43, vcc
    v_mov_b32 v24, 0x3f803f80
    v_cmp_eq_u32 vcc, 0, v46
    s_nop 1
    v_cndmask_b32 v28, 0, v44, vcc
    v_mov_b32 v25, 0x3f803f80
    v_cmp_eq_u32 vcc, 1, v46
    s_nop 1
    v_cndmask_b32 v29, 0, v44, vcc
    v_mov_b32 v26, 0x3f803f80
    v_cmp_eq_u32 vcc, 2, v46
    s_nop 1
    v_cndmask_b32 v30, 0, v44, vcc
    v_mov_b32 v27, 0x3f803f80
    v_cmp_eq_u32 vcc, 3, v46
    s_nop 1
    v_cndmask_b32 v31, 0, v44, vcc
    s_bitcmp1_b32 s5, 0
    s_cselect_b32 s63, 0x3f800000, 0x3f80
    v_mov_b32 v44, s63
    v_cmp_eq_u32 vcc, 0, v40
    s_nop 1
    v_cndmask_b32 v196, 0, v44, vcc
    v_cmp_eq_u32 vcc, 1, v40
    s_nop 1
    v_cndmask_b32 v197, 0, v44, vcc
    v_cmp_eq_u32 vcc, 2, v40
    s_nop 1
    v_cndmask_b32 v198, 0, v44, vcc
    v_cmp_eq_u32 vcc, 3, v40
    s_nop 1
    v_cndmask_b32 v199, 0, v44, vcc
    s_and_b32 s67, s4, 1
    s_lshl_b32 s63, s66, 1
    s_add_u32 s63, s63, s67
    s_mul_i32 s80, s63, 3145728
    s_add_u32 s80, s80, 25165824
    s_mov_b32 s68, 0
    v_and_b32 v15, 3, v0
    v_lshlrev_b32 v15, 8, v15
    s_lshl_b32 s63, s3, 10
    v_add_u32 v190, s63, v6
    s_and_b32 s63, s3, 1
    s_lshl_b32 s63, s63, 12
    v_add_u32 v191, s63, v6
    v_lshlrev_b32 v192, 3, v0
    v_and_b32 v200, 2, v0
    v_xor_b32 v200, 2, v200
    v_mul_u32_u24 v200, 20, v200
    v_add_u32 v200, v200, v4
    s_barrier
    s_mul_i32 s76, s5, 36992
    s_mul_i32 s77, s3, 9248
    s_add_u32 s76, s76, s77
    s_add_u32 s76, s76, s80
    v_lshlrev_b32 v40, 7, v0
    buffer_load_dword v222, v40, s[8:11], s76 offen sc1
    s_add_u32 s76, s76, 8192
    buffer_load_dword v222, v40, s[8:11], s76 offen sc1
    s_add_u32 s76, s76, 8192
    s_lshl_b32 s76, s66, 5
    s_add_u32 s76, s76, s5
    s_lshl_b32 s76, s76, 2
    s_add_u32 s76, s76, s3
    s_lshl_b32 s76, s76, 6
    s_add_u32 s76, s76, s67
    s_lshl_b32 s76, s76, 2
    s_add_u32 s76, s76, 65536
    s_mov_b32 s77, 4096
    s_mov_b32 s60, 1048576
L_poll_36:
    buffer_load_dword v44, v14, s[8:11], s76 offen sc1
    s_waitcnt vmcnt(0)
    v_cmp_eq_u32 vcc, 0, v44
    s_cbranch_vccz L_pdone_37
    s_sleep 2
    s_sub_u32 s60, s60, 1
    s_cbranch_scc1 L_abort
    s_branch L_poll_36
L_pdone_37:
    s_mul_i32 s63, s66, 6291456
    s_mul_i32 s64, s67, 36864
    s_add_u32 s63, s63, s64
    s_mul_i32 s64, s3, 9216
    s_add_u32 s63, s63, s64
    s_add_u32 s63, s63, 10485760
    s_add_u32 s64, s64, s68
    s_add_u32 m0, s64, 0
    s_nop 0
    buffer_load_dwordx4 v1, s[8:11], s63 offen offset:0 sc1 lds
    s_add_u32 m0, s64, 896
    s_nop 0
    buffer_load_dwordx4 v1, s[8:11], s63 offen offset:128 sc1 lds
    s_add_u32 m0, s64, 1792
    s_nop 0
    buffer_load_dwordx4 v1, s[8:11], s63 offen offset:256 sc1 lds
    s_add_u32 m0, s64, 2688
    s_nop 0
    buffer_load_dwordx4 v1, s[8:11], s63 offen offset:384 sc1 lds
    s_add_u32 m0, s64, 3584
    s_nop 0
    buffer_load_dwordx4 v1, s[8:11], s63 offen offset:512 sc1 lds
    s_add_u32 m0, s64, 4480
    s_nop 0
    buffer_load_dwordx4 v1, s[8:11], s63 offen offset:640 sc1 lds
    s_add_u32 m0, s64, 5376
    s_nop 0
    buffer_load_dwordx4 v1, s[8:11], s63 offen offset:768 sc1 lds
    s_add_u32 m0, s64, 6272
    s_nop 0
    buffer_load_dwordx4 v1, s[8:11], s63 offen offset:896 sc1 lds
    s_add_u32 m0, s64, 7168
    s_nop 0
    buffer_load_dwordx4 v1, s[8:11], s63 offen offset:1024 sc1 lds
    s_getpc_b64 s[64:65]
    s_lshl_b32 s63, s3, 13
    v_lshlrev_b32 v222, 7, v0
    v_add_u32 v222, s63, v222
    v_min_u32 v222, 12288, v222
    global_load_dword v222, v222, s[64:65]
    s_waitcnt vmcnt(1)
    s_cmp_lg_u32 s6, 0
    s_cbranch_scc1 L_qo_safe
    s_mov_b32 s90, 196608
    s_mov_b32 s69, 0
    v_mov_b32 v201, 0
    v_mov_b32 v202, v4
    s_lshl_b32 s87, s66, 5
    s_add_u32 s87, s87, s5
    s_mul_i32 s87, s87, 2101248
    s_mul_i32 s63, s67, 24576
    s_add_u32 s87, s87, s63
    s_add_u32 s87, s87, 67108864
    s_lshl_b32 s93, s66, 5
    s_add_u32 s93, s93, s5
    s_lshl_b32 s93, s93, 2
    s_lshl_b32 s93, s93, 6
    s_add_u32 s93, s93, s67
    s_lshl_b32 s93, s93, 2
    s_add_u32 s93, s93, 131072
    s_mov_b32 s70, 0
    s_lshl_b32 s65, s3, 12
    s_add_u32 s72, s87, s65
    s_add_u32 s72, s72, 0
    s_add_u32 m0, s65, 36864
    s_barrier
    ds_read_b128 v[32:35], v2 offset:0
    ds_read_b128 v[36:39], v2 offset:18432
    ds_read_b128 v[40:43], v3 offset:0
    ds_read_b128 v[44:47], v3 offset:18432
    ds_read_b128 v[48:51], v2 offset:1024
    ds_read_b128 v[52:55], v2 offset:19456
    ds_read_b128 v[56:59], v3 offset:1024
    ds_read_b128 v[60:63], v3 offset:19456
    s_waitcnt lgkmcnt(6)
    v_mfma_f32_16x16x32_bf16 v[64:67], a[0:3], v[32:35], 0
    v_mfma_f32_16x16x32_bf16 v[68:71], a[4:7], v[32:35], 0
    buffer_load_dwordx4 v4, s[8:11], s72 offen offset:0 sc1  lds
    v_mfma_f32_16x16x32_bf16 v[72:75], a[0:3], v[36:39], 0
    v_mfma_f32_16x16x32_bf16 v[76:79], a[4:7], v[36:39], 0
    buffer_load_dwordx4 v4, s[8:11], s72 offen offset:1024 sc1  lds
    ds_read_b128 v[32:35], v2 offset:2048
    ds_read_b128 v[36:39], v2 offset:20480
    s_waitcnt lgkmcnt(6)
    v_mfma_f32_16x16x32_bf16 v[64:67], a[8:11], v[40:43], v[64:67]
    v_mfma_f32_16x16x32_bf16 v[68:71], a[12:15], v[40:43], v[68:71]
    buffer_load_dwordx4 v4, s[8:11], s72 offen offset:2048 sc1  lds
    v_mfma_f32_16x16x32_bf16 v[72:75], a[8:11], v[44:47], v[72:75]
    v_mfma_f32_16x16x32_bf16 v[76:79], a[12:15], v[44:47], v[76:79]
    buffer_load_dwordx4 v4, s[8:11], s72 offen offset:3072 sc1  lds
    ds_read_b128 v[40:43], v3 offset:2048
    ds_read_b128 v[44:47], v3 offset:20480
    s_waitcnt lgkmcnt(6)
    v_mfma_f32_16x16x32_bf16 v[64:67], a[16:19], v[48:51], v[64:67]
    v_mfma_f32_16x16x32_bf16 v[68:71], a[20:23], v[48:51], v[68:71]
    v_mfma_f32_16x16x32_bf16 v[72:75], a[16:19], v[52:55], v[72:75]
    v_mfma_f32_16x16x32_bf16 v[76:79], a[20:23], v[52:55], v[76:79]
    ds_read_b128 v[48:51], v2 offset:3072
    ds_read_b128 v[52:55], v2 offset:21504
    s_waitcnt lgkmcnt(6)
    v_mfma_f32_16x16x32_bf16 v[64:67], a[24:27], v[56:59], v[64:67]
    v_mfma_f32_16x16x32_bf16 v[68:71], a[28:31], v[56:59], v[68:71]
    v_mfma_f32_16x16x32_bf16 v[72:75], a[24:27], v[60:63], v[72:75]
    v_mfma_f32_16x16x32_bf16 v[76:79], a[28:31], v[60:63], v[76:79]
    ds_read_b128 v[56:59], v3 offset:3072
    ds_read_b128 v[60:63], v3 offset:21504
    s_waitcnt lgkmcnt(6)
    v_mfma_f32_16x16x32_bf16 v[64:67], a[32:35], v[32:35], v[64:67]
    v_mfma_f32_16x16x32_bf16 v[68:71], a[36:39], v[32:35], v[68:71]
    v_mfma_f32_16x16x32_bf16 v[72:75], a[32:35], v[36:39], v[72:75]
    v_mfma_f32_16x16x32_bf16 v[76:79], a[36:39], v[36:39], v[76:79]
    ds_read_b128 v[32:35], v2 offset:4096
    ds_read_b128 v[36:39], v2 offset:22528
    s_waitcnt lgkmcnt(6)
    v_mfma_f32_16x16x32_bf16 v[64:67], a[40:43], v[40:43], v[64:67]
    v_mfma_f32_16x16x32_bf16 v[68:71], a[44:47], v[40:43], v[68:71]
    v_mfma_f32_16x16x32_bf16 v[72:75], a[40:43], v[44:47], v[72:75]
    v_mfma_f32_16x16x32_bf16 v[76:79], a[44:47], v[44:47], v[76:79]
    ds_read_b128 v[40:43], v3 offset:4096
    ds_read_b128 v[44:47], v3 offset:22528
    s_waitcnt lgkmcnt(6)
    v_mfma_f32_16x16x32_bf16 v[64:67], a[48:51], v[48:51], v[64:67]
    v_mfma_f32_16x16x32_bf16 v[68:71], a[52:55], v[48:51], v[68:71]
    v_mfma_f32_16x16x32_bf16 v[72:75], a[48:51], v[52:55], v[72:75]
    v_mfma_f32_16x16x32_bf16 v[76:79], a[52:55], v[52:55], v[76:79]
    ds_read_b128 v[48:51], v2 offset:5120
    ds_read_b128 v[52:55], v2 offset:23552
    s_waitcnt lgkmcnt(6)
    v_mfma_f32_16x16x32_bf16 v[64:67], a[56:59], v[56:59], v[64:67]
    v_mfma_f32_16x16x32_bf16 v[68:71], a[60:63], v[56:59], v[68:71]
    v_mfma_f32_16x16x32_bf16 v[72:75], a[56:59], v[60:63], v[72:75]
    v_mfma_f32_16x16x32_bf16 v[76:79], a[60:63], v[60:63], v[76:79]
    ds_read_b128 v[56:59], v3 offset:5120
    ds_read_b128 v[60:63], v3 offset:23552
    s_waitcnt lgkmcnt(6)
    v_mfma_f32_16x16x32_bf16 v[64:67], a[64:67], v[32:35], v[64:67]
    v_mfma_f32_16x16x32_bf16 v[68:71], a[68:71], v[32:35], v[68:71]
    v_mfma_f32_16x16x32_bf16 v[72:75], a[64:67], v[36:39], v[72:75]
    v_mfma_f32_16x16x32_bf16 v[76:79], a[68:71], v[36:39], v[76:79]
    ds_read_b128 v[32:35], v2 offset:6144
    ds_read_b128 v[36:39], v2 offset:24576
    s_waitcnt lgkmcnt(6)
    v_mfma_f32_16x16x32_bf16 v[64:67], a[72:75], v[40:43], v[64:67]
    v_mfma_f32_16x16x32_bf16 v[68:71], a[76:79], v[40:43], v[68:71]
    v_mfma_f32_16x16x32_bf16 v[72:75], a[72:75], v[44:47], v[72:75]
    v_mfma_f32_16x16x32_bf16 v[76:79], a[76:79], v[44:47], v[76:79]
    ds_read_b128 v[40:43], v3 offset:6144
    ds_read_b128 v[44:47], v3 offset:24576
    s_waitcnt lgkmcnt(6)
    v_mfma_f32_16x16x32_bf16 v[64:67], a[80:83], v[48:51], v[64:67]
    v_mfma_f32_16x16x32_bf16 v[68:71], a[84:87], v[48:51], v[68:71]
    v_mfma_f32_16x16x32_bf16 v[72:75], a[80:83], v[52:55], v[72:75]
    v_mfma_f32_16x16x32_bf16 v[76:79], a[84:87], v[52:55], v[76:79]
    ds_read_b128 v[48:51], v2 offset:7168
    ds_read_b128 v[52:55], v2 offset:25600
    s_waitcnt lgkmcnt(6)
    v_mfma_f32_16x16x32_bf16 v[64:67], a[88:91], v[56:59], v[64:67]
    v_mfma_f32_16x16x32_bf16 v[68:71], a[92:95], v[56:59], v[68:71]
    v_mfma_f32_16x16x32_bf16 v[72:75], a[88:91], v[60:63], v[72:75]
    v_mfma_f32_16x16x32_bf16 v[76:79], a[92:95], v[60:63], v[76:79]
    ds_read_b128 v[56:59], v3 offset:7168
    ds_read_b128 v[60:63], v3 offset:25600
    s_waitcnt lgkmcnt(6)
    v_mfma_f32_16x16x32_bf16 v[64:67], a[96:99], v[32:35], v[64:67]
    v_mfma_f32_16x16x32_bf16 v[68:71], a[100:103], v[32:35], v[68:71]
    v_mfma_f32_16x16x32_bf16 v[72:75], a[96:99], v[36:39], v[72:75]
    v_mfma_f32_16x16x32_bf16 v[76:79], a[100:103], v[36:39], v[76:79]
    ds_read_b128 v[32:35], v2 offset:8192
    ds_read_b128 v[36:39], v2 offset:26624
    s_waitcnt lgkmcnt(6)
    v_mfma_f32_16x16x32_bf16 v[64:67], a[104:107], v[40:43], v[64:67]
    v_mfma_f32_16x16x32_bf16 v[68:71], a[108:111], v[40:43], v[68:71]
    v_mfma_f32_16x16x32_bf16 v[72:75], a[104:107], v[44:47], v[72:75]
    v_mfma_f32_16x16x32_bf16 v[76:79], a[108:111], v[44:47], v[76:79]
    ds_read_b128 v[40:43], v3 offset:8192
    ds_read_b128 v[44:47], v3 offset:26624
    s_waitcnt lgkmcnt(6)
    v_mfma_f32_16x16x32_bf16 v[64:67], a[112:115], v[48:51], v[64:67]
    v_mfma_f32_16x16x32_bf16 v[68:71], a[116:119], v[48:51], v[68:71]
    v_mfma_f32_16x16x32_bf16 v[72:75], a[112:115], v[52:55], v[72:75]
    v_mfma_f32_16x16x32_bf16 v[76:79], a[116:119], v[52:55], v[76:79]
    s_waitcnt lgkmcnt(4)
    v_mfma_f32_16x16x32_bf16 v[64:67], a[120:123], v[56:59], v[64:67]
    v_mfma_f32_16x16x32_bf16 v[68:71], a[124:127], v[56:59], v[68:71]
    v_mfma_f32_16x16x32_bf16 v[72:75], a[120:123], v[60:63], v[72:75]
    v_mfma_f32_16x16x32_bf16 v[76:79], a[124:127], v[60:63], v[76:79]
    s_waitcnt lgkmcnt(2)
    v_mfma_f32_16x16x32_bf16 v[64:67], a[128:131], v[32:35], v[64:67]
    v_mfma_f32_16x16x32_bf16 v[68:71], a[132:135], v[32:35], v[68:71]
    v_mfma_f32_16x16x32_bf16 v[72:75], a[128:131], v[36:39], v[72:75]
    v_mfma_f32_16x16x32_bf16 v[76:79], a[132:135], v[36:39], v[76:79]
    s_waitcnt lgkmcnt(0)
    v_mfma_f32_16x16x32_bf16 v[64:67], a[136:139], v[40:43], v[64:67]
    v_mfma_f32_16x16x32_bf16 v[68:71], a[140:143], v[40:43], v[68:71]
    v_mfma_f32_16x16x32_bf16 v[72:75], a[136:139], v[44:47], v[72:75]
    v_mfma_f32_16x16x32_bf16 v[76:79], a[140:143], v[44:47], v[76:79]
    v_cvt_pk_bf16_f32 v32, v64, v65
    v_cvt_pk_bf16_f32 v33, v66, v67
    v_cvt_pk_bf16_f32 v34, v68, v69
    v_cvt_pk_bf16_f32 v35, v70, v71
    ds_write_b128 v190, v[32:35] offset:0
    v_cvt_pk_bf16_f32 v36, v72, v73
    v_cvt_pk_bf16_f32 v37, v74, v75
    s_nop 0
    v_cvt_pk_bf16_f32 v38, v76, v77
    v_cvt_pk_bf16_f32 v39, v78, v79
    ds_write_b128 v190, v[36:39] offset:4096
    s_waitcnt vmcnt(0) lgkmcnt(0)
    s_barrier
    s_cmp_eq_u32 s3, 0
    s_cbranch_scc1 L_rows_40
L_qo_loopF:
    s_cmp_ge_u32 s3, 2
    s_cbranch_scc1 L_att_38
    s_cmp_eq_u32 s3, 1
    s_cbranch_scc1 L_xd_39
    v_add_u32 v40, v4, v6
    v_lshlrev_b32 v41, 1, v13
    v_add_u32 v41, 73728, v41
    ds_read_b128 v[32:35], v40 offset:16384
    ds_read_b128 v[36:39], v40 offset:16400
    ds_read_b32 v48, v41 offset:18432
    ds_read_b32 v49, v41 offset:18688
    ds_read_b32 v50, v41 offset:18944
    ds_read_b32 v51, v41 offset:19200
    v_lshlrev_b32 v80, 16, v176
    v_and_b32 v81, 0xffff0000, v176
    v_lshlrev_b32 v82, 16, v177
    v_and_b32 v83, 0xffff0000, v177
    v_lshlrev_b32 v84, 16, v178
    v_and_b32 v85, 0xffff0000, v178
    v_lshlrev_b32 v86, 16, v179
    v_and_b32 v87, 0xffff0000, v179
    v_lshlrev_b32 v88, 16, v180
    v_lshlrev_b32 v100, 16, v184
    v_and_b32 v101, 0xffff0000, v184
    v_lshlrev_b32 v102, 16, v185
    v_and_b32 v103, 0xffff0000, v185
    v_lshlrev_b32 v104, 16, v186
    v_and_b32 v105, 0xffff0000, v186
    v_lshlrev_b32 v106, 16, v187
    v_and_b32 v107, 0xffff0000, v187
    v_lshlrev_b32 v108, 16, v188
    s_mul_i32 s76, s82, 1152
    s_waitcnt lgkmcnt(0)
    v_pk_add_f32 v[48:49], v[48:49], v[50:51]
    v_add_f32 v40, v48, v49
    v_cvt_pk_bf16_f32 v64, v32, v33
    v_cvt_pk_bf16_f32 v65, v34, v35
    v_cvt_pk_bf16_f32 v66, v36, v37
    v_cvt_pk_bf16_f32 v67, v38, v39
    v_cvt_pk_bf16_f32 v68, v40, v40
    v_lshlrev_b32 v90, 16, v64
    v_and_b32 v91, 0xffff0000, v64
    v_lshlrev_b32 v92, 16, v65
    v_and_b32 v93, 0xffff0000, v65
    v_lshlrev_b32 v94, 16, v66
    v_and_b32 v95, 0xffff0000, v66
    v_lshlrev_b32 v96, 16, v67
    v_and_b32 v97, 0xffff0000, v67
    v_lshlrev_b32 v98, 16, v68
    v_pk_add_f32 v[80:81], v[80:81], v[90:91]
    v_pk_add_f32 v[82:83], v[82:83], v[92:93]
    v_pk_add_f32 v[84:85], v[84:85], v[94:95]
    v_pk_add_f32 v[86:87], v[86:87], v[96:97]
    v_add_f32 v88, v88, v98
    v_cvt_pk_bf16_f32 v64, v80, v81
    v_cvt_pk_bf16_f32 v65, v82, v83
    v_cvt_pk_bf16_f32 v66, v84, v85
    v_cvt_pk_bf16_f32 v67, v86, v87
    v_cvt_pk_bf16_f32 v68, v88, v88
    s_cmp_eq_u32 s66, 0
    s_cbranch_scc1 L_ln_45
    buffer_store_dwordx4 v[64:67], v4, s[56:59], s76 offen
    buffer_store_short v68, v13, s[56:59], s76 offen offset:1024
    s_branch L_qn_46
L_ln_45:
    v_lshlrev_b32 v80, 16, v64
    v_and_b32 v81, 0xffff0000, v64
    v_lshlrev_b32 v82, 16, v65
    v_and_b32 v83, 0xffff0000, v65
    v_lshlrev_b32 v84, 16, v66
    v_and_b32 v85, 0xffff0000, v66
    v_lshlrev_b32 v86, 16, v67
    v_and_b32 v87, 0xffff0000, v67
    v_lshlrev_b32 v88, 16, v68
    v_readfirstlane_b32 s64, v80
    s_nop 1
    v_mul_f32 v46, -1.0, s64
    v_mul_f32 v47, -1.0, s64
    v_pk_add_f32 v[90:91], v[80:81], v[46:47]
    v_pk_add_f32 v[92:93], v[82:83], v[46:47]
    v_pk_add_f32 v[94:95], v[84:85], v[46:47]
    v_pk_add_f32 v[96:97], v[86:87], v[46:47]
    v_add_f32 v98, v88, v46
    v_pk_add_f32 v[44:45], v[90:91], v[92:93]
    v_pk_mul_f32 v[42:43], v[90:91], v[90:91]
    v_pk_add_f32 v[44:45], v[44:45], v[94:95]
    v_pk_fma_f32 v[42:43], v[92:93], v[92:93], v[42:43]
    v_pk_add_f32 v[44:45], v[44:45], v[96:97]
    v_pk_fma_f32 v[42:43], v[94:95], v[94:95], v[42:43]
    v_add_f32 v44, v44, v98
    v_pk_fma_f32 v[42:43], v[96:97], v[96:97], v[42:43]
    v_add_f32 v44, v44, v45
    v_fmac_f32 v42, v98, v98
    v_add_f32 v42, v42, v43
    s_nop 1
    v_permlane32_swap_b32 v44, v42
    v_add_f32 v44, v44, v42
    v_mov_b32 v45, v44
    s_nop 1
    v_permlane16_swap_b32 v44, v45
    v_add_f32 v44, v44, v45
    s_nop 1
    v_add_f32_dpp v44, v44, v44 quad_perm:[1,0,3,2] row_mask:0xf bank_mask:0xf
    s_nop 1
    v_add_f32_dpp v44, v44, v44 quad_perm:[2,3,0,1] row_mask:0xf bank_mask:0xf
    s_nop 1
    v_add_f32_dpp v44, v44, v44 row_half_mirror row_mask:0xf bank_mask:0xf
    s_nop 1
    v_add_f32_dpp v44, v44, v44 row_mirror row_mask:0xf bank_mask:0xf
    v_mul_f32 v44, 1.7361111111e-03, v44
    s_nop 0
    v_readlane_b32 s64, v44, 0
    v_readlane_b32 s65, v44, 32
    s_nop 0
    v_mov_b32 v44, s64
    v_fma_f32 v42, -v44, v44, s65
    v_max_f32 v42, 0, v42
    v_add_f32 v42, 0x3727c5ac, v42
    v_rsq_f32 v42, v42
    v_mul_f32 v44, -1.0, v44
    v_mov_b32 v43, v42
    v_mul_f32 v44, v44, v42
    v_mov_b32 v45, v44
    v_pk_fma_f32 v[90:91], v[90:91], v[42:43], v[44:45]
    v_pk_fma_f32 v[92:93], v[92:93], v[42:43], v[44:45]
    v_pk_fma_f32 v[94:95], v[94:95], v[42:43], v[44:45]
    v_pk_fma_f32 v[96:97], v[96:97], v[42:43], v[44:45]
    v_fma_f32 v98, v98, v42, v44
    v_pk_fma_f32 v[80:81], v[90:91], v[100:101], v[80:81]
    v_pk_fma_f32 v[82:83], v[92:93], v[102:103], v[82:83]
    v_pk_fma_f32 v[84:85], v[94:95], v[104:105], v[84:85]
    v_pk_fma_f32 v[86:87], v[96:97], v[106:107], v[86:87]
    v_fma_f32 v88, v98, v108, v88
    v_cvt_pk_bf16_f32 v64, v80, v81
    v_cvt_pk_bf16_f32 v65, v82, v83
    v_cvt_pk_bf16_f32 v66, v84, v85
    v_cvt_pk_bf16_f32 v67, v86, v87
    v_cvt_pk_bf16_f32 v68, v88, v88
    s_add_u32 s77, s76, 13631488
    s_add_u32 s78, s76, 16777216
    v_add_u32 v41, 73728, v13
    buffer_store_dwordx4 v[64:67], v4, s[8:11], s77 offen sc1
    ds_write_b16 v41, v68 offset:19456
    v_lshlrev_b32 v80, 16, v64
    v_and_b32 v81, 0xffff0000, v64
    v_lshlrev_b32 v82, 16, v65
    v_and_b32 v83, 0xffff0000, v65
    v_lshlrev_b32 v84, 16, v66
    v_and_b32 v85, 0xffff0000, v66
    v_lshlrev_b32 v86, 16, v67
    v_and_b32 v87, 0xffff0000, v67
    v_lshlrev_b32 v88, 16, v68
    v_readfirstlane_b32 s64, v80
    s_nop 1
    v_mul_f32 v46, -1.0, s64
    v_mul_f32 v47, -1.0, s64
    v_pk_add_f32 v[90:91], v[80:81], v[46:47]
    v_pk_add_f32 v[92:93], v[82:83], v[46:47]
    v_pk_add_f32 v[94:95], v[84:85], v[46:47]
    v_pk_add_f32 v[96:97], v[86:87], v[46:47]
    v_add_f32 v98, v88, v46
    v_pk_add_f32 v[44:45], v[90:91], v[92:93]
    v_pk_mul_f32 v[42:43], v[90:91], v[90:91]
    v_pk_add_f32 v[44:45], v[44:45], v[94:95]
    v_pk_fma_f32 v[42:43], v[92:93], v[92:93], v[42:43]
    v_pk_add_f32 v[44:45], v[44:45], v[96:97]
    v_pk_fma_f32 v[42:43], v[94:95], v[94:95], v[42:43]
    v_add_f32 v44, v44, v98
    v_pk_fma_f32 v[42:43], v[96:97], v[96:97], v[42:43]
    v_add_f32 v44, v44, v45
    v_fmac_f32 v42, v98, v98
    v_add_f32 v42, v42, v43
    s_nop 1
    v_permlane32_swap_b32 v44, v42
    v_add_f32 v44, v44, v42
    v_mov_b32 v45, v44
    s_nop 1
    v_permlane16_swap_b32 v44, v45
    v_add_f32 v44, v44, v45
    s_nop 1
    v_add_f32_dpp v44, v44, v44 quad_perm:[1,0,3,2] row_mask:0xf bank_mask:0xf
    s_nop 1
    v_add_f32_dpp v44, v44, v44 quad_perm:[2,3,0,1] row_mask:0xf bank_mask:0xf
    s_nop 1
    v_add_f32_dpp v44, v44, v44 row_half_mirror row_mask:0xf bank_mask:0xf
    s_nop 1
    v_add_f32_dpp v44, v44, v44 row_mirror row_mask:0xf bank_mask:0xf
    v_mul_f32 v44, 1.7361111111e-03, v44
    s_nop 0
    v_readlane_b32 s64, v44, 0
    v_readlane_b32 s65, v44, 32
    s_nop 0
    v_mov_b32 v44, s64
    v_fma_f32 v42, -v44, v44, s65
    v_max_f32 v42, 0, v42
    v_sub_f32 v46, v46, v44
    v_cvt_pk_bf16_f32 v42, v42, v42
    v_and_b32 v42, 0xffff0000, v42
    v_cvt_pk_bf16_f32 v46, v46, v46
    v_and_b32 v46, 0xffff0000, v46
    v_add_f32 v42, 0x3727c5ac, v42
    v_mov_b32 v47, v46
    v_cvt_pk_bf16_f32 v42, v42, v42
    v_and_b32 v42, 0xffff0000, v42
    v_sqrt_f32 v42, v42
    v_pk_add_f32 v[90:91], v[80:81], v[46:47]
    v_pk_add_f32 v[92:93], v[82:83], v[46:47]
    v_pk_add_f32 v[94:95], v[84:85], v[46:47]
    v_pk_add_f32 v[96:97], v[86:87], v[46:47]
    v_add_f32 v98, v88, v46
    v_cvt_pk_bf16_f32 v42, v42, v42
    v_and_b32 v42, 0xffff0000, v42
    v_rcp_f32 v42, v42
    v_cvt_pk_bf16_f32 v72, v90, v91
    v_cvt_pk_bf16_f32 v73, v92, v93
    v_cvt_pk_bf16_f32 v74, v94, v95
    v_cvt_pk_bf16_f32 v75, v96, v97
    v_cvt_pk_bf16_f32 v76, v98, v98
    v_mov_b32 v43, v42
    v_lshlrev_b32 v90, 16, v72
    v_and_b32 v91, 0xffff0000, v72
    v_lshlrev_b32 v92, 16, v73
    v_and_b32 v93, 0xffff0000, v73
    v_lshlrev_b32 v94, 16, v74
    v_and_b32 v95, 0xffff0000, v74
    v_lshlrev_b32 v96, 16, v75
    v_and_b32 v97, 0xffff0000, v75
    v_lshlrev_b32 v98, 16, v76
    v_pk_mul_f32 v[90:91], v[90:91], v[42:43]
    v_pk_mul_f32 v[92:93], v[92:93], v[42:43]
    v_pk_mul_f32 v[94:95], v[94:95], v[42:43]
    v_pk_mul_f32 v[96:97], v[96:97], v[42:43]
    v_mul_f32 v98, v98, v42
    v_cvt_pk_bf16_f32 v72, v90, v91
    v_cvt_pk_bf16_f32 v73, v92, v93
    v_cvt_pk_bf16_f32 v74, v94, v95
    v_cvt_pk_bf16_f32 v75, v96, v97
    v_cvt_pk_bf16_f32 v76, v98, v98
    ds_write_b16 v41, v76 offset:19584
    buffer_store_dwordx4 v[72:75], v4, s[8:11], s78 offen sc1
    s_waitcnt lgkmcnt(0)
    ds_read_b128 v[32:35], v6 offset:19456
    ds_read_b128 v[36:39], v6 offset:19584
    s_lshr_b32 s63, s82, 5
    s_lshl_b32 s69, s5, 6
    s_add_u32 s69, s69, s63
    s_lshl_b32 s69, s69, 2
    s_add_u32 s69, s69, 24576
    s_waitcnt lgkmcnt(0)
    s_mov_b64 exec, 0xff
    buffer_store_dwordx4 v[32:35], v4, s[8:11], s77 offen offset:1024 sc1
    buffer_store_dwordx4 v[36:39], v4, s[8:11], s78 offen offset:1024 sc1
    s_mov_b64 exec, -1
L_qn_46:
    s_cmp_eq_u32 s70, 1
    s_cbranch_scc1 L_rows_40
    s_cmp_eq_u32 s69, 0
    s_cbranch_scc1 L_fl_47
    s_waitcnt vmcnt(0)
    s_mov_b64 exec, 1
    buffer_store_dword v24, v14, s[8:11], s69 offen sc1
    s_mov_b64 exec, -1
    s_mov_b32 s69, 0
L_fl_47:
L_rows_40:
    s_and_b32 s76, s67, 30
    s_cbranch_scc1 L_xf_48
    s_lshl_b32 s77, s67, 7
    s_and_b32 s77, s77, 4096
    s_add_u32 s77, s77, 4096
    v_lshlrev_b32 v41, 2, v4
    s_mov_b32 s60, 1048576
L_poll_49:
    buffer_load_dword v40, v41, s[8:11], s77 offen sc1
    s_waitcnt vmcnt(0)
    v_cmp_eq_u32 vcc, 0, v40
    s_cbranch_vccz L_pdone_50
    s_sleep 4
    s_sub_u32 s60, s60, 1
    s_cbranch_scc1 L_abort
    s_branch L_poll_49
L_pdone_50:
L_xf_48:
    s_lshl_b32 s76, s67, 5
    s_add_u32 s76, s76, s5
    s_mul_i32 s76, s76, 1152
    s_mul_i32 s77, s66, 6291456
    s_add_u32 s77, s77, s76
    s_add_u32 s77, s77, 7340032
    s_add_u32 s78, s76, 4194304
    buffer_load_dwordx4 v[176:179], v4, s[8:11], s77 offen sc1
    buffer_load_ushort v180, v13, s[8:11], s77 offen offset:1024 sc1
    buffer_load_dwordx4 v[184:187], v4, s[8:11], s78 offen sc1
    buffer_load_ushort v188, v13, s[8:11], s78 offen offset:1024 sc1
    s_branch L_join_41
L_xd_39:
    s_cmp_ge_u32 s67, 62
    s_cbranch_scc1 L_join_41
    s_add_u32 s74, s67, 2
    s_add_u32 s75, s93, -65528
    v_cmp_eq_u32 vcc, 0, v201
    s_cbranch_vccz L_kmh_43
    s_mov_b32 s60, 1048576
L_poll_51:
    buffer_load_dword v193, v15, s[8:11], s75 offen sc1
    s_waitcnt vmcnt(0)
    v_cmp_eq_u32 vcc, 0, v193
    s_cbranch_vccz L_pdone_52
    s_sleep 1
    s_sub_u32 s60, s60, 1
    s_cbranch_scc1 L_abort
    s_branch L_poll_51
L_pdone_52:
L_kmh_43:
    s_mul_i32 s75, s66, 6291456
    s_mul_i32 s79, s74, 36864
    s_add_u32 s75, s75, s79
    s_add_u32 s75, s75, 10485760
    s_xor_b32 s79, s68, 16384
    s_add_u32 s72, s87, 49152
    s_add_u32 m0, s79, 36864
    s_nop 0
    buffer_load_dwordx4 v4, s[8:11], s72 offen offset:0 sc1  lds
    buffer_load_dwordx4 v4, s[8:11], s72 offen offset:1024 sc1  lds
    buffer_load_dwordx4 v4, s[8:11], s72 offen offset:2048 sc1  lds
    buffer_load_dwordx4 v4, s[8:11], s72 offen offset:3072 sc1  lds
    s_add_u32 s72, s72, 4096
    s_add_u32 m0, s79, 40960
    s_nop 0
    buffer_load_dwordx4 v4, s[8:11], s72 offen offset:0 sc1  lds
    buffer_load_dwordx4 v4, s[8:11], s72 offen offset:1024 sc1  lds
    buffer_load_dwordx4 v4, s[8:11], s72 offen offset:2048 sc1  lds
    buffer_load_dwordx4 v4, s[8:11], s72 offen offset:3072 sc1  lds
    s_add_u32 s72, s72, 4096
    s_add_u32 m0, s79, 45056
    s_nop 0
    buffer_load_dwordx4 v4, s[8:11], s72 offen offset:0 sc1  lds
    buffer_load_dwordx4 v4, s[8:11], s72 offen offset:1024 sc1  lds
    buffer_load_dwordx4 v4, s[8:11], s72 offen offset:2048 sc1  lds
    buffer_load_dwordx4 v4, s[8:11], s72 offen offset:3072 sc1  lds
    s_add_u32 s72, s72, 4096
    s_add_u32 m0, s79, 49152
    s_nop 0
    buffer_load_dwordx4 v4, s[8:11], s72 offen offset:0 sc1  lds
    buffer_load_dwordx4 v4, s[8:11], s72 offen offset:1024 sc1  lds
    buffer_load_dwordx4 v4, s[8:11], s72 offen offset:2048 sc1  lds
    buffer_load_dwordx4 v4, s[8:11], s72 offen offset:3072 sc1  lds
    s_mov_b32 m0, 0
    s_nop 0
    buffer_load_dwordx4 v10, s[8:11], s75 offen offset:0 sc1 lds
    s_mov_b32 m0, 896
    s_nop 0
    buffer_load_dwordx4 v10, s[8:11], s75 offen offset:128 sc1 lds
    s_mov_b32 m0, 1792
    s_nop 0
    buffer_load_dwordx4 v10, s[8:11], s75 offen offset:256 sc1 lds
    s_mov_b32 m0, 2688
    s_nop 0
    buffer_load_dwordx4 v10, s[8:11], s75 offen offset:384 sc1 lds
    s_mov_b32 m0, 3584
    s_nop 0
    buffer_load_dwordx4 v10, s[8:11], s75 offen offset:512 sc1 lds
    s_mov_b32 m0, 4480
    s_nop 0
    buffer_load_dwordx4 v10, s[8:11], s75 offen offset:640 sc1 lds
    s_mov_b32 m0, 5376
    s_nop 0
    buffer_load_dwordx4 v10, s[8:11], s75 offen offset:768 sc1 lds
    s_mov_b32 m0, 6272
    s_nop 0
    buffer_load_dwordx4 v10, s[8:11], s75 offen offset:896 sc1 lds
    s_mov_b32 m0, 7168
    s_nop 0
    buffer_load_dwordx4 v10, s[8:11], s75 offen offset:1024 sc1 lds
    s_add_u32 s75, s75, 9216
    s_mov_b32 m0, 9216
    s_nop 0
    buffer_load_dwordx4 v1, s[8:11], s75 offen offset:0 sc1 lds
    s_mov_b32 m0, 10112
    s_nop 0
    buffer_load_dwordx4 v1, s[8:11], s75 offen offset:128 sc1 lds
    s_mov_b32 m0, 11008
    s_nop 0
    buffer_load_dwordx4 v1, s[8:11], s75 offen offset:256 sc1 lds
    s_mov_b32 m0, 11904
    s_nop 0
    buffer_load_dwordx4 v1, s[8:11], s75 offen offset:384 sc1 lds
    s_mov_b32 m0, 12800
    s_nop 0
    buffer_load_dwordx4 v1, s[8:11], s75 offen offset:512 sc1 lds
    s_mov_b32 m0, 13696
    s_nop 0
    buffer_load_dwordx4 v1, s[8:11], s75 offen offset:640 sc1 lds
    s_mov_b32 m0, 14592
    s_nop 0
    buffer_load_dwordx4 v1, s[8:11], s75 offen offset:768 sc1 lds
    s_mov_b32 m0, 15488
    s_nop 0
    buffer_load_dwordx4 v1, s[8:11], s75 offen offset:896 sc1 lds
    s_mov_b32 m0, 16384
    s_nop 0
    buffer_load_dwordx4 v1, s[8:11], s75 offen offset:1024 sc1 lds
    s_add_u32 s75, s75, 9216
    s_mov_b32 m0, 18432
    s_nop 0
    buffer_load_dwordx4 v10, s[8:11], s75 offen offset:0 sc1 lds
    s_mov_b32 m0, 19328
    s_nop 0
    buffer_load_dwordx4 v10, s[8:11], s75 offen offset:128 sc1 lds
    s_mov_b32 m0, 20224
    s_nop 0
    buffer_load_dwordx4 v10, s[8:11], s75 offen offset:256 sc1 lds
    s_mov_b32 m0, 21120
    s_nop 0
    buffer_load_dwordx4 v10, s[8:11], s75 offen offset:384 sc1 lds
    s_mov_b32 m0, 22016
    s_nop 0
    buffer_load_dwordx4 v10, s[8:11], s75 offen offset:512 sc1 lds
    s_mov_b32 m0, 22912
    s_nop 0
    buffer_load_dwordx4 v10, s[8:11], s75 offen offset:640 sc1 lds
    s_mov_b32 m0, 23808
    s_nop 0
    buffer_load_dwordx4 v10, s[8:11], s75 offen offset:768 sc1 lds
    s_mov_b32 m0, 24704
    s_nop 0
    buffer_load_dwordx4 v10, s[8:11], s75 offen offset:896 sc1 lds
    s_mov_b32 m0, 25600
    s_nop 0
    buffer_load_dwordx4 v10, s[8:11], s75 offen offset:1024 sc1 lds
    s_add_u32 s75, s75, 9216
    s_mov_b32 m0, 27648
    s_nop 0
    buffer_load_dwordx4 v1, s[8:11], s75 offen offset:0 sc1 lds
    s_mov_b32 m0, 28544
    s_nop 0
    buffer_load_dwordx4 v1, s[8:11], s75 offen offset:128 sc1 lds
    s_mov_b32 m0, 29440
    s_nop 0
    buffer_load_dwordx4 v1, s[8:11], s75 offen offset:256 sc1 lds
    s_mov_b32 m0, 30336
    s_nop 0
    buffer_load_dwordx4 v1, s[8:11], s75 offen offset:384 sc1 lds
    s_mov_b32 m0, 31232
    s_nop 0
    buffer_load_dwordx4 v1, s[8:11], s75 offen offset:512 sc1 lds
    s_mov_b32 m0, 32128
    s_nop 0
    buffer_load_dwordx4 v1, s[8:11], s75 offen offset:640 sc1 lds
    s_mov_b32 m0, 33024
    s_nop 0
    buffer_load_dwordx4 v1, s[8:11], s75 offen offset:768 sc1 lds
    s_mov_b32 m0, 33920
    s_nop 0
    buffer_load_dwordx4 v1, s[8:11], s75 offen offset:896 sc1 lds
    s_mov_b32 m0, 34816
    s_nop 0
    buffer_load_dwordx4 v1, s[8:11], s75 offen offset:1024 sc1 lds
    s_branch L_join_41
L_att_38:
    ds_read_b128 v[64:67], v191 offset:0
    ds_read_b128 v[80:83], v202 offset:36864
    ds_read_b128 v[84:87], v202 offset:37888
    ds_read_b128 v[68:71], v191 offset:1024
    ds_read_b128 v[88:91], v202 offset:40960
    ds_read_b128 v[92:95], v202 offset:41984
    ds_read_b128 v[72:75], v191 offset:2048
    ds_read_b128 v[96:99], v202 offset:45056
    ds_read_b128 v[100:103], v202 offset:46080
    ds_read_b128 v[76:79], v191 offset:3072
    ds_read_b128 v[104:107], v202 offset:49152
    ds_read_b128 v[108:111], v202 offset:50176
    s_waitcnt lgkmcnt(9)
    v_mfma_f32_16x16x32_bf16 v[48:51], v[80:83], v[64:67], v[16:19]
    ds_read_b128 v[112:115], v202 offset:38912
    v_mfma_f32_16x16x32_bf16 v[52:55], v[84:87], v[64:67], v[20:23]
    ds_read_b128 v[116:119], v202 offset:39936
    s_waitcnt lgkmcnt(8)
    v_mfma_f32_16x16x32_bf16 v[48:51], v[88:91], v[68:71], v[48:51]
    ds_read_b128 v[120:123], v202 offset:43008
    v_mfma_f32_16x16x32_bf16 v[52:55], v[92:95], v[68:71], v[52:55]
    ds_read_b128 v[124:127], v202 offset:44032
    s_waitcnt lgkmcnt(7)
    v_mfma_f32_16x16x32_bf16 v[48:51], v[96:99], v[72:75], v[48:51]
    ds_read_b128 v[128:131], v202 offset:47104
    v_mfma_f32_16x16x32_bf16 v[52:55], v[100:103], v[72:75], v[52:55]
    ds_read_b128 v[132:135], v202 offset:48128
    s_waitcnt lgkmcnt(6)
    v_mfma_f32_16x16x32_bf16 v[48:51], v[104:107], v[76:79], v[48:51]
    ds_read_b128 v[136:139], v202 offset:51200
    v_mfma_f32_16x16x32_bf16 v[52:55], v[108:111], v[76:79], v[52:55]
    ds_read_b128 v[140:143], v202 offset:52224
    s_cmp_eq_u32 s70, 1
    s_cbranch_scc1 L_kmh_42
    s_mov_b32 s60, 1048576
L_poll_53:
    buffer_load_dword v193, v15, s[8:11], s93 offen sc1
    s_waitcnt vmcnt(0)
    v_cmp_eq_u32 vcc, 0, v193
    s_cbranch_vccz L_pdone_54
    s_sleep 2
    s_sub_u32 s60, s60, 1
    s_cbranch_scc1 L_abort
    s_branch L_poll_53
L_pdone_54:
    s_add_u32 s76, s87, 16384
    s_add_u32 s77, s76, 4096
    buffer_load_dwordx4 v[144:147], v4, s[8:11], s76 offen offset:0 sc1
    buffer_load_dwordx4 v[148:151], v4, s[8:11], s76 offen offset:2048 sc1
    buffer_load_dwordx4 v[152:155], v4, s[8:11], s77 offen offset:0 sc1
    buffer_load_dwordx4 v[156:159], v4, s[8:11], s77 offen offset:2048 sc1
    buffer_load_dwordx2 v[160:161], v200, s[8:11], s76 offen offset:0 sc1
    buffer_load_dwordx2 v[162:163], v200, s[8:11], s76 offen offset:2048 sc1
    buffer_load_dwordx2 v[164:165], v200, s[8:11], s77 offen offset:0 sc1
    buffer_load_dwordx2 v[166:167], v200, s[8:11], s77 offen offset:2048 sc1
L_kmh_42:
    s_nop 4
    v_max3_f32 v60, v48, v49, v50
    v_max3_f32 v61, v51, v52, v53
    v_max3_f32 v60, v60, v54, v55
    s_waitcnt vmcnt(7)
    v_mfma_f32_16x16x32_bf16 v[56:59], v[144:147], v[64:67], 0
    s_waitcnt vmcnt(6)
    v_mfma_f32_16x16x32_bf16 v[56:59], v[148:151], v[68:71], v[56:59]
    s_waitcnt vmcnt(5)
    v_mfma_f32_16x16x32_bf16 v[56:59], v[152:155], v[72:75], v[56:59]
    s_waitcnt vmcnt(4)
    v_mfma_f32_16x16x32_bf16 v[56:59], v[156:159], v[76:79], v[56:59]
    buffer_load_dwordx2 v[40:41], v192, s[8:11], s90 offen sc1
    s_nop 6
    v_max3_f32 v61, v61, v56, v57
    v_max_f32 v60, v60, v61
    v_mov_b32 v61, v60
    s_nop 1
    v_permlane16_swap_b32 v60, v61
    v_max_f32 v60, v60, v61
    v_mov_b32 v61, v60
    s_nop 1
    v_permlane32_swap_b32 v60, v61
    v_max_f32 v60, v60, v61
    v_mul_f32 v60, s83, v60
    v_fma_f32 v48, v48, s83, -v60
    v_fma_f32 v49, v49, s83, -v60
    v_fma_f32 v50, v50, s83, -v60
    v_fma_f32 v51, v51, s83, -v60
    v_fma_f32 v52, v52, s83, -v60
    v_fma_f32 v53, v53, s83, -v60
    v_fma_f32 v54, v54, s83, -v60
    v_fma_f32 v55, v55, s83, -v60
    v_fma_f32 v56, v56, s83, -v60
    v_fma_f32 v57, v57, s83, -v60
    v_exp_f32 v48, v48
    v_exp_f32 v49, v49
    v_exp_f32 v50, v50
    v_exp_f32 v51, v51
    v_exp_f32 v52, v52
    v_exp_f32 v53, v53
    v_exp_f32 v54, v54
    v_exp_f32 v55, v55
    v_exp_f32 v56, v56
    v_exp_f32 v57, v57
    v_cvt_pk_bf16_f32 v32, v48, v49
    v_cvt_pk_bf16_f32 v33, v50, v51
    v_cvt_pk_bf16_f32 v34, v52, v53
    v_cvt_pk_bf16_f32 v35, v54, v55
    v_cvt_pk_bf16_f32 v36, v56, v57
    v_mov_b32 v37, 0
    v_mov_b32 v38, 0
    v_mov_b32 v39, v36
    s_waitcnt vmcnt(1) lgkmcnt(0)
    v_mfma_f32_16x16x32_bf16 v[44:47], v[24:27], v[32:35], 0
    v_mfma_f32_16x16x32_bf16 v[80:83], v[112:115], v[32:35], 0
    v_mfma_f32_16x16x32_bf16 v[84:87], v[116:119], v[32:35], 0
    v_mfma_f32_16x16x16_bf16 v[44:47], v[24:25], v[36:37], v[44:47]
    v_mfma_f32_16x16x16_bf16 v[80:83], v[160:161], v[36:37], v[80:83]
    v_mfma_f32_16x16x16_bf16 v[84:87], v[160:161], v[38:39], v[84:87]
    v_mfma_f32_16x16x32_bf16 v[88:91], v[120:123], v[32:35], 0
    v_rcp_f32 v44, v44
    v_mfma_f32_16x16x32_bf16 v[92:95], v[124:127], v[32:35], 0
    v_mfma_f32_16x16x16_bf16 v[88:91], v[162:163], v[36:37], v[88:91]
    v_mul_f32 v80, v80, v44
    v_mul_f32 v81, v81, v44
    v_mul_f32 v82, v82, v44
    v_mfma_f32_16x16x16_bf16 v[92:95], v[162:163], v[38:39], v[92:95]
    v_mul_f32 v83, v83, v44
    v_mul_f32 v84, v84, v44
    v_mul_f32 v85, v85, v44
    v_mfma_f32_16x16x32_bf16 v[96:99], v[128:131], v[32:35], 0
    v_mul_f32 v86, v86, v44
    v_mul_f32 v87, v87, v44
    v_cvt_pk_bf16_f32 v48, v80, v81
    v_mfma_f32_16x16x32_bf16 v[100:103], v[132:135], v[32:35], 0
    v_cvt_pk_bf16_f32 v49, v82, v83
    v_cvt_pk_bf16_f32 v50, v84, v85
    v_cvt_pk_bf16_f32 v51, v86, v87
    v_mfma_f32_16x16x16_bf16 v[96:99], v[164:165], v[36:37], v[96:99]
    ds_write_b128 v191, v[48:51] offset:8192
    v_mul_f32 v88, v88, v44
    v_mul_f32 v89, v89, v44
    v_mfma_f32_16x16x16_bf16 v[100:103], v[164:165], v[38:39], v[100:103]
    v_mul_f32 v90, v90, v44
    v_mul_f32 v91, v91, v44
    v_mul_f32 v92, v92, v44
    v_mfma_f32_16x16x32_bf16 v[104:107], v[136:139], v[32:35], 0
    v_mul_f32 v93, v93, v44
    v_mul_f32 v94, v94, v44
    v_mul_f32 v95, v95, v44
    v_mfma_f32_16x16x32_bf16 v[108:111], v[140:143], v[32:35], 0
    v_cvt_pk_bf16_f32 v52, v88, v89
    v_cvt_pk_bf16_f32 v53, v90, v91
    v_cvt_pk_bf16_f32 v54, v92, v93
    v_mfma_f32_16x16x16_bf16 v[104:107], v[166:167], v[36:37], v[104:107]
    v_cvt_pk_bf16_f32 v55, v94, v95
    ds_write_b128 v191, v[52:55] offset:9216
    v_mul_f32 v96, v96, v44
    v_mfma_f32_16x16x16_bf16 v[108:111], v[166:167], v[38:39], v[108:111]
    v_mul_f32 v97, v97, v44
    v_mul_f32 v98, v98, v44
    v_mul_f32 v99, v99, v44
    v_mul_f32 v100, v100, v44
    v_mul_f32 v101, v101, v44
    v_mul_f32 v102, v102, v44
    v_mul_f32 v103, v103, v44
    v_cvt_pk_bf16_f32 v56, v96, v97
    v_cvt_pk_bf16_f32 v57, v98, v99
    v_cvt_pk_bf16_f32 v58, v100, v101
    v_cvt_pk_bf16_f32 v59, v102, v103
    ds_write_b128 v191, v[56:59] offset:10240
    v_mul_f32 v104, v104, v44
    v_mul_f32 v105, v105, v44
    v_mul_f32 v106, v106, v44
    v_mul_f32 v107, v107, v44
    v_mul_f32 v108, v108, v44
    v_mul_f32 v109, v109, v44
    v_mul_f32 v110, v110, v44
    v_mul_f32 v111, v111, v44
    v_cvt_pk_bf16_f32 v60, v104, v105
    v_cvt_pk_bf16_f32 v61, v106, v107
    v_cvt_pk_bf16_f32 v62, v108, v109
    v_cvt_pk_bf16_f32 v63, v110, v111
    ds_write_b128 v191, v[60:63] offset:11264
    s_waitcnt vmcnt(0)
    v_and_b32 v40, v40, v41
    v_cmp_ne_u32 vcc, -1, v40
    s_cbranch_vccnz L_rf_55
L_rfok_56:
L_join_41:
    s_lshl_b32 s82, s67, 5
    s_add_u32 s82, s82, s5
    s_lshl_b32 s81, s66, 11
    s_add_u32 s81, s81, s82
    s_mov_b32 s88, s80
    s_lshl_b32 s77, s5, 10
    s_add_u32 s77, s77, s88
    s_lshl_b32 s84, s5, 8
    s_lshl_b32 s63, s3, 6
    s_add_u32 s84, s84, s63
    s_add_u32 s84, s84, s88
    s_add_u32 s84, s84, 1052672
    s_lshl_b32 s63, s3, 8
    s_add_u32 s77, s77, s63
    s_add_u32 s78, s77, 526336
    s_waitcnt lgkmcnt(0)
    s_barrier
    ds_read_b128 v[80:83], v6 offset:8192
    ds_read_b128 v[84:87], v6 offset:9216
    ds_read_b128 v[88:91], v6 offset:10240
    ds_read_b128 v[92:95], v6 offset:11264
    ds_read_b128 v[96:99], v6 offset:12288
    ds_read_b128 v[100:103], v6 offset:13312
    ds_read_b128 v[104:107], v6 offset:14336
    ds_read_b128 v[108:111], v6 offset:15360
    s_lshl_b32 s89, s81, 4
    s_lshl_b32 s64, s3, 2
    s_add_u32 s89, s89, s64
    s_add_u32 s89, s89, 196608
    s_lshr_b32 s90, s81, 5
    s_lshl_b32 s90, s90, 9
    s_add_u32 s90, s90, 196608
    s_mul_i32 s91, s5, 32896
    s_add_u32 s91, s91, s88
    s_lshr_b32 s92, s5, 1
    s_lshl_b32 s92, s92, 13
    s_lshl_b32 s64, s3, 11
    s_add_u32 s92, s92, s64
    s_add_u32 s92, s92, s88
    s_add_u32 s92, s92, 1052672
    s_add_u32 s91, s91, s63
    s_xor_b32 s68, s68, 16384
    v_xor_b32 v202, 16384, v202
    s_waitcnt lgkmcnt(7)
    v_mfma_f32_16x16x32_bf16 v[112:115], v[80:83], a[144:147], 0
    v_mfma_f32_16x16x32_bf16 v[116:119], v[80:83], a[160:163], 0
    v_mfma_f32_16x16x32_bf16 v[120:123], v[80:83], a[176:179], 0
    v_mfma_f32_16x16x32_bf16 v[124:127], v[80:83], a[192:195], 0
    v_mfma_f32_16x16x32_bf16 v[128:131], v[80:83], a[208:211], 0
    v_mfma_f32_16x16x32_bf16 v[132:135], v[80:83], a[224:227], 0
    v_mfma_f32_16x16x32_bf16 v[136:139], v[80:83], a[240:243], 0
    buffer_load_dwordx2 v[194:195], v192, s[8:11], s90 offen sc1
    v_mfma_f32_16x16x32_bf16 v[140:143], v[80:83], v[224:227], 0
    s_waitcnt lgkmcnt(6)
    v_mfma_f32_16x16x32_bf16 v[112:115], v[84:87], a[148:151], v[112:115]
    v_mfma_f32_16x16x32_bf16 v[116:119], v[84:87], a[164:167], v[116:119]
    v_mfma_f32_16x16x32_bf16 v[120:123], v[84:87], a[180:183], v[120:123]
    v_mfma_f32_16x16x32_bf16 v[124:127], v[84:87], a[196:199], v[124:127]
    v_mfma_f32_16x16x32_bf16 v[128:131], v[84:87], a[212:215], v[128:131]
    v_mfma_f32_16x16x32_bf16 v[132:135], v[84:87], a[228:231], v[132:135]
    v_mfma_f32_16x16x32_bf16 v[136:139], v[84:87], a[244:247], v[136:139]
    v_mfma_f32_16x16x32_bf16 v[140:143], v[84:87], v[228:231], v[140:143]
    s_waitcnt lgkmcnt(5)
    v_mfma_f32_16x16x32_bf16 v[112:115], v[88:91], a[152:155], v[112:115]
    v_mfma_f32_16x16x32_bf16 v[116:119], v[88:91], a[168:171], v[116:119]
    v_mfma_f32_16x16x32_bf16 v[120:123], v[88:91], a[184:187], v[120:123]
    v_mfma_f32_16x16x32_bf16 v[124:127], v[88:91], a[200:203], v[124:127]
    v_mfma_f32_16x16x32_bf16 v[128:131], v[88:91], a[216:219], v[128:131]
    v_mfma_f32_16x16x32_bf16 v[132:135], v[88:91], a[232:235], v[132:135]
    v_mfma_f32_16x16x32_bf16 v[136:139], v[88:91], a[248:251], v[136:139]
    s_cmp_eq_u32 s69, 0
    s_cbranch_scc1 L_fl_57
    s_waitcnt vmcnt(5)
    s_mov_b64 exec, 1
    buffer_store_dword v24, v14, s[8:11], s69 offen sc1
    s_mov_b64 exec, -1
    s_mov_b32 s69, 0
L_fl_57:
    v_mfma_f32_16x16x32_bf16 v[140:143], v[88:91], v[232:235], v[140:143]
    s_waitcnt lgkmcnt(4)
    v_mfma_f32_16x16x32_bf16 v[112:115], v[92:95], a[156:159], v[112:115]
    v_mfma_f32_16x16x32_bf16 v[116:119], v[92:95], a[172:175], v[116:119]
    v_mfma_f32_16x16x32_bf16 v[120:123], v[92:95], a[188:191], v[120:123]
    v_mfma_f32_16x16x32_bf16 v[124:127], v[92:95], a[204:207], v[124:127]
    v_mfma_f32_16x16x32_bf16 v[128:131], v[92:95], a[220:223], v[128:131]
    v_mfma_f32_16x16x32_bf16 v[132:135], v[92:95], a[236:239], v[132:135]
    v_mfma_f32_16x16x32_bf16 v[136:139], v[92:95], a[252:255], v[136:139]
    v_mfma_f32_16x16x32_bf16 v[140:143], v[92:95], v[236:239], v[140:143]
    s_waitcnt lgkmcnt(0)
    v_mfma_f32_16x16x32_bf16 v[144:147], v[96:99], a[144:147], 0
    v_cvt_pk_bf16_f32 v32, v112, v116
    v_mfma_f32_16x16x32_bf16 v[148:151], v[96:99], a[160:163], 0
    v_cvt_pk_bf16_f32 v33, v120, v124
    v_mfma_f32_16x16x32_bf16 v[152:155], v[96:99], a[176:179], 0
    v_cvt_pk_bf16_f32 v34, v128, v132
    v_mfma_f32_16x16x32_bf16 v[156:159], v[96:99], a[192:195], 0
    v_cvt_pk_bf16_f32 v35, v136, v140
    v_mfma_f32_16x16x32_bf16 v[160:163], v[96:99], a[208:211], 0
    buffer_store_dwordx4 v[32:35], v7, s[8:11], s77 offen
    s_add_u32 s77, s77, 32896
    v_mfma_f32_16x16x32_bf16 v[164:167], v[96:99], a[224:227], 0
    v_mfma_f32_16x16x32_bf16 v[168:171], v[96:99], a[240:243], 0
    v_mfma_f32_16x16x32_bf16 v[172:175], v[96:99], v[224:227], 0
    v_mfma_f32_16x16x32_bf16 v[144:147], v[100:103], a[148:151], v[144:147]
    v_cvt_pk_bf16_f32 v36, v113, v117
    v_mfma_f32_16x16x32_bf16 v[148:151], v[100:103], a[164:167], v[148:151]
    v_cvt_pk_bf16_f32 v37, v121, v125
    v_mfma_f32_16x16x32_bf16 v[152:155], v[100:103], a[180:183], v[152:155]
    v_cvt_pk_bf16_f32 v38, v129, v133
    v_mfma_f32_16x16x32_bf16 v[156:159], v[100:103], a[196:199], v[156:159]
    v_cvt_pk_bf16_f32 v39, v137, v141
    v_mfma_f32_16x16x32_bf16 v[160:163], v[100:103], a[212:215], v[160:163]
    buffer_store_dwordx4 v[36:39], v7, s[8:11], s77 offen
    s_add_u32 s77, s77, 32896
    v_mfma_f32_16x16x32_bf16 v[164:167], v[100:103], a[228:231], v[164:167]
    v_mfma_f32_16x16x32_bf16 v[168:171], v[100:103], a[244:247], v[168:171]
    v_mfma_f32_16x16x32_bf16 v[172:175], v[100:103], v[228:231], v[172:175]
    v_mfma_f32_16x16x32_bf16 v[144:147], v[104:107], a[152:155], v[144:147]
    v_cvt_pk_bf16_f32 v40, v114, v118
    v_mfma_f32_16x16x32_bf16 v[148:151], v[104:107], a[168:171], v[148:151]
    v_cvt_pk_bf16_f32 v41, v122, v126
    v_mfma_f32_16x16x32_bf16 v[152:155], v[104:107], a[184:187], v[152:155]
    v_cvt_pk_bf16_f32 v42, v130, v134
    v_mfma_f32_16x16x32_bf16 v[156:159], v[104:107], a[200:203], v[156:159]
    v_cvt_pk_bf16_f32 v43, v138, v142
    v_mfma_f32_16x16x32_bf16 v[160:163], v[104:107], a[216:219], v[160:163]
    buffer_store_dwordx4 v[40:43], v7, s[8:11], s77 offen
    s_add_u32 s77, s77, 32896
    v_mfma_f32_16x16x32_bf16 v[164:167], v[104:107], a[232:235], v[164:167]
    v_mfma_f32_16x16x32_bf16 v[168:171], v[104:107], a[248:251], v[168:171]
    v_mfma_f32_16x16x32_bf16 v[172:175], v[104:107], v[232:235], v[172:175]
    v_mfma_f32_16x16x32_bf16 v[144:147], v[108:111], a[156:159], v[144:147]
    v_cvt_pk_bf16_f32 v44, v115, v119
    v_mfma_f32_16x16x32_bf16 v[148:151], v[108:111], a[172:175], v[148:151]
    v_cvt_pk_bf16_f32 v45, v123, v127
    v_mfma_f32_16x16x32_bf16 v[152:155], v[108:111], a[188:191], v[152:155]
    v_cvt_pk_bf16_f32 v46, v131, v135
    v_mfma_f32_16x16x32_bf16 v[156:159], v[108:111], a[204:207], v[156:159]
    v_cvt_pk_bf16_f32 v47, v139, v143
    v_mfma_f32_16x16x32_bf16 v[160:163], v[108:111], a[220:223], v[160:163]
    buffer_store_dwordx4 v[44:47], v7, s[8:11], s77 offen
    v_mfma_f32_16x16x32_bf16 v[164:167], v[108:111], a[236:239], v[164:167]
    v_mfma_f32_16x16x32_bf16 v[168:171], v[108:111], a[252:255], v[168:171]
    v_mfma_f32_16x16x32_bf16 v[172:175], v[108:111], v[236:239], v[172:175]
    v_mfma_f32_16x16x32_bf16 v[48:51], v[80:83], v[240:243], 0
    v_cvt_pk_bf16_f32 v112, v144, v148
    v_cvt_pk_bf16_f32 v116, v145, v149
    v_mfma_f32_16x16x32_bf16 v[52:55], v[96:99], v[240:243], 0
    v_cvt_pk_bf16_f32 v120, v146, v150
    v_cvt_pk_bf16_f32 v124, v147, v151
    v_mfma_f32_16x16x32_bf16 v[48:51], v[84:87], v[244:247], v[48:51]
    v_cvt_pk_bf16_f32 v113, v152, v156
    v_cvt_pk_bf16_f32 v117, v153, v157
    v_mfma_f32_16x16x32_bf16 v[52:55], v[100:103], v[244:247], v[52:55]
    v_cvt_pk_bf16_f32 v121, v154, v158
    v_cvt_pk_bf16_f32 v125, v155, v159
    v_mfma_f32_16x16x32_bf16 v[48:51], v[88:91], v[248:251], v[48:51]
    v_cvt_pk_bf16_f32 v114, v160, v164
    v_cvt_pk_bf16_f32 v118, v161, v165
    v_mfma_f32_16x16x32_bf16 v[52:55], v[104:107], v[248:251], v[52:55]
    v_cvt_pk_bf16_f32 v122, v162, v166
    v_cvt_pk_bf16_f32 v126, v163, v167
    v_mfma_f32_16x16x32_bf16 v[48:51], v[92:95], v[252:255], v[48:51]
    v_cvt_pk_bf16_f32 v115, v168, v172
    v_cvt_pk_bf16_f32 v119, v169, v173
    v_mfma_f32_16x16x32_bf16 v[52:55], v[108:111], v[252:255], v[52:55]
    v_cvt_pk_bf16_f32 v123, v170, v174
    v_cvt_pk_bf16_f32 v127, v171, v175
    buffer_store_dwordx4 v[112:115], v7, s[8:11], s78 offen
    s_add_u32 s78, s78, 32896
    v_cvt_pk_bf16_f32 v128, v48, v49
    v_cvt_pk_bf16_f32 v129, v50, v51
    s_nop 1
    v_cvt_pk_bf16_f32 v130, v52, v53
    v_cvt_pk_bf16_f32 v131, v54, v55
    s_cmp_ge_u32 s67, 62
    s_cbranch_scc1 L_qo_doneF
    s_add_u32 s67, s67, 2
    s_waitcnt vmcnt(6)
    s_lshl_b32 s87, s66, 5
    s_add_u32 s87, s87, s5
    s_mul_i32 s87, s87, 2101248
    s_mul_i32 s63, s67, 24576
    s_add_u32 s87, s87, s63
    s_add_u32 s87, s87, 67108864
    s_lshl_b32 s93, s66, 5
    s_add_u32 s93, s93, s5
    s_lshl_b32 s93, s93, 2
    s_lshl_b32 s93, s93, 6
    s_add_u32 s93, s93, s67
    s_lshl_b32 s93, s93, 2
    s_add_u32 s93, s93, 131072
    s_mov_b32 s70, 0
    s_barrier
    ds_read_b128 v[32:35], v2 offset:0
    ds_read_b128 v[36:39], v2 offset:18432
    ds_read_b128 v[40:43], v3 offset:0
    ds_read_b128 v[44:47], v3 offset:18432
    ds_read_b128 v[48:51], v2 offset:1024
    ds_read_b128 v[52:55], v2 offset:19456
    ds_read_b128 v[56:59], v3 offset:1024
    ds_read_b128 v[60:63], v3 offset:19456
    s_waitcnt lgkmcnt(6)
    v_mfma_f32_16x16x32_bf16 v[64:67], a[0:3], v[32:35], 0
    v_mfma_f32_16x16x32_bf16 v[68:71], a[4:7], v[32:35], 0
    v_mfma_f32_16x16x32_bf16 v[72:75], a[0:3], v[36:39], 0
    v_mfma_f32_16x16x32_bf16 v[76:79], a[4:7], v[36:39], 0
    buffer_store_dwordx4 v[116:119], v7, s[8:11], s78 offen
    s_add_u32 s78, s78, 32896
    ds_read_b128 v[32:35], v2 offset:2048
    ds_read_b128 v[36:39], v2 offset:20480
    s_waitcnt lgkmcnt(6)
    v_mfma_f32_16x16x32_bf16 v[64:67], a[8:11], v[40:43], v[64:67]
    v_mfma_f32_16x16x32_bf16 v[68:71], a[12:15], v[40:43], v[68:71]
    v_mfma_f32_16x16x32_bf16 v[72:75], a[8:11], v[44:47], v[72:75]
    v_mfma_f32_16x16x32_bf16 v[76:79], a[12:15], v[44:47], v[76:79]
    buffer_store_dwordx4 v[120:123], v7, s[8:11], s78 offen
    s_add_u32 s78, s78, 32896
    ds_read_b128 v[40:43], v3 offset:2048
    ds_read_b128 v[44:47], v3 offset:20480
    s_waitcnt lgkmcnt(6)
    v_mfma_f32_16x16x32_bf16 v[64:67], a[16:19], v[48:51], v[64:67]
    v_mfma_f32_16x16x32_bf16 v[68:71], a[20:23], v[48:51], v[68:71]
    v_mfma_f32_16x16x32_bf16 v[72:75], a[16:19], v[52:55], v[72:75]
    v_mfma_f32_16x16x32_bf16 v[76:79], a[20:23], v[52:55], v[76:79]
    buffer_store_dwordx4 v[124:127], v7, s[8:11], s78 offen
    ds_read_b128 v[48:51], v2 offset:3072
    ds_read_b128 v[52:55], v2 offset:21504
    s_waitcnt lgkmcnt(6)
    v_mfma_f32_16x16x32_bf16 v[64:67], a[24:27], v[56:59], v[64:67]
    v_mfma_f32_16x16x32_bf16 v[68:71], a[28:31], v[56:59], v[68:71]
    buffer_store_dword v128, v8, s[8:11], s84 offen
    s_add_u32 s84, s84, 8192
    v_mfma_f32_16x16x32_bf16 v[72:75], a[24:27], v[60:63], v[72:75]
    v_mfma_f32_16x16x32_bf16 v[76:79], a[28:31], v[60:63], v[76:79]
    buffer_store_dword v129, v8, s[8:11], s84 offen
    s_add_u32 s84, s84, 57344
    ds_read_b128 v[56:59], v3 offset:3072
    ds_read_b128 v[60:63], v3 offset:21504
    s_waitcnt lgkmcnt(6)
    v_mfma_f32_16x16x32_bf16 v[64:67], a[32:35], v[32:35], v[64:67]
    v_mfma_f32_16x16x32_bf16 v[68:71], a[36:39], v[32:35], v[68:71]
    buffer_store_dword v130, v8, s[8:11], s84 offen
    s_add_u32 s84, s84, 8192
    v_mfma_f32_16x16x32_bf16 v[72:75], a[32:35], v[36:39], v[72:75]
    v_mfma_f32_16x16x32_bf16 v[76:79], a[36:39], v[36:39], v[76:79]
    buffer_store_dword v131, v8, s[8:11], s84 offen
    ds_read_b128 v[32:35], v2 offset:4096
    ds_read_b128 v[36:39], v2 offset:22528
    s_waitcnt lgkmcnt(6)
    v_mfma_f32_16x16x32_bf16 v[64:67], a[40:43], v[40:43], v[64:67]
    v_mfma_f32_16x16x32_bf16 v[68:71], a[44:47], v[40:43], v[68:71]
    v_mfma_f32_16x16x32_bf16 v[72:75], a[40:43], v[44:47], v[72:75]
    v_mfma_f32_16x16x32_bf16 v[76:79], a[44:47], v[44:47], v[76:79]
    ds_read_b128 v[40:43], v3 offset:4096
    ds_read_b128 v[44:47], v3 offset:22528
    s_waitcnt lgkmcnt(6)
    v_mfma_f32_16x16x32_bf16 v[64:67], a[48:51], v[48:51], v[64:67]
    v_mfma_f32_16x16x32_bf16 v[68:71], a[52:55], v[48:51], v[68:71]
    v_mfma_f32_16x16x32_bf16 v[72:75], a[48:51], v[52:55], v[72:75]
    v_mfma_f32_16x16x32_bf16 v[76:79], a[52:55], v[52:55], v[76:79]
    ds_read_b128 v[48:51], v2 offset:5120
    ds_read_b128 v[52:55], v2 offset:23552
    s_waitcnt lgkmcnt(6)
    v_mfma_f32_16x16x32_bf16 v[64:67], a[56:59], v[56:59], v[64:67]
    v_mfma_f32_16x16x32_bf16 v[68:71], a[60:63], v[56:59], v[68:71]
    v_mfma_f32_16x16x32_bf16 v[72:75], a[56:59], v[60:63], v[72:75]
    v_mfma_f32_16x16x32_bf16 v[76:79], a[60:63], v[60:63], v[76:79]
    ds_read_b128 v[56:59], v3 offset:5120
    ds_read_b128 v[60:63], v3 offset:23552
    s_waitcnt lgkmcnt(6)
    v_mfma_f32_16x16x32_bf16 v[64:67], a[64:67], v[32:35], v[64:67]
    v_mfma_f32_16x16x32_bf16 v[68:71], a[68:71], v[32:35], v[68:71]
    v_mfma_f32_16x16x32_bf16 v[72:75], a[64:67], v[36:39], v[72:75]
    v_mfma_f32_16x16x32_bf16 v[76:79], a[68:71], v[36:39], v[76:79]
    s_waitcnt vmcnt(0)
    s_mov_b64 exec, 1
    buffer_store_dword v24, v14, s[8:11], s89 offen
    s_mov_b64 exec, -1
    ds_read_b128 v[32:35], v2 offset:6144
    ds_read_b128 v[36:39], v2 offset:24576
    s_waitcnt lgkmcnt(6)
    v_mfma_f32_16x16x32_bf16 v[64:67], a[72:75], v[40:43], v[64:67]
    v_mfma_f32_16x16x32_bf16 v[68:71], a[76:79], v[40:43], v[68:71]
    v_mfma_f32_16x16x32_bf16 v[72:75], a[72:75], v[44:47], v[72:75]
    v_mfma_f32_16x16x32_bf16 v[76:79], a[76:79], v[44:47], v[76:79]
    ds_read_b128 v[40:43], v3 offset:6144
    ds_read_b128 v[44:47], v3 offset:24576
    s_waitcnt lgkmcnt(6)
    v_mfma_f32_16x16x32_bf16 v[64:67], a[80:83], v[48:51], v[64:67]
    v_mfma_f32_16x16x32_bf16 v[68:71], a[84:87], v[48:51], v[68:71]
    v_mfma_f32_16x16x32_bf16 v[72:75], a[80:83], v[52:55], v[72:75]
    v_mfma_f32_16x16x32_bf16 v[76:79], a[84:87], v[52:55], v[76:79]
    ds_read_b128 v[48:51], v2 offset:7168
    ds_read_b128 v[52:55], v2 offset:25600
    s_waitcnt lgkmcnt(6)
    v_mfma_f32_16x16x32_bf16 v[64:67], a[88:91], v[56:59], v[64:67]
    v_mfma_f32_16x16x32_bf16 v[68:71], a[92:95], v[56:59], v[68:71]
    v_mfma_f32_16x16x32_bf16 v[72:75], a[88:91], v[60:63], v[72:75]
    v_mfma_f32_16x16x32_bf16 v[76:79], a[92:95], v[60:63], v[76:79]
    ds_read_b128 v[56:59], v3 offset:7168
    ds_read_b128 v[60:63], v3 offset:25600
    s_waitcnt lgkmcnt(6)
    v_mfma_f32_16x16x32_bf16 v[64:67], a[96:99], v[32:35], v[64:67]
    v_mfma_f32_16x16x32_bf16 v[68:71], a[100:103], v[32:35], v[68:71]
    v_mfma_f32_16x16x32_bf16 v[72:75], a[96:99], v[36:39], v[72:75]
    v_mfma_f32_16x16x32_bf16 v[76:79], a[100:103], v[36:39], v[76:79]
    ds_read_b128 v[32:35], v2 offset:8192
    ds_read_b128 v[36:39], v2 offset:26624
    s_waitcnt lgkmcnt(6)
    v_mfma_f32_16x16x32_bf16 v[64:67], a[104:107], v[40:43], v[64:67]
    v_mfma_f32_16x16x32_bf16 v[68:71], a[108:111], v[40:43], v[68:71]
    v_mfma_f32_16x16x32_bf16 v[72:75], a[104:107], v[44:47], v[72:75]
    v_mfma_f32_16x16x32_bf16 v[76:79], a[108:111], v[44:47], v[76:79]
    buffer_load_dwordx2 v[194:195], v192, s[8:11], s90 offen sc1
    ds_read_b128 v[40:43], v3 offset:8192
    ds_read_b128 v[44:47], v3 offset:26624
    s_waitcnt lgkmcnt(6)
    v_mfma_f32_16x16x32_bf16 v[64:67], a[112:115], v[48:51], v[64:67]
    v_mfma_f32_16x16x32_bf16 v[68:71], a[116:119], v[48:51], v[68:71]
    v_mfma_f32_16x16x32_bf16 v[72:75], a[112:115], v[52:55], v[72:75]
    v_mfma_f32_16x16x32_bf16 v[76:79], a[116:119], v[52:55], v[76:79]
    s_waitcnt lgkmcnt(4)
    v_mfma_f32_16x16x32_bf16 v[64:67], a[120:123], v[56:59], v[64:67]
    v_mfma_f32_16x16x32_bf16 v[68:71], a[124:127], v[56:59], v[68:71]
    v_mfma_f32_16x16x32_bf16 v[72:75], a[120:123], v[60:63], v[72:75]
    v_mfma_f32_16x16x32_bf16 v[76:79], a[124:127], v[60:63], v[76:79]
    s_waitcnt lgkmcnt(2)
    v_mfma_f32_16x16x32_bf16 v[64:67], a[128:131], v[32:35], v[64:67]
    v_mfma_f32_16x16x32_bf16 v[68:71], a[132:135], v[32:35], v[68:71]
    v_mfma_f32_16x16x32_bf16 v[72:75], a[128:131], v[36:39], v[72:75]
    v_mfma_f32_16x16x32_bf16 v[76:79], a[132:135], v[36:39], v[76:79]
    s_waitcnt lgkmcnt(0)
    v_mfma_f32_16x16x32_bf16 v[64:67], a[136:139], v[40:43], v[64:67]
    v_mfma_f32_16x16x32_bf16 v[68:71], a[140:143], v[40:43], v[68:71]
    v_mfma_f32_16x16x32_bf16 v[72:75], a[136:139], v[44:47], v[72:75]
    v_mfma_f32_16x16x32_bf16 v[76:79], a[140:143], v[44:47], v[76:79]
    v_cvt_pk_bf16_f32 v32, v64, v65
    v_cvt_pk_bf16_f32 v33, v66, v67
    v_cvt_pk_bf16_f32 v34, v68, v69
    v_cvt_pk_bf16_f32 v35, v70, v71
    ds_write_b128 v190, v[32:35] offset:0
    v_cvt_pk_bf16_f32 v36, v72, v73
    v_cvt_pk_bf16_f32 v37, v74, v75
    s_nop 0
    v_cvt_pk_bf16_f32 v38, v76, v77
    v_cvt_pk_bf16_f32 v39, v78, v79
    ds_write_b128 v190, v[36:39] offset:4096
    s_waitcnt vmcnt(0)
    v_min_u32 v194, v194, v195
    v_cmp_eq_u32 vcc, 0, v194
    s_cbranch_vccz L_qj_58
    s_mov_b32 s60, 1048576
L_poll_59:
    buffer_load_dwordx2 v[194:195], v192, s[8:11], s90 offen sc1
    s_waitcnt vmcnt(0)
    v_min_u32 v194, v194, v195
    v_cmp_eq_u32 vcc, 0, v194
    s_cbranch_vccz L_pdone_60
    s_sub_u32 s60, s60, 1
    s_cbranch_scc1 L_abort
    s_branch L_poll_59
L_pdone_60:
L_qj_58:
    buffer_load_dwordx4 v[80:83], v9, s[8:11], s91 offen sc1
    s_add_u32 s91, s91, 4096
    buffer_load_dwordx4 v[84:87], v9, s[8:11], s91 offen sc1
    s_add_u32 s91, s91, 4096
    buffer_load_dwordx4 v[88:91], v9, s[8:11], s91 offen sc1
    s_add_u32 s91, s91, 4096
    buffer_load_dwordx4 v[92:95], v9, s[8:11], s91 offen sc1
    s_add_u32 s91, s91, 4096
    buffer_load_dwordx4 v[96:99], v9, s[8:11], s91 offen sc1
    s_add_u32 s91, s91, 4096
    buffer_load_dwordx4 v[100:103], v9, s[8:11], s91 offen sc1
    s_add_u32 s91, s91, 4096
    buffer_load_dwordx4 v[104:107], v9, s[8:11], s91 offen sc1
    s_add_u32 s91, s91, 4096
    buffer_load_dwordx4 v[108:111], v9, s[8:11], s91 offen sc1
    s_add_u32 s91, s91, 4096
    buffer_load_dwordx4 v[112:115], v4, s[8:11], s92 offen offset:0 sc1
    buffer_load_dwordx4 v[116:119], v4, s[8:11], s92 offen offset:1024 sc1
    buffer_load_dword v193, v15, s[8:11], s93 offen sc1
    s_add_u32 s75, s93, -65528
    buffer_load_dword v201, v15, s[8:11], s75 offen sc1
    s_waitcnt vmcnt(11)
    v_mfma_f32_16x16x32_bf16 v[40:43], v[28:31], v[80:83], 0
    s_waitcnt vmcnt(10)
    v_mfma_f32_16x16x32_bf16 v[40:43], v[28:31], v[84:87], v[40:43]
    s_waitcnt vmcnt(9)
    v_mfma_f32_16x16x32_bf16 v[40:43], v[28:31], v[88:91], v[40:43]
    s_waitcnt vmcnt(8)
    v_mfma_f32_16x16x32_bf16 v[40:43], v[28:31], v[92:95], v[40:43]
    s_waitcnt vmcnt(7)
    v_mfma_f32_16x16x32_bf16 v[40:43], v[28:31], v[96:99], v[40:43]
    s_waitcnt vmcnt(6)
    v_mfma_f32_16x16x32_bf16 v[40:43], v[28:31], v[100:103], v[40:43]
    s_waitcnt vmcnt(5)
    v_mfma_f32_16x16x32_bf16 v[40:43], v[28:31], v[104:107], v[40:43]
    s_waitcnt vmcnt(4)
    v_mfma_f32_16x16x32_bf16 v[40:43], v[28:31], v[108:111], v[40:43]
    s_waitcnt vmcnt(3)
    v_mfma_f32_16x16x32_bf16 v[44:47], v[196:199], v[112:115], 0
    s_waitcnt vmcnt(2)
    v_mfma_f32_16x16x32_bf16 v[44:47], v[196:199], v[116:119], v[44:47]
    s_mov_b64 exec, 0xffffffff
    ds_write2_b32 v11, v40, v41 offset0:0 offset1:16
    ds_write2_b32 v11, v42, v43 offset0:32 offset1:48
    s_mov_b64 exec, 0xffff
    s_nop 3
    ds_write_b128 v12, v[44:47]
    s_mov_b64 exec, -1
    v_mov_b32 v48, -1
    s_mov_b64 exec, 1
    buffer_store_dword v48, v14, s[8:11], s89 offen
    s_mov_b64 exec, -1
    s_waitcnt vmcnt(1)
    v_cmp_eq_u32 vcc, 0, v193
    s_cbranch_vccnz L_kmn_61
    s_mov_b32 s70, 1
    s_cmp_lt_u32 s3, 2
    s_cbranch_scc1 L_kmn_61
    s_add_u32 s76, s87, 16384
    s_add_u32 s77, s76, 4096
    buffer_load_dwordx4 v[144:147], v4, s[8:11], s76 offen offset:0 sc1
    buffer_load_dwordx4 v[148:151], v4, s[8:11], s76 offen offset:2048 sc1
    buffer_load_dwordx4 v[152:155], v4, s[8:11], s77 offen offset:0 sc1
    buffer_load_dwordx4 v[156:159], v4, s[8:11], s77 offen offset:2048 sc1
    buffer_load_dwordx2 v[160:161], v200, s[8:11], s76 offen offset:0 sc1
    buffer_load_dwordx2 v[162:163], v200, s[8:11], s76 offen offset:2048 sc1
    buffer_load_dwordx2 v[164:165], v200, s[8:11], s77 offen offset:0 sc1
    buffer_load_dwordx2 v[166:167], v200, s[8:11], s77 offen offset:2048 sc1
L_kmn_61:
    s_waitcnt lgkmcnt(0)
    s_barrier
    s_branch L_qo_loopF
L_qo_doneF:
    buffer_store_dwordx4 v[116:119], v7, s[8:11], s78 offen
    s_add_u32 s78, s78, 32896
    buffer_store_dwordx4 v[120:123], v7, s[8:11], s78 offen
    s_add_u32 s78, s78, 32896
    buffer_store_dwordx4 v[124:127], v7, s[8:11], s78 offen
    buffer_store_dword v128, v8, s[8:11], s84 offen
    s_add_u32 s84, s84, 8192
    buffer_store_dword v129, v8, s[8:11], s84 offen
    s_add_u32 s84, s84, 57344
    buffer_store_dword v130, v8, s[8:11], s84 offen
    s_add_u32 s84, s84, 8192
    buffer_store_dword v131, v8, s[8:11], s84 offen
    s_waitcnt vmcnt(0)
    s_mov_b64 exec, 1
    buffer_store_dword v24, v14, s[8:11], s89 offen
    s_mov_b64 exec, -1
    s_mov_b32 s60, 1048576
L_poll_63:
    buffer_load_dwordx2 v[194:195], v192, s[8:11], s90 offen sc1
    s_waitcnt vmcnt(0)
    v_min_u32 v194, v194, v195
    v_cmp_eq_u32 vcc, 0, v194
    s_cbranch_vccz L_pdone_64
    s_sub_u32 s60, s60, 1
    s_cbranch_scc1 L_abort
    s_branch L_poll_63
L_pdone_64:
L_qj_62:
    buffer_load_dwordx4 v[80:83], v9, s[8:11], s91 offen sc1
    s_add_u32 s91, s91, 4096
    buffer_load_dwordx4 v[84:87], v9, s[8:11], s91 offen sc1
    s_add_u32 s91, s91, 4096
    buffer_load_dwordx4 v[88:91], v9, s[8:11], s91 offen sc1
    s_add_u32 s91, s91, 4096
    buffer_load_dwordx4 v[92:95], v9, s[8:11], s91 offen sc1
    s_add_u32 s91, s91, 4096
    buffer_load_dwordx4 v[96:99], v9, s[8:11], s91 offen sc1
    s_add_u32 s91, s91, 4096
    buffer_load_dwordx4 v[100:103], v9, s[8:11], s91 offen sc1
    s_add_u32 s91, s91, 4096
    buffer_load_dwordx4 v[104:107], v9, s[8:11], s91 offen sc1
    s_add_u32 s91, s91, 4096
    buffer_load_dwordx4 v[108:111], v9, s[8:11], s91 offen sc1
    s_add_u32 s91, s91, 4096
    buffer_load_dwordx4 v[112:115], v4, s[8:11], s92 offen offset:0 sc1
    buffer_load_dwordx4 v[116:119], v4, s[8:11], s92 offen offset:1024 sc1
    s_waitcnt vmcnt(9)
    v_mfma_f32_16x16x32_bf16 v[40:43], v[28:31], v[80:83], 0
    s_waitcnt vmcnt(8)
    v_mfma_f32_16x16x32_bf16 v[40:43], v[28:31], v[84:87], v[40:43]
    s_waitcnt vmcnt(7)
    v_mfma_f32_16x16x32_bf16 v[40:43], v[28:31], v[88:91], v[40:43]
    s_waitcnt vmcnt(6)
    v_mfma_f32_16x16x32_bf16 v[40:43], v[28:31], v[92:95], v[40:43]
    s_waitcnt vmcnt(5)
    v_mfma_f32_16x16x32_bf16 v[40:43], v[28:31], v[96:99], v[40:43]
    s_waitcnt vmcnt(4)
    v_mfma_f32_16x16x32_bf16 v[40:43], v[28:31], v[100:103], v[40:43]
    s_waitcnt vmcnt(3)
    v_mfma_f32_16x16x32_bf16 v[40:43], v[28:31], v[104:107], v[40:43]
    s_waitcnt vmcnt(2)
    v_mfma_f32_16x16x32_bf16 v[40:43], v[28:31], v[108:111], v[40:43]
    s_waitcnt vmcnt(1)
    v_mfma_f32_16x16x32_bf16 v[44:47], v[196:199], v[112:115], 0
    s_waitcnt vmcnt(0)
    v_mfma_f32_16x16x32_bf16 v[44:47], v[196:199], v[116:119], v[44:47]
    s_mov_b64 exec, 0xffffffff
    ds_write2_b32 v11, v40, v41 offset0:0 offset1:16
    ds_write2_b32 v11, v42, v43 offset0:32 offset1:48
    s_mov_b64 exec, 0xffff
    s_nop 3
    ds_write_b128 v12, v[44:47]
    s_mov_b64 exec, -1
    s_waitcnt lgkmcnt(0)
    s_barrier
    s_cmp_lg_u32 s3, 0
    s_cbranch_scc1 L_end_65
    v_add_u32 v40, v4, v6
    v_lshlrev_b32 v41, 1, v13
    v_add_u32 v41, 73728, v41
    ds_read_b128 v[32:35], v40 offset:16384
    ds_read_b128 v[36:39], v40 offset:16400
    ds_read_b32 v48, v41 offset:18432
    ds_read_b32 v49, v41 offset:18688
    ds_read_b32 v50, v41 offset:18944
    ds_read_b32 v51, v41 offset:19200
    v_lshlrev_b32 v80, 16, v176
    v_and_b32 v81, 0xffff0000, v176
    v_lshlrev_b32 v82, 16, v177
    v_and_b32 v83, 0xffff0000, v177
    v_lshlrev_b32 v84, 16, v178
    v_and_b32 v85, 0xffff0000, v178
    v_lshlrev_b32 v86, 16, v179
    v_and_b32 v87, 0xffff0000, v179
    v_lshlrev_b32 v88, 16, v180
    v_lshlrev_b32 v100, 16, v184
    v_and_b32 v101, 0xffff0000, v184
    v_lshlrev_b32 v102, 16, v185
    v_and_b32 v103, 0xffff0000, v185
    v_lshlrev_b32 v104, 16, v186
    v_and_b32 v105, 0xffff0000, v186
    v_lshlrev_b32 v106, 16, v187
    v_and_b32 v107, 0xffff0000, v187
    v_lshlrev_b32 v108, 16, v188
    s_mul_i32 s76, s82, 1152
    s_waitcnt lgkmcnt(0)
    v_pk_add_f32 v[48:49], v[48:49], v[50:51]
    v_add_f32 v40, v48, v49
    v_cvt_pk_bf16_f32 v64, v32, v33
    v_cvt_pk_bf16_f32 v65, v34, v35
    v_cvt_pk_bf16_f32 v66, v36, v37
    v_cvt_pk_bf16_f32 v67, v38, v39
    v_cvt_pk_bf16_f32 v68, v40, v40
    v_lshlrev_b32 v90, 16, v64
    v_and_b32 v91, 0xffff0000, v64
    v_lshlrev_b32 v92, 16, v65
    v_and_b32 v93, 0xffff0000, v65
    v_lshlrev_b32 v94, 16, v66
    v_and_b32 v95, 0xffff0000, v66
    v_lshlrev_b32 v96, 16, v67
    v_and_b32 v97, 0xffff0000, v67
    v_lshlrev_b32 v98, 16, v68
    v_pk_add_f32 v[80:81], v[80:81], v[90:91]
    v_pk_add_f32 v[82:83], v[82:83], v[92:93]
    v_pk_add_f32 v[84:85], v[84:85], v[94:95]
    v_pk_add_f32 v[86:87], v[86:87], v[96:97]
    v_add_f32 v88, v88, v98
    v_cvt_pk_bf16_f32 v64, v80, v81
    v_cvt_pk_bf16_f32 v65, v82, v83
    v_cvt_pk_bf16_f32 v66, v84, v85
    v_cvt_pk_bf16_f32 v67, v86, v87
    v_cvt_pk_bf16_f32 v68, v88, v88
    s_cmp_eq_u32 s66, 0
    s_cbranch_scc1 L_ln_66
    buffer_store_dwordx4 v[64:67], v4, s[56:59], s76 offen
    buffer_store_short v68, v13, s[56:59], s76 offen offset:1024
    s_branch L_qn_67
L_ln_66:
    v_lshlrev_b32 v80, 16, v64
    v_and_b32 v81, 0xffff0000, v64
    v_lshlrev_b32 v82, 16, v65
    v_and_b32 v83, 0xffff0000, v65
    v_lshlrev_b32 v84, 16, v66
    v_and_b32 v85, 0xffff0000, v66
    v_lshlrev_b32 v86, 16, v67
    v_and_b32 v87, 0xffff0000, v67
    v_lshlrev_b32 v88, 16, v68
    v_readfirstlane_b32 s64, v80
    s_nop 1
    v_mul_f32 v46, -1.0, s64
    v_mul_f32 v47, -1.0, s64
    v_pk_add_f32 v[90:91], v[80:81], v[46:47]
    v_pk_add_f32 v[92:93], v[82:83], v[46:47]
    v_pk_add_f32 v[94:95], v[84:85], v[46:47]
    v_pk_add_f32 v[96:97], v[86:87], v[46:47]
    v_add_f32 v98, v88, v46
    v_pk_add_f32 v[44:45], v[90:91], v[92:93]
    v_pk_mul_f32 v[42:43], v[90:91], v[90:91]
    v_pk_add_f32 v[44:45], v[44:45], v[94:95]
    v_pk_fma_f32 v[42:43], v[92:93], v[92:93], v[42:43]
    v_pk_add_f32 v[44:45], v[44:45], v[96:97]
    v_pk_fma_f32 v[42:43], v[94:95], v[94:95], v[42:43]
    v_add_f32 v44, v44, v98
    v_pk_fma_f32 v[42:43], v[96:97], v[96:97], v[42:43]
    v_add_f32 v44, v44, v45
    v_fmac_f32 v42, v98, v98
    v_add_f32 v42, v42, v43
    s_nop 1
    v_permlane32_swap_b32 v44, v42
    v_add_f32 v44, v44, v42
    v_mov_b32 v45, v44
    s_nop 1
    v_permlane16_swap_b32 v44, v45
    v_add_f32 v44, v44, v45
    s_nop 1
    v_add_f32_dpp v44, v44, v44 quad_perm:[1,0,3,2] row_mask:0xf bank_mask:0xf
    s_nop 1
    v_add_f32_dpp v44, v44, v44 quad_perm:[2,3,0,1] row_mask:0xf bank_mask:0xf
    s_nop 1
    v_add_f32_dpp v44, v44, v44 row_half_mirror row_mask:0xf bank_mask:0xf
    s_nop 1
    v_add_f32_dpp v44, v44, v44 row_mirror row_mask:0xf bank_mask:0xf
    v_mul_f32 v44, 1.7361111111e-03, v44
    s_nop 0
    v_readlane_b32 s64, v44, 0
    v_readlane_b32 s65, v44, 32
    s_nop 0
    v_mov_b32 v44, s64
    v_fma_f32 v42, -v44, v44, s65
    v_max_f32 v42, 0, v42
    v_add_f32 v42, 0x3727c5ac, v42
    v_rsq_f32 v42, v42
    v_mul_f32 v44, -1.0, v44
    v_mov_b32 v43, v42
    v_mul_f32 v44, v44, v42
    v_mov_b32 v45, v44
    v_pk_fma_f32 v[90:91], v[90:91], v[42:43], v[44:45]
    v_pk_fma_f32 v[92:93], v[92:93], v[42:43], v[44:45]
    v_pk_fma_f32 v[94:95], v[94:95], v[42:43], v[44:45]
    v_pk_fma_f32 v[96:97], v[96:97], v[42:43], v[44:45]
    v_fma_f32 v98, v98, v42, v44
    v_pk_fma_f32 v[80:81], v[90:91], v[100:101], v[80:81]
    v_pk_fma_f32 v[82:83], v[92:93], v[102:103], v[82:83]
    v_pk_fma_f32 v[84:85], v[94:95], v[104:105], v[84:85]
    v_pk_fma_f32 v[86:87], v[96:97], v[106:107], v[86:87]
    v_fma_f32 v88, v98, v108, v88
    v_cvt_pk_bf16_f32 v64, v80, v81
    v_cvt_pk_bf16_f32 v65, v82, v83
    v_cvt_pk_bf16_f32 v66, v84, v85
    v_cvt_pk_bf16_f32 v67, v86, v87
    v_cvt_pk_bf16_f32 v68, v88, v88
    s_add_u32 s77, s76, 13631488
    s_add_u32 s78, s76, 16777216
    v_add_u32 v41, 73728, v13
    buffer_store_dwordx4 v[64:67], v4, s[8:11], s77 offen sc1
    ds_write_b16 v41, v68 offset:19456
    v_lshlrev_b32 v80, 16, v64
    v_and_b32 v81, 0xffff0000, v64
    v_lshlrev_b32 v82, 16, v65
    v_and_b32 v83, 0xffff0000, v65
    v_lshlrev_b32 v84, 16, v66
    v_and_b32 v85, 0xffff0000, v66
    v_lshlrev_b32 v86, 16, v67
    v_and_b32 v87, 0xffff0000, v67
    v_lshlrev_b32 v88, 16, v68
    v_readfirstlane_b32 s64, v80
    s_nop 1
    v_mul_f32 v46, -1.0, s64
    v_mul_f32 v47, -1.0, s64
    v_pk_add_f32 v[90:91], v[80:81], v[46:47]
    v_pk_add_f32 v[92:93], v[82:83], v[46:47]
    v_pk_add_f32 v[94:95], v[84:85], v[46:47]
    v_pk_add_f32 v[96:97], v[86:87], v[46:47]
    v_add_f32 v98, v88, v46
    v_pk_add_f32 v[44:45], v[90:91], v[92:93]
    v_pk_mul_f32 v[42:43], v[90:91], v[90:91]
    v_pk_add_f32 v[44:45], v[44:45], v[94:95]
    v_pk_fma_f32 v[42:43], v[92:93], v[92:93], v[42:43]
    v_pk_add_f32 v[44:45], v[44:45], v[96:97]
    v_pk_fma_f32 v[42:43], v[94:95], v[94:95], v[42:43]
    v_add_f32 v44, v44, v98
    v_pk_fma_f32 v[42:43], v[96:97], v[96:97], v[42:43]
    v_add_f32 v44, v44, v45
    v_fmac_f32 v42, v98, v98
    v_add_f32 v42, v42, v43
    s_nop 1
    v_permlane32_swap_b32 v44, v42
    v_add_f32 v44, v44, v42
    v_mov_b32 v45, v44
    s_nop 1
    v_permlane16_swap_b32 v44, v45
    v_add_f32 v44, v44, v45
    s_nop 1
    v_add_f32_dpp v44, v44, v44 quad_perm:[1,0,3,2] row_mask:0xf bank_mask:0xf
    s_nop 1
    v_add_f32_dpp v44, v44, v44 quad_perm:[2,3,0,1] row_mask:0xf bank_mask:0xf
    s_nop 1
    v_add_f32_dpp v44, v44, v44 row_half_mirror row_mask:0xf bank_mask:0xf
    s_nop 1
    v_add_f32_dpp v44, v44, v44 row_mirror row_mask:0xf bank_mask:0xf
    v_mul_f32 v44, 1.7361111111e-03, v44
    s_nop 0
    v_readlane_b32 s64, v44, 0
    v_readlane_b32 s65, v44, 32
    s_nop 0
    v_mov_b32 v44, s64
    v_fma_f32 v42, -v44, v44, s65
    v_max_f32 v42, 0, v42
    v_sub_f32 v46, v46, v44
    v_cvt_pk_bf16_f32 v42, v42, v42
    v_and_b32 v42, 0xffff0000, v42
    v_cvt_pk_bf16_f32 v46, v46, v46
    v_and_b32 v46, 0xffff0000, v46
    v_add_f32 v42, 0x3727c5ac, v42
    v_mov_b32 v47, v46
    v_cvt_pk_bf16_f32 v42, v42, v42
    v_and_b32 v42, 0xffff0000, v42
    v_sqrt_f32 v42, v42
    v_pk_add_f32 v[90:91], v[80:81], v[46:47]
    v_pk_add_f32 v[92:93], v[82:83], v[46:47]
    v_pk_add_f32 v[94:95], v[84:85], v[46:47]
    v_pk_add_f32 v[96:97], v[86:87], v[46:47]
    v_add_f32 v98, v88, v46
    v_cvt_pk_bf16_f32 v42, v42, v42
    v_and_b32 v42, 0xffff0000, v42
    v_rcp_f32 v42, v42
    v_cvt_pk_bf16_f32 v72, v90, v91
    v_cvt_pk_bf16_f32 v73, v92, v93
    v_cvt_pk_bf16_f32 v74, v94, v95
    v_cvt_pk_bf16_f32 v75, v96, v97
    v_cvt_pk_bf16_f32 v76, v98, v98
    v_mov_b32 v43, v42
    v_lshlrev_b32 v90, 16, v72
    v_and_b32 v91, 0xffff0000, v72
    v_lshlrev_b32 v92, 16, v73
    v_and_b32 v93, 0xffff0000, v73
    v_lshlrev_b32 v94, 16, v74
    v_and_b32 v95, 0xffff0000, v74
    v_lshlrev_b32 v96, 16, v75
    v_and_b32 v97, 0xffff0000, v75
    v_lshlrev_b32 v98, 16, v76
    v_pk_mul_f32 v[90:91], v[90:91], v[42:43]
    v_pk_mul_f32 v[92:93], v[92:93], v[42:43]
    v_pk_mul_f32 v[94:95], v[94:95], v[42:43]
    v_pk_mul_f32 v[96:97], v[96:97], v[42:43]
    v_mul_f32 v98, v98, v42
    v_cvt_pk_bf16_f32 v72, v90, v91
    v_cvt_pk_bf16_f32 v73, v92, v93
    v_cvt_pk_bf16_f32 v74, v94, v95
    v_cvt_pk_bf16_f32 v75, v96, v97
    v_cvt_pk_bf16_f32 v76, v98, v98
    ds_write_b16 v41, v76 offset:19584
    buffer_store_dwordx4 v[72:75], v4, s[8:11], s78 offen sc1
    s_waitcnt lgkmcnt(0)
    ds_read_b128 v[32:35], v6 offset:19456
    ds_read_b128 v[36:39], v6 offset:19584
    s_lshr_b32 s63, s82, 5
    s_lshl_b32 s69, s5, 6
    s_add_u32 s69, s69, s63
    s_lshl_b32 s69, s69, 2
    s_add_u32 s69, s69, 24576
    s_waitcnt lgkmcnt(0)
    s_mov_b64 exec, 0xff
    buffer_store_dwordx4 v[32:35], v4, s[8:11], s77 offen offset:1024 sc1
    buffer_store_dwordx4 v[36:39], v4, s[8:11], s78 offen offset:1024 sc1
    s_mov_b64 exec, -1
L_qn_67:
    s_cmp_eq_u32 s69, 0
    s_cbranch_scc1 L_fl_68
    s_waitcnt vmcnt(0)
    s_mov_b64 exec, 1
    buffer_store_dword v24, v14, s[8:11], s69 offen sc1
    s_mov_b64 exec, -1
    s_mov_b32 s69, 0
L_fl_68:
L_end_65:
    s_endpgm
L_rf_55:
    s_cmp_lt_u32 s67, 2
    s_cbranch_scc1 L_rfok_56
    s_mov_b32 s60, 1048576
L_poll_69:
    buffer_load_dwordx2 v[40:41], v192, s[8:11], s90 offen sc1
    s_waitcnt vmcnt(0)
    v_and_b32 v40, v40, v41
    v_cmp_ne_u32 vcc, -1, v40
    s_cbranch_vccz L_pdone_70
    s_sub_u32 s60, s60, 1
    s_cbranch_scc1 L_abort
    s_branch L_poll_69
L_pdone_70:
    s_branch L_rfok_56
L_qo_safe:
    s_mov_b32 s90, 196608
    s_mov_b32 s69, 0
    v_mov_b32 v201, 0
    v_mov_b32 v202, v4
    s_lshl_b32 s87, s66, 5
    s_add_u32 s87, s87, s5
    s_mul_i32 s87, s87, 2101248
    s_mul_i32 s63, s67, 24576
    s_add_u32 s87, s87, s63
    s_add_u32 s87, s87, 67108864
    s_lshl_b32 s93, s66, 5
    s_add_u32 s93, s93, s5
    s_lshl_b32 s93, s93, 2
    s_lshl_b32 s93, s93, 6
    s_add_u32 s93, s93, s67
    s_lshl_b32 s93, s93, 2
    s_add_u32 s93, s93, 131072
    s_mov_b32 s70, 0
    s_lshl_b32 s65, s3, 12
    s_add_u32 s72, s87, s65
    s_add_u32 s72, s72, 0
    s_add_u32 m0, s65, 36864
    s_barrier
    ds_read_b128 v[32:35], v2 offset:0
    ds_read_b128 v[36:39], v2 offset:18432
    ds_read_b128 v[40:43], v3 offset:0
    ds_read_b128 v[44:47], v3 offset:18432
    ds_read_b128 v[48:51], v2 offset:1024
    ds_read_b128 v[52:55], v2 offset:19456
    ds_read_b128 v[56:59], v3 offset:1024
    ds_read_b128 v[60:63], v3 offset:19456
    s_waitcnt lgkmcnt(6)
    v_mfma_f32_16x16x32_bf16 v[64:67], a[0:3], v[32:35], 0
    v_mfma_f32_16x16x32_bf16 v[68:71], a[4:7], v[32:35], 0
    buffer_load_dwordx4 v4, s[8:11], s72 offen offset:0 sc1  lds
    v_mfma_f32_16x16x32_bf16 v[72:75], a[0:3], v[36:39], 0
    v_mfma_f32_16x16x32_bf16 v[76:79], a[4:7], v[36:39], 0
    buffer_load_dwordx4 v4, s[8:11], s72 offen offset:1024 sc1  lds
    ds_read_b128 v[32:35], v2 offset:2048
    ds_read_b128 v[36:39], v2 offset:20480
    s_waitcnt lgkmcnt(6)
    v_mfma_f32_16x16x32_bf16 v[64:67], a[8:11], v[40:43], v[64:67]
    v_mfma_f32_16x16x32_bf16 v[68:71], a[12:15], v[40:43], v[68:71]
    buffer_load_dwordx4 v4, s[8:11], s72 offen offset:2048 sc1  lds
    v_mfma_f32_16x16x32_bf16 v[72:75], a[8:11], v[44:47], v[72:75]
    v_mfma_f32_16x16x32_bf16 v[76:79], a[12:15], v[44:47], v[76:79]
    buffer_load_dwordx4 v4, s[8:11], s72 offen offset:3072 sc1  lds
    ds_read_b128 v[40:43], v3 offset:2048
    ds_read_b128 v[44:47], v3 offset:20480
    s_waitcnt lgkmcnt(6)
    v_mfma_f32_16x16x32_bf16 v[64:67], a[16:19], v[48:51], v[64:67]
    v_mfma_f32_16x16x32_bf16 v[68:71], a[20:23], v[48:51], v[68:71]
    v_mfma_f32_16x16x32_bf16 v[72:75], a[16:19], v[52:55], v[72:75]
    v_mfma_f32_16x16x32_bf16 v[76:79], a[20:23], v[52:55], v[76:79]
    ds_read_b128 v[48:51], v2 offset:3072
    ds_read_b128 v[52:55], v2 offset:21504
    s_waitcnt lgkmcnt(6)
    v_mfma_f32_16x16x32_bf16 v[64:67], a[24:27], v[56:59], v[64:67]
    v_mfma_f32_16x16x32_bf16 v[68:71], a[28:31], v[56:59], v[68:71]
    v_mfma_f32_16x16x32_bf16 v[72:75], a[24:27], v[60:63], v[72:75]
    v_mfma_f32_16x16x32_bf16 v[76:79], a[28:31], v[60:63], v[76:79]
    ds_read_b128 v[56:59], v3 offset:3072
    ds_read_b128 v[60:63], v3 offset:21504
    s_waitcnt lgkmcnt(6)
    v_mfma_f32_16x16x32_bf16 v[64:67], a[32:35], v[32:35], v[64:67]
    v_mfma_f32_16x16x32_bf16 v[68:71], a[36:39], v[32:35], v[68:71]
    v_mfma_f32_16x16x32_bf16 v[72:75], a[32:35], v[36:39], v[72:75]
    v_mfma_f32_16x16x32_bf16 v[76:79], a[36:39], v[36:39], v[76:79]
    ds_read_b128 v[32:35], v2 offset:4096
    ds_read_b128 v[36:39], v2 offset:22528
    s_waitcnt lgkmcnt(6)
    v_mfma_f32_16x16x32_bf16 v[64:67], a[40:43], v[40:43], v[64:67]
    v_mfma_f32_16x16x32_bf16 v[68:71], a[44:47], v[40:43], v[68:71]
    v_mfma_f32_16x16x32_bf16 v[72:75], a[40:43], v[44:47], v[72:75]
    v_mfma_f32_16x16x32_bf16 v[76:79], a[44:47], v[44:47], v[76:79]
    ds_read_b128 v[40:43], v3 offset:4096
    ds_read_b128 v[44:47], v3 offset:22528
    s_waitcnt lgkmcnt(6)
    v_mfma_f32_16x16x32_bf16 v[64:67], a[48:51], v[48:51], v[64:67]
    v_mfma_f32_16x16x32_bf16 v[68:71], a[52:55], v[48:51], v[68:71]
    v_mfma_f32_16x16x32_bf16 v[72:75], a[48:51], v[52:55], v[72:75]
    v_mfma_f32_16x16x32_bf16 v[76:79], a[52:55], v[52:55], v[76:79]
    ds_read_b128 v[48:51], v2 offset:5120
    ds_read_b128 v[52:55], v2 offset:23552
    s_waitcnt lgkmcnt(6)
    v_mfma_f32_16x16x32_bf16 v[64:67], a[56:59], v[56:59], v[64:67]
    v_mfma_f32_16x16x32_bf16 v[68:71], a[60:63], v[56:59], v[68:71]
    v_mfma_f32_16x16x32_bf16 v[72:75], a[56:59], v[60:63], v[72:75]
    v_mfma_f32_16x16x32_bf16 v[76:79], a[60:63], v[60:63], v[76:79]
    ds_read_b128 v[56:59], v3 offset:5120
    ds_read_b128 v[60:63], v3 offset:23552
    s_waitcnt lgkmcnt(6)
    v_mfma_f32_16x16x32_bf16 v[64:67], a[64:67], v[32:35], v[64:67]
    v_mfma_f32_16x16x32_bf16 v[68:71], a[68:71], v[32:35], v[68:71]
    v_mfma_f32_16x16x32_bf16 v[72:75], a[64:67], v[36:39], v[72:75]
    v_mfma_f32_16x16x32_bf16 v[76:79], a[68:71], v[36:39], v[76:79]
    ds_read_b128 v[32:35], v2 offset:6144
    ds_read_b128 v[36:39], v2 offset:24576
    s_waitcnt lgkmcnt(6)
    v_mfma_f32_16x16x32_bf16 v[64:67], a[72:75], v[40:43], v[64:67]
    v_mfma_f32_16x16x32_bf16 v[68:71], a[76:79], v[40:43], v[68:71]
    v_mfma_f32_16x16x32_bf16 v[72:75], a[72:75], v[44:47], v[72:75]
    v_mfma_f32_16x16x32_bf16 v[76:79], a[76:79], v[44:47], v[76:79]
    ds_read_b128 v[40:43], v3 offset:6144
    ds_read_b128 v[44:47], v3 offset:24576
    s_waitcnt lgkmcnt(6)
    v_mfma_f32_16x16x32_bf16 v[64:67], a[80:83], v[48:51], v[64:67]
    v_mfma_f32_16x16x32_bf16 v[68:71], a[84:87], v[48:51], v[68:71]
    v_mfma_f32_16x16x32_bf16 v[72:75], a[80:83], v[52:55], v[72:75]
    v_mfma_f32_16x16x32_bf16 v[76:79], a[84:87], v[52:55], v[76:79]
    ds_read_b128 v[48:51], v2 offset:7168
    ds_read_b128 v[52:55], v2 offset:25600
    s_waitcnt lgkmcnt(6)
    v_mfma_f32_16x16x32_bf16 v[64:67], a[88:91], v[56:59], v[64:67]
    v_mfma_f32_16x16x32_bf16 v[68:71], a[92:95], v[56:59], v[68:71]
    v_mfma_f32_16x16x32_bf16 v[72:75], a[88:91], v[60:63], v[72:75]
    v_mfma_f32_16x16x32_bf16 v[76:79], a[92:95], v[60:63], v[76:79]
    ds_read_b128 v[56:59], v3 offset:7168
    ds_read_b128 v[60:63], v3 offset:25600
    s_waitcnt lgkmcnt(6)
    v_mfma_f32_16x16x32_bf16 v[64:67], a[96:99], v[32:35], v[64:67]
    v_mfma_f32_16x16x32_bf16 v[68:71], a[100:103], v[32:35], v[68:71]
    v_mfma_f32_16x16x32_bf16 v[72:75], a[96:99], v[36:39], v[72:75]
    v_mfma_f32_16x16x32_bf16 v[76:79], a[100:103], v[36:39], v[76:79]
    ds_read_b128 v[32:35], v2 offset:8192
    ds_read_b128 v[36:39], v2 offset:26624
    s_waitcnt lgkmcnt(6)
    v_mfma_f32_16x16x32_bf16 v[64:67], a[104:107], v[40:43], v[64:67]
    v_mfma_f32_16x16x32_bf16 v[68:71], a[108:111], v[40:43], v[68:71]
    v_mfma_f32_16x16x32_bf16 v[72:75], a[104:107], v[44:47], v[72:75]
    v_mfma_f32_16x16x32_bf16 v[76:79], a[108:111], v[44:47], v[76:79]
    ds_read_b128 v[40:43], v3 offset:8192
    ds_read_b128 v[44:47], v3 offset:26624
    s_waitcnt lgkmcnt(6)
    v_mfma_f32_16x16x32_bf16 v[64:67], a[112:115], v[48:51], v[64:67]
    v_mfma_f32_16x16x32_bf16 v[68:71], a[116:119], v[48:51], v[68:71]
    v_mfma_f32_16x16x32_bf16 v[72:75], a[112:115], v[52:55], v[72:75]
    v_mfma_f32_16x16x32_bf16 v[76:79], a[116:119], v[52:55], v[76:79]
    s_waitcnt lgkmcnt(4)
    v_mfma_f32_16x16x32_bf16 v[64:67], a[120:123], v[56:59], v[64:67]
    v_mfma_f32_16x16x32_bf16 v[68:71], a[124:127], v[56:59], v[68:71]
    v_mfma_f32_16x16x32_bf16 v[72:75], a[120:123], v[60:63], v[72:75]
    v_mfma_f32_16x16x32_bf16 v[76:79], a[124:127], v[60:63], v[76:79]
    s_waitcnt lgkmcnt(2)
    v_mfma_f32_16x16x32_bf16 v[64:67], a[128:131], v[32:35], v[64:67]
    v_mfma_f32_16x16x32_bf16 v[68:71], a[132:135], v[32:35], v[68:71]
    v_mfma_f32_16x16x32_bf16 v[72:75], a[128:131], v[36:39], v[72:75]
    v_mfma_f32_16x16x32_bf16 v[76:79], a[132:135], v[36:39], v[76:79]
    s_waitcnt lgkmcnt(0)
    v_mfma_f32_16x16x32_bf16 v[64:67], a[136:139], v[40:43], v[64:67]
    v_mfma_f32_16x16x32_bf16 v[68:71], a[140:143], v[40:43], v[68:71]
    v_mfma_f32_16x16x32_bf16 v[72:75], a[136:139], v[44:47], v[72:75]
    v_mfma_f32_16x16x32_bf16 v[76:79], a[140:143], v[44:47], v[76:79]
    v_cvt_pk_bf16_f32 v32, v64, v65
    v_cvt_pk_bf16_f32 v33, v66, v67
    v_cvt_pk_bf16_f32 v34, v68, v69
    v_cvt_pk_bf16_f32 v35, v70, v71
    ds_write_b128 v190, v[32:35] offset:0
    v_cvt_pk_bf16_f32 v36, v72, v73
    v_cvt_pk_bf16_f32 v37, v74, v75
    s_nop 0
    v_cvt_pk_bf16_f32 v38, v76, v77
    v_cvt_pk_bf16_f32 v39, v78, v79
    ds_write_b128 v190, v[36:39] offset:4096
    s_waitcnt vmcnt(0) lgkmcnt(0)
    s_barrier
    s_cmp_eq_u32 s3, 0
    s_cbranch_scc1 L_rows_73
L_qo_loopS:
    s_cmp_ge_u32 s3, 2
    s_cbranch_scc1 L_att_71
    s_cmp_eq_u32 s3, 1
    s_cbranch_scc1 L_xd_72
    v_add_u32 v40, v4, v6
    v_lshlrev_b32 v41, 1, v13
    v_add_u32 v41, 73728, v41
    ds_read_b128 v[32:35], v40 offset:16384
    ds_read_b128 v[36:39], v40 offset:16400
    ds_read_b32 v48, v41 offset:18432
    ds_read_b32 v49, v41 offset:18688
    ds_read_b32 v50, v41 offset:18944
    ds_read_b32 v51, v41 offset:19200
    v_lshlrev_b32 v80, 16, v176
    v_and_b32 v81, 0xffff0000, v176
    v_lshlrev_b32 v82, 16, v177
    v_and_b32 v83, 0xffff0000, v177
    v_lshlrev_b32 v84, 16, v178
    v_and_b32 v85, 0xffff0000, v178
    v_lshlrev_b32 v86, 16, v179
    v_and_b32 v87, 0xffff0000, v179
    v_lshlrev_b32 v88, 16, v180
    v_lshlrev_b32 v100, 16, v184
    v_and_b32 v101, 0xffff0000, v184
    v_lshlrev_b32 v102, 16, v185
    v_and_b32 v103, 0xffff0000, v185
    v_lshlrev_b32 v104, 16, v186
    v_and_b32 v105, 0xffff0000, v186
    v_lshlrev_b32 v106, 16, v187
    v_and_b32 v107, 0xffff0000, v187
    v_lshlrev_b32 v108, 16, v188
    s_mul_i32 s76, s82, 1152
    s_waitcnt lgkmcnt(0)
    v_pk_add_f32 v[48:49], v[48:49], v[50:51]
    v_add_f32 v40, v48, v49
    v_cvt_pk_bf16_f32 v64, v32, v33
    v_cvt_pk_bf16_f32 v65, v34, v35
    v_cvt_pk_bf16_f32 v66, v36, v37
    v_cvt_pk_bf16_f32 v67, v38, v39
    v_cvt_pk_bf16_f32 v68, v40, v40
    v_lshlrev_b32 v90, 16, v64
    v_and_b32 v91, 0xffff0000, v64
    v_lshlrev_b32 v92, 16, v65
    v_and_b32 v93, 0xffff0000, v65
    v_lshlrev_b32 v94, 16, v66
    v_and_b32 v95, 0xffff0000, v66
    v_lshlrev_b32 v96, 16, v67
    v_and_b32 v97, 0xffff0000, v67
    v_lshlrev_b32 v98, 16, v68
    v_pk_add_f32 v[80:81], v[80:81], v[90:91]
    v_pk_add_f32 v[82:83], v[82:83], v[92:93]
    v_pk_add_f32 v[84:85], v[84:85], v[94:95]
    v_pk_add_f32 v[86:87], v[86:87], v[96:97]
    v_add_f32 v88, v88, v98
    v_cvt_pk_bf16_f32 v64, v80, v81
    v_cvt_pk_bf16_f32 v65, v82, v83
    v_cvt_pk_bf16_f32 v66, v84, v85
    v_cvt_pk_bf16_f32 v67, v86, v87
    v_cvt_pk_bf16_f32 v68, v88, v88
    s_cmp_eq_u32 s66, 0
    s_cbranch_scc1 L_ln_78
    buffer_store_dwordx4 v[64:67], v4, s[56:59], s76 offen
    buffer_store_short v68, v13, s[56:59], s76 offen offset:1024
    s_branch L_qn_79
L_ln_78:
    v_lshlrev_b32 v80, 16, v64
    v_and_b32 v81, 0xffff0000, v64
    v_lshlrev_b32 v82, 16, v65
    v_and_b32 v83, 0xffff0000, v65
    v_lshlrev_b32 v84, 16, v66
    v_and_b32 v85, 0xffff0000, v66
    v_lshlrev_b32 v86, 16, v67
    v_and_b32 v87, 0xffff0000, v67
    v_lshlrev_b32 v88, 16, v68
    v_readfirstlane_b32 s64, v80
    s_nop 1
    v_mul_f32 v46, -1.0, s64
    v_mul_f32 v47, -1.0, s64
    v_pk_add_f32 v[90:91], v[80:81], v[46:47]
    v_pk_add_f32 v[92:93], v[82:83], v[46:47]
    v_pk_add_f32 v[94:95], v[84:85], v[46:47]
    v_pk_add_f32 v[96:97], v[86:87], v[46:47]
    v_add_f32 v98, v88, v46
    v_pk_add_f32 v[44:45], v[90:91], v[92:93]
    v_pk_mul_f32 v[42:43], v[90:91], v[90:91]
    v_pk_add_f32 v[44:45], v[44:45], v[94:95]
    v_pk_fma_f32 v[42:43], v[92:93], v[92:93], v[42:43]
    v_pk_add_f32 v[44:45], v[44:45], v[96:97]
    v_pk_fma_f32 v[42:43], v[94:95], v[94:95], v[42:43]
    v_add_f32 v44, v44, v98
    v_pk_fma_f32 v[42:43], v[96:97], v[96:97], v[42:43]
    v_add_f32 v44, v44, v45
    v_fmac_f32 v42, v98, v98
    v_add_f32 v42, v42, v43
    s_nop 1
    v_permlane32_swap_b32 v44, v42
    v_add_f32 v44, v44, v42
    v_mov_b32 v45, v44
    s_nop 1
    v_permlane16_swap_b32 v44, v45
    v_add_f32 v44, v44, v45
    s_nop 1
    v_add_f32_dpp v44, v44, v44 quad_perm:[1,0,3,2] row_mask:0xf bank_mask:0xf
    s_nop 1
    v_add_f32_dpp v44, v44, v44 quad_perm:[2,3,0,1] row_mask:0xf bank_mask:0xf
    s_nop 1
    v_add_f32_dpp v44, v44, v44 row_half_mirror row_mask:0xf bank_mask:0xf
    s_nop 1
    v_add_f32_dpp v44, v44, v44 row_mirror row_mask:0xf bank_mask:0xf
    v_mul_f32 v44, 1.7361111111e-03, v44
    s_nop 0
    v_readlane_b32 s64, v44, 0
    v_readlane_b32 s65, v44, 32
    s_nop 0
    v_mov_b32 v44, s64
    v_fma_f32 v42, -v44, v44, s65
    v_max_f32 v42, 0, v42
    v_add_f32 v42, 0x3727c5ac, v42
    v_rsq_f32 v42, v42
    v_mul_f32 v44, -1.0, v44
    v_mov_b32 v43, v42
    v_mul_f32 v44, v44, v42
    v_mov_b32 v45, v44
    v_pk_fma_f32 v[90:91], v[90:91], v[42:43], v[44:45]
    v_pk_fma_f32 v[92:93], v[92:93], v[42:43], v[44:45]
    v_pk_fma_f32 v[94:95], v[94:95], v[42:43], v[44:45]
    v_pk_fma_f32 v[96:97], v[96:97], v[42:43], v[44:45]
    v_fma_f32 v98, v98, v42, v44
    v_pk_fma_f32 v[80:81], v[90:91], v[100:101], v[80:81]
    v_pk_fma_f32 v[82:83], v[92:93], v[102:103], v[82:83]
    v_pk_fma_f32 v[84:85], v[94:95], v[104:105], v[84:85]
    v_pk_fma_f32 v[86:87], v[96:97], v[106:107], v[86:87]
    v_fma_f32 v88, v98, v108, v88
    v_cvt_pk_bf16_f32 v64, v80, v81
    v_cvt_pk_bf16_f32 v65, v82, v83
    v_cvt_pk_bf16_f32 v66, v84, v85
    v_cvt_pk_bf16_f32 v67, v86, v87
    v_cvt_pk_bf16_f32 v68, v88, v88
    s_add_u32 s77, s76, 13631488
    s_add_u32 s78, s76, 16777216
    v_add_u32 v41, 73728, v13
    buffer_store_dwordx4 v[64:67], v4, s[8:11], s77 offen sc1
    ds_write_b16 v41, v68 offset:19456
    v_lshlrev_b32 v80, 16, v64
    v_and_b32 v81, 0xffff0000, v64
    v_lshlrev_b32 v82, 16, v65
    v_and_b32 v83, 0xffff0000, v65
    v_lshlrev_b32 v84, 16, v66
    v_and_b32 v85, 0xffff0000, v66
    v_lshlrev_b32 v86, 16, v67
    v_and_b32 v87, 0xffff0000, v67
    v_lshlrev_b32 v88, 16, v68
    v_readfirstlane_b32 s64, v80
    s_nop 1
    v_mul_f32 v46, -1.0, s64
    v_mul_f32 v47, -1.0, s64
    v_pk_add_f32 v[90:91], v[80:81], v[46:47]
    v_pk_add_f32 v[92:93], v[82:83], v[46:47]
    v_pk_add_f32 v[94:95], v[84:85], v[46:47]
    v_pk_add_f32 v[96:97], v[86:87], v[46:47]
    v_add_f32 v98, v88, v46
    v_pk_add_f32 v[44:45], v[90:91], v[92:93]
    v_pk_mul_f32 v[42:43], v[90:91], v[90:91]
    v_pk_add_f32 v[44:45], v[44:45], v[94:95]
    v_pk_fma_f32 v[42:43], v[92:93], v[92:93], v[42:43]
    v_pk_add_f32 v[44:45], v[44:45], v[96:97]
    v_pk_fma_f32 v[42:43], v[94:95], v[94:95], v[42:43]
    v_add_f32 v44, v44, v98
    v_pk_fma_f32 v[42:43], v[96:97], v[96:97], v[42:43]
    v_add_f32 v44, v44, v45
    v_fmac_f32 v42, v98, v98
    v_add_f32 v42, v42, v43
    s_nop 1
    v_permlane32_swap_b32 v44, v42
    v_add_f32 v44, v44, v42
    v_mov_b32 v45, v44
    s_nop 1
    v_permlane16_swap_b32 v44, v45
    v_add_f32 v44, v44, v45
    s_nop 1
    v_add_f32_dpp v44, v44, v44 quad_perm:[1,0,3,2] row_mask:0xf bank_mask:0xf
    s_nop 1
    v_add_f32_dpp v44, v44, v44 quad_perm:[2,3,0,1] row_mask:0xf bank_mask:0xf
    s_nop 1
    v_add_f32_dpp v44, v44, v44 row_half_mirror row_mask:0xf bank_mask:0xf
    s_nop 1
    v_add_f32_dpp v44, v44, v44 row_mirror row_mask:0xf bank_mask:0xf
    v_mul_f32 v44, 1.7361111111e-03, v44
    s_nop 0
    v_readlane_b32 s64, v44, 0
    v_readlane_b32 s65, v44, 32
    s_nop 0
    v_mov_b32 v44, s64
    v_fma_f32 v42, -v44, v44, s65
    v_max_f32 v42, 0, v42
    v_sub_f32 v46, v46, v44
    v_cvt_pk_bf16_f32 v42, v42, v42
    v_and_b32 v42, 0xffff0000, v42
    v_cvt_pk_bf16_f32 v46, v46, v46
    v_and_b32 v46, 0xffff0000, v46
    v_add_f32 v42, 0x3727c5ac, v42
    v_mov_b32 v47, v46
    v_cvt_pk_bf16_f32 v42, v42, v42
    v_and_b32 v42, 0xffff0000, v42
    v_sqrt_f32 v42, v42
    v_pk_add_f32 v[90:91], v[80:81], v[46:47]
    v_pk_add_f32 v[92:93], v[82:83], v[46:47]
    v_pk_add_f32 v[94:95], v[84:85], v[46:47]
    v_pk_add_f32 v[96:97], v[86:87], v[46:47]
    v_add_f32 v98, v88, v46
    v_cvt_pk_bf16_f32 v42, v42, v42
    v_and_b32 v42, 0xffff0000, v42
    v_rcp_f32 v42, v42
    v_cvt_pk_bf16_f32 v72, v90, v91
    v_cvt_pk_bf16_f32 v73, v92, v93
    v_cvt_pk_bf16_f32 v74, v94, v95
    v_cvt_pk_bf16_f32 v75, v96, v97
    v_cvt_pk_bf16_f32 v76, v98, v98
    v_mov_b32 v43, v42
    v_lshlrev_b32 v90, 16, v72
    v_and_b32 v91, 0xffff0000, v72
    v_lshlrev_b32 v92, 16, v73
    v_and_b32 v93, 0xffff0000, v73
    v_lshlrev_b32 v94, 16, v74
    v_and_b32 v95, 0xffff0000, v74
    v_lshlrev_b32 v96, 16, v75
    v_and_b32 v97, 0xffff0000, v75
    v_lshlrev_b32 v98, 16, v76
    v_pk_mul_f32 v[90:91], v[90:91], v[42:43]
    v_pk_mul_f32 v[92:93], v[92:93], v[42:43]
    v_pk_mul_f32 v[94:95], v[94:95], v[42:43]
    v_pk_mul_f32 v[96:97], v[96:97], v[42:43]
    v_mul_f32 v98, v98, v42
    v_cvt_pk_bf16_f32 v72, v90, v91
    v_cvt_pk_bf16_f32 v73, v92, v93
    v_cvt_pk_bf16_f32 v74, v94, v95
    v_cvt_pk_bf16_f32 v75, v96, v97
    v_cvt_pk_bf16_f32 v76, v98, v98
    ds_write_b16 v41, v76 offset:19584
    buffer_store_dwordx4 v[72:75], v4, s[8:11], s78 offen sc1
    s_waitcnt lgkmcnt(0)
    ds_read_b128 v[32:35], v6 offset:19456
    ds_read_b128 v[36:39], v6 offset:19584
    s_lshr_b32 s63, s82, 5
    s_lshl_b32 s69, s5, 6
    s_add_u32 s69, s69, s63
    s_lshl_b32 s69, s69, 2
    s_add_u32 s69, s69, 24576
    s_waitcnt lgkmcnt(0)
    s_mov_b64 exec, 0xff
    buffer_store_dwordx4 v[32:35], v4, s[8:11], s77 offen offset:1024 sc1
    buffer_store_dwordx4 v[36:39], v4, s[8:11], s78 offen offset:1024 sc1
    s_mov_b64 exec, -1
L_qn_79:
    s_cmp_eq_u32 s70, 1
    s_cbranch_scc1 L_rows_73
    s_cmp_eq_u32 s69, 0
    s_cbranch_scc1 L_fl_80
    s_waitcnt vmcnt(0)
    s_mov_b64 exec, 1
    buffer_store_dword v24, v14, s[8:11], s69 offen sc1
    s_mov_b64 exec, -1
    s_mov_b32 s69, 0
L_fl_80:
L_rows_73:
    s_and_b32 s76, s67, 30
    s_cbranch_scc1 L_xf_81
    s_lshl_b32 s77, s67, 7
    s_and_b32 s77, s77, 4096
    s_add_u32 s77, s77, 4096
    v_lshlrev_b32 v41, 2, v4
    s_mov_b32 s60, 1048576
L_poll_82:
    buffer_load_dword v40, v41, s[8:11], s77 offen sc1
    s_waitcnt vmcnt(0)
    v_cmp_eq_u32 vcc, 0, v40
    s_cbranch_vccz L_pdone_83
    s_sleep 4
    s_sub_u32 s60, s60, 1
    s_cbranch_scc1 L_abort
    s_branch L_poll_82
L_pdone_83:
L_xf_81:
    s_lshl_b32 s76, s67, 5
    s_add_u32 s76, s76, s5
    s_mul_i32 s76, s76, 1152
    s_mul_i32 s77, s66, 6291456
    s_add_u32 s77, s77, s76
    s_add_u32 s77, s77, 7340032
    s_add_u32 s78, s76, 4194304
    buffer_load_dwordx4 v[176:179], v4, s[8:11], s77 offen sc1
    buffer_load_ushort v180, v13, s[8:11], s77 offen offset:1024 sc1
    buffer_load_dwordx4 v[184:187], v4, s[8:11], s78 offen sc1
    buffer_load_ushort v188, v13, s[8:11], s78 offen offset:1024 sc1
    s_branch L_join_74
L_xd_72:
    s_cmp_ge_u32 s67, 62
    s_cbranch_scc1 L_join_74
    s_add_u32 s74, s67, 2
    s_add_u32 s75, s93, -65528
    v_cmp_eq_u32 vcc, 0, v201
    s_cbranch_vccz L_kmh_76
    s_mov_b32 s60, 1048576
L_poll_84:
    buffer_load_dword v193, v15, s[8:11], s75 offen sc1
    s_waitcnt vmcnt(0)
    v_cmp_eq_u32 vcc, 0, v193
    s_cbranch_vccz L_pdone_85
    s_sleep 1
    s_sub_u32 s60, s60, 1
    s_cbranch_scc1 L_abort
    s_branch L_poll_84
L_pdone_85:
L_kmh_76:
    s_mul_i32 s75, s66, 6291456
    s_mul_i32 s79, s74, 36864
    s_add_u32 s75, s75, s79
    s_add_u32 s75, s75, 10485760
    s_xor_b32 s79, s68, 16384
    s_add_u32 s72, s87, 49152
    s_add_u32 m0, s79, 36864
    s_nop 0
    buffer_load_dwordx4 v4, s[8:11], s72 offen offset:0 sc1  lds
    buffer_load_dwordx4 v4, s[8:11], s72 offen offset:1024 sc1  lds
    buffer_load_dwordx4 v4, s[8:11], s72 offen offset:2048 sc1  lds
    buffer_load_dwordx4 v4, s[8:11], s72 offen offset:3072 sc1  lds
    s_add_u32 s72, s72, 4096
    s_add_u32 m0, s79, 40960
    s_nop 0
    buffer_load_dwordx4 v4, s[8:11], s72 offen offset:0 sc1  lds
    buffer_load_dwordx4 v4, s[8:11], s72 offen offset:1024 sc1  lds
    buffer_load_dwordx4 v4, s[8:11], s72 offen offset:2048 sc1  lds
    buffer_load_dwordx4 v4, s[8:11], s72 offen offset:3072 sc1  lds
    s_add_u32 s72, s72, 4096
    s_add_u32 m0, s79, 45056
    s_nop 0
    buffer_load_dwordx4 v4, s[8:11], s72 offen offset:0 sc1  lds
    buffer_load_dwordx4 v4, s[8:11], s72 offen offset:1024 sc1  lds
    buffer_load_dwordx4 v4, s[8:11], s72 offen offset:2048 sc1  lds
    buffer_load_dwordx4 v4, s[8:11], s72 offen offset:3072 sc1  lds
    s_add_u32 s72, s72, 4096
    s_add_u32 m0, s79, 49152
    s_nop 0
    buffer_load_dwordx4 v4, s[8:11], s72 offen offset:0 sc1  lds
    buffer_load_dwordx4 v4, s[8:11], s72 offen offset:1024 sc1  lds
    buffer_load_dwordx4 v4, s[8:11], s72 offen offset:2048 sc1  lds
    buffer_load_dwordx4 v4, s[8:11], s72 offen offset:3072 sc1  lds
    s_mov_b32 m0, 0
    s_nop 0
    buffer_load_dwordx4 v10, s[8:11], s75 offen offset:0 sc1 lds
    s_mov_b32 m0, 896
    s_nop 0
    buffer_load_dwordx4 v10, s[8:11], s75 offen offset:128 sc1 lds
    s_mov_b32 m0, 1792
    s_nop 0
    buffer_load_dwordx4 v10, s[8:11], s75 offen offset:256 sc1 lds
    s_mov_b32 m0, 2688
    s_nop 0
    buffer_load_dwordx4 v10, s[8:11], s75 offen offset:384 sc1 lds
    s_mov_b32 m0, 3584
    s_nop 0
    buffer_load_dwordx4 v10, s[8:11], s75 offen offset:512 sc1 lds
    s_mov_b32 m0, 4480
    s_nop 0
    buffer_load_dwordx4 v10, s[8:11], s75 offen offset:640 sc1 lds
    s_mov_b32 m0, 5376
    s_nop 0
    buffer_load_dwordx4 v10, s[8:11], s75 offen offset:768 sc1 lds
    s_mov_b32 m0, 6272
    s_nop 0
    buffer_load_dwordx4 v10, s[8:11], s75 offen offset:896 sc1 lds
    s_mov_b32 m0, 7168
    s_nop 0
    buffer_load_dwordx4 v10, s[8:11], s75 offen offset:1024 sc1 lds
    s_add_u32 s75, s75, 9216
    s_mov_b32 m0, 9216
    s_nop 0
    buffer_load_dwordx4 v1, s[8:11], s75 offen offset:0 sc1 lds
    s_mov_b32 m0, 10112
    s_nop 0
    buffer_load_dwordx4 v1, s[8:11], s75 offen offset:128 sc1 lds
    s_mov_b32 m0, 11008
    s_nop 0
    buffer_load_dwordx4 v1, s[8:11], s75 offen offset:256 sc1 lds
    s_mov_b32 m0, 11904
    s_nop 0
    buffer_load_dwordx4 v1, s[8:11], s75 offen offset:384 sc1 lds
    s_mov_b32 m0, 12800
    s_nop 0
    buffer_load_dwordx4 v1, s[8:11], s75 offen offset:512 sc1 lds
    s_mov_b32 m0, 13696
    s_nop 0
    buffer_load_dwordx4 v1, s[8:11], s75 offen offset:640 sc1 lds
    s_mov_b32 m0, 14592
    s_nop 0
    buffer_load_dwordx4 v1, s[8:11], s75 offen offset:768 sc1 lds
    s_mov_b32 m0, 15488
    s_nop 0
    buffer_load_dwordx4 v1, s[8:11], s75 offen offset:896 sc1 lds
    s_mov_b32 m0, 16384
    s_nop 0
    buffer_load_dwordx4 v1, s[8:11], s75 offen offset:1024 sc1 lds
    s_add_u32 s75, s75, 9216
    s_mov_b32 m0, 18432
    s_nop 0
    buffer_load_dwordx4 v10, s[8:11], s75 offen offset:0 sc1 lds
    s_mov_b32 m0, 19328
    s_nop 0
    buffer_load_dwordx4 v10, s[8:11], s75 offen offset:128 sc1 lds
    s_mov_b32 m0, 20224
    s_nop 0
    buffer_load_dwordx4 v10, s[8:11], s75 offen offset:256 sc1 lds
    s_mov_b32 m0, 21120
    s_nop 0
    buffer_load_dwordx4 v10, s[8:11], s75 offen offset:384 sc1 lds
    s_mov_b32 m0, 22016
    s_nop 0
    buffer_load_dwordx4 v10, s[8:11], s75 offen offset:512 sc1 lds
    s_mov_b32 m0, 22912
    s_nop 0
    buffer_load_dwordx4 v10, s[8:11], s75 offen offset:640 sc1 lds
    s_mov_b32 m0, 23808
    s_nop 0
    buffer_load_dwordx4 v10, s[8:11], s75 offen offset:768 sc1 lds
    s_mov_b32 m0, 24704
    s_nop 0
    buffer_load_dwordx4 v10, s[8:11], s75 offen offset:896 sc1 lds
    s_mov_b32 m0, 25600
    s_nop 0
    buffer_load_dwordx4 v10, s[8:11], s75 offen offset:1024 sc1 lds
    s_add_u32 s75, s75, 9216
    s_mov_b32 m0, 27648
    s_nop 0
    buffer_load_dwordx4 v1, s[8:11], s75 offen offset:0 sc1 lds
    s_mov_b32 m0, 28544
    s_nop 0
    buffer_load_dwordx4 v1, s[8:11], s75 offen offset:128 sc1 lds
    s_mov_b32 m0, 29440
    s_nop 0
    buffer_load_dwordx4 v1, s[8:11], s75 offen offset:256 sc1 lds
    s_mov_b32 m0, 30336
    s_nop 0
    buffer_load_dwordx4 v1, s[8:11], s75 offen offset:384 sc1 lds
    s_mov_b32 m0, 31232
    s_nop 0
    buffer_load_dwordx4 v1, s[8:11], s75 offen offset:512 sc1 lds
    s_mov_b32 m0, 32128
    s_nop 0
    buffer_load_dwordx4 v1, s[8:11], s75 offen offset:640 sc1 lds
    s_mov_b32 m0, 33024
    s_nop 0
    buffer_load_dwordx4 v1, s[8:11], s75 offen offset:768 sc1 lds
    s_mov_b32 m0, 33920
    s_nop 0
    buffer_load_dwordx4 v1, s[8:11], s75 offen offset:896 sc1 lds
    s_mov_b32 m0, 34816
    s_nop 0
    buffer_load_dwordx4 v1, s[8:11], s75 offen offset:1024 sc1 lds
    s_branch L_join_74
L_att_71:
    ds_read_b128 v[64:67], v191 offset:0
    ds_read_b128 v[80:83], v202 offset:36864
    ds_read_b128 v[84:87], v202 offset:37888
    ds_read_b128 v[68:71], v191 offset:1024
    ds_read_b128 v[88:91], v202 offset:40960
    ds_read_b128 v[92:95], v202 offset:41984
    ds_read_b128 v[72:75], v191 offset:2048
    ds_read_b128 v[96:99], v202 offset:45056
    ds_read_b128 v[100:103], v202 offset:46080
    ds_read_b128 v[76:79], v191 offset:3072
    ds_read_b128 v[104:107], v202 offset:49152
    ds_read_b128 v[108:111], v202 offset:50176
    s_waitcnt lgkmcnt(9)
    v_mfma_f32_16x16x32_bf16 v[48:51], v[80:83], v[64:67], v[16:19]
    ds_read_b128 v[112:115], v202 offset:38912
    v_mfma_f32_16x16x32_bf16 v[52:55], v[84:87], v[64:67], v[20:23]
    ds_read_b128 v[116:119], v202 offset:39936
    s_waitcnt lgkmcnt(8)
    v_mfma_f32_16x16x32_bf16 v[48:51], v[88:91], v[68:71], v[48:51]
    ds_read_b128 v[120:123], v202 offset:43008
    v_mfma_f32_16x16x32_bf16 v[52:55], v[92:95], v[68:71], v[52:55]
    ds_read_b128 v[124:127], v202 offset:44032
    s_waitcnt lgkmcnt(7)
    v_mfma_f32_16x16x32_bf16 v[48:51], v[96:99], v[72:75], v[48:51]
    ds_read_b128 v[128:131], v202 offset:47104
    v_mfma_f32_16x16x32_bf16 v[52:55], v[100:103], v[72:75], v[52:55]
    ds_read_b128 v[132:135], v202 offset:48128
    s_waitcnt lgkmcnt(6)
    v_mfma_f32_16x16x32_bf16 v[48:51], v[104:107], v[76:79], v[48:51]
    ds_read_b128 v[136:139], v202 offset:51200
    v_mfma_f32_16x16x32_bf16 v[52:55], v[108:111], v[76:79], v[52:55]
    ds_read_b128 v[140:143], v202 offset:52224
    s_cmp_eq_u32 s70, 1
    s_cbranch_scc1 L_kmh_75
    s_mov_b32 s60, 1048576
L_poll_86:
    buffer_load_dword v193, v15, s[8:11], s93 offen sc1
    s_waitcnt vmcnt(0)
    v_cmp_eq_u32 vcc, 0, v193
    s_cbranch_vccz L_pdone_87
    s_sleep 2
    s_sub_u32 s60, s60, 1
    s_cbranch_scc1 L_abort
    s_branch L_poll_86
L_pdone_87:
    s_add_u32 s76, s87, 16384
    s_add_u32 s77, s76, 4096
    buffer_load_dwordx4 v[144:147], v4, s[8:11], s76 offen offset:0 sc1
    buffer_load_dwordx4 v[148:151], v4, s[8:11], s76 offen offset:2048 sc1
    buffer_load_dwordx4 v[152:155], v4, s[8:11], s77 offen offset:0 sc1
    buffer_load_dwordx4 v[156:159], v4, s[8:11], s77 offen offset:2048 sc1
    buffer_load_dwordx2 v[160:161], v200, s[8:11], s76 offen offset:0 sc1
    buffer_load_dwordx2 v[162:163], v200, s[8:11], s76 offen offset:2048 sc1
    buffer_load_dwordx2 v[164:165], v200, s[8:11], s77 offen offset:0 sc1
    buffer_load_dwordx2 v[166:167], v200, s[8:11], s77 offen offset:2048 sc1
L_kmh_75:
    s_nop 4
    v_max3_f32 v60, v48, v49, v50
    v_max3_f32 v61, v51, v52, v53
    v_max3_f32 v60, v60, v54, v55
    s_waitcnt vmcnt(7)
    v_mfma_f32_16x16x32_bf16 v[56:59], v[144:147], v[64:67], 0
    s_waitcnt vmcnt(6)
    v_mfma_f32_16x16x32_bf16 v[56:59], v[148:151], v[68:71], v[56:59]
    s_waitcnt vmcnt(5)
    v_mfma_f32_16x16x32_bf16 v[56:59], v[152:155], v[72:75], v[56:59]
    s_waitcnt vmcnt(4)
    v_mfma_f32_16x16x32_bf16 v[56:59], v[156:159], v[76:79], v[56:59]
    buffer_load_dwordx2 v[40:41], v192, s[8:11], s90 offen sc1
    s_nop 6
    v_max3_f32 v61, v61, v56, v57
    v_max_f32 v60, v60, v61
    v_mov_b32 v61, v60
    s_nop 1
    v_permlane16_swap_b32 v60, v61
    v_max_f32 v60, v60, v61
    v_mov_b32 v61, v60
    s_nop 1
    v_permlane32_swap_b32 v60, v61
    v_max_f32 v60, v60, v61
    v_mul_f32 v60, s83, v60
    v_fma_f32 v48, v48, s83, -v60
    v_fma_f32 v49, v49, s83, -v60
    v_fma_f32 v50, v50, s83, -v60
    v_fma_f32 v51, v51, s83, -v60
    v_fma_f32 v52, v52, s83, -v60
    v_fma_f32 v53, v53, s83, -v60
    v_fma_f32 v54, v54, s83, -v60
    v_fma_f32 v55, v55, s83, -v60
    v_fma_f32 v56, v56, s83, -v60
    v_fma_f32 v57, v57, s83, -v60
    v_exp_f32 v48, v48
    v_exp_f32 v49, v49
    v_exp_f32 v50, v50
    v_exp_f32 v51, v51
    v_exp_f32 v52, v52
    v_exp_f32 v53, v53
    v_exp_f32 v54, v54
    v_exp_f32 v55, v55
    v_exp_f32 v56, v56
    v_exp_f32 v57, v57
    v_cvt_pk_bf16_f32 v32, v48, v49
    v_cvt_pk_bf16_f32 v33, v50, v51
    v_cvt_pk_bf16_f32 v34, v52, v53
    v_cvt_pk_bf16_f32 v35, v54, v55
    v_cvt_pk_bf16_f32 v36, v56, v57
    v_mov_b32 v37, 0
    v_mov_b32 v38, 0
    v_mov_b32 v39, v36
    s_waitcnt vmcnt(1) lgkmcnt(0)
    v_mfma_f32_16x16x32_bf16 v[44:47], v[24:27], v[32:35], 0
    v_mfma_f32_16x16x32_bf16 v[80:83], v[112:115], v[32:35], 0
    v_mfma_f32_16x16x32_bf16 v[84:87], v[116:119], v[32:35], 0
    v_mfma_f32_16x16x16_bf16 v[44:47], v[24:25], v[36:37], v[44:47]
    v_mfma_f32_16x16x16_bf16 v[80:83], v[160:161], v[36:37], v[80:83]
    v_mfma_f32_16x16x16_bf16 v[84:87], v[160:161], v[38:39], v[84:87]
    v_mfma_f32_16x16x32_bf16 v[88:91], v[120:123], v[32:35], 0
    v_rcp_f32 v44, v44
    v_mfma_f32_16x16x32_bf16 v[92:95], v[124:127], v[32:35], 0
    v_mfma_f32_16x16x16_bf16 v[88:91], v[162:163], v[36:37], v[88:91]
    v_mul_f32 v80, v80, v44
    v_mul_f32 v81, v81, v44
    v_mul_f32 v82, v82, v44
    v_mfma_f32_16x16x16_bf16 v[92:95], v[162:163], v[38:39], v[92:95]
    v_mul_f32 v83, v83, v44
    v_mul_f32 v84, v84, v44
    v_mul_f32 v85, v85, v44
    v_mfma_f32_16x16x32_bf16 v[96:99], v[128:131], v[32:35], 0
    v_mul_f32 v86, v86, v44
    v_mul_f32 v87, v87, v44
    v_cvt_pk_bf16_f32 v48, v80, v81
    v_mfma_f32_16x16x32_bf16 v[100:103], v[132:135], v[32:35], 0
    v_cvt_pk_bf16_f32 v49, v82, v83
    v_cvt_pk_bf16_f32 v50, v84, v85
    v_cvt_pk_bf16_f32 v51, v86, v87
    v_mfma_f32_16x16x16_bf16 v[96:99], v[164:165], v[36:37], v[96:99]
    ds_write_b128 v191, v[48:51] offset:8192
    v_mul_f32 v88, v88, v44
    v_mul_f32 v89, v89, v44
    v_mfma_f32_16x16x16_bf16 v[100:103], v[164:165], v[38:39], v[100:103]
    v_mul_f32 v90, v90, v44
    v_mul_f32 v91, v91, v44
    v_mul_f32 v92, v92, v44
    v_mfma_f32_16x16x32_bf16 v[104:107], v[136:139], v[32:35], 0
    v_mul_f32 v93, v93, v44
    v_mul_f32 v94, v94, v44
    v_mul_f32 v95, v95, v44
    v_mfma_f32_16x16x32_bf16 v[108:111], v[140:143], v[32:35], 0
    v_cvt_pk_bf16_f32 v52, v88, v89
    v_cvt_pk_bf16_f32 v53, v90, v91
    v_cvt_pk_bf16_f32 v54, v92, v93
    v_mfma_f32_16x16x16_bf16 v[104:107], v[166:167], v[36:37], v[104:107]
    v_cvt_pk_bf16_f32 v55, v94, v95
    ds_write_b128 v191, v[52:55] offset:9216
    v_mul_f32 v96, v96, v44
    v_mfma_f32_16x16x16_bf16 v[108:111], v[166:167], v[38:39], v[108:111]
    v_mul_f32 v97, v97, v44
    v_mul_f32 v98, v98, v44
    v_mul_f32 v99, v99, v44
    v_mul_f32 v100, v100, v44
    v_mul_f32 v101, v101, v44
    v_mul_f32 v102, v102, v44
    v_mul_f32 v103, v103, v44
    v_cvt_pk_bf16_f32 v56, v96, v97
    v_cvt_pk_bf16_f32 v57, v98, v99
    v_cvt_pk_bf16_f32 v58, v100, v101
    v_cvt_pk_bf16_f32 v59, v102, v103
    ds_write_b128 v191, v[56:59] offset:10240
    v_mul_f32 v104, v104, v44
    v_mul_f32 v105, v105, v44
    v_mul_f32 v106, v106, v44
    v_mul_f32 v107, v107, v44
    v_mul_f32 v108, v108, v44
    v_mul_f32 v109, v109, v44
    v_mul_f32 v110, v110, v44
    v_mul_f32 v111, v111, v44
    v_cvt_pk_bf16_f32 v60, v104, v105
    v_cvt_pk_bf16_f32 v61, v106, v107
    v_cvt_pk_bf16_f32 v62, v108, v109
    v_cvt_pk_bf16_f32 v63, v110, v111
    ds_write_b128 v191, v[60:63] offset:11264
    s_waitcnt vmcnt(0)
    v_and_b32 v40, v40, v41
    v_cmp_ne_u32 vcc, -1, v40
    s_cbranch_vccnz L_rf_88
L_rfok_89:
L_join_74:
    s_lshl_b32 s82, s67, 5
    s_add_u32 s82, s82, s5
    s_lshl_b32 s81, s66, 11
    s_add_u32 s81, s81, s82
    s_mov_b32 s88, s80
    s_lshl_b32 s77, s5, 10
    s_add_u32 s77, s77, s88
    s_lshl_b32 s84, s5, 8
    s_lshl_b32 s63, s3, 6
    s_add_u32 s84, s84, s63
    s_add_u32 s84, s84, s88
    s_add_u32 s84, s84, 1052672
    s_lshl_b32 s63, s3, 8
    s_add_u32 s77, s77, s63
    s_add_u32 s78, s77, 526336
    s_waitcnt lgkmcnt(0)
    s_barrier
    ds_read_b128 v[80:83], v6 offset:8192
    ds_read_b128 v[84:87], v6 offset:9216
    ds_read_b128 v[88:91], v6 offset:10240
    ds_read_b128 v[92:95], v6 offset:11264
    ds_read_b128 v[96:99], v6 offset:12288
    ds_read_b128 v[100:103], v6 offset:13312
    ds_read_b128 v[104:107], v6 offset:14336
    ds_read_b128 v[108:111], v6 offset:15360
    s_lshl_b32 s89, s81, 4
    s_lshl_b32 s64, s3, 2
    s_add_u32 s89, s89, s64
    s_add_u32 s89, s89, 196608
    s_lshr_b32 s90, s81, 5
    s_lshl_b32 s90, s90, 9
    s_add_u32 s90, s90, 196608
    s_mul_i32 s91, s5, 32896
    s_add_u32 s91, s91, s88
    s_lshr_b32 s92, s5, 1
    s_lshl_b32 s92, s92, 13
    s_lshl_b32 s64, s3, 11
    s_add_u32 s92, s92, s64
    s_add_u32 s92, s92, s88
    s_add_u32 s92, s92, 1052672
    s_add_u32 s91, s91, s63
    s_xor_b32 s68, s68, 16384
    v_xor_b32 v202, 16384, v202
    s_waitcnt lgkmcnt(7)
    v_mfma_f32_16x16x32_bf16 v[112:115], v[80:83], a[144:147], 0
    v_mfma_f32_16x16x32_bf16 v[116:119], v[80:83], a[160:163], 0
    v_mfma_f32_16x16x32_bf16 v[120:123], v[80:83], a[176:179], 0
    v_mfma_f32_16x16x32_bf16 v[124:127], v[80:83], a[192:195], 0
    v_mfma_f32_16x16x32_bf16 v[128:131], v[80:83], a[208:211], 0
    v_mfma_f32_16x16x32_bf16 v[132:135], v[80:83], a[224:227], 0
    v_mfma_f32_16x16x32_bf16 v[136:139], v[80:83], a[240:243], 0
    buffer_load_dwordx2 v[194:195], v192, s[8:11], s90 offen sc1
    v_mfma_f32_16x16x32_bf16 v[140:143], v[80:83], v[224:227], 0
    s_waitcnt lgkmcnt(6)
    v_mfma_f32_16x16x32_bf16 v[112:115], v[84:87], a[148:151], v[112:115]
    v_mfma_f32_16x16x32_bf16 v[116:119], v[84:87], a[164:167], v[116:119]
    v_mfma_f32_16x16x32_bf16 v[120:123], v[84:87], a[180:183], v[120:123]
    v_mfma_f32_16x16x32_bf16 v[124:127], v[84:87], a[196:199], v[124:127]
    v_mfma_f32_16x16x32_bf16 v[128:131], v[84:87], a[212:215], v[128:131]
    v_mfma_f32_16x16x32_bf16 v[132:135], v[84:87], a[228:231], v[132:135]
    v_mfma_f32_16x16x32_bf16 v[136:139], v[84:87], a[244:247], v[136:139]
    v_mfma_f32_16x16x32_bf16 v[140:143], v[84:87], v[228:231], v[140:143]
    s_waitcnt lgkmcnt(5)
    v_mfma_f32_16x16x32_bf16 v[112:115], v[88:91], a[152:155], v[112:115]
    v_mfma_f32_16x16x32_bf16 v[116:119], v[88:91], a[168:171], v[116:119]
    v_mfma_f32_16x16x32_bf16 v[120:123], v[88:91], a[184:187], v[120:123]
    v_mfma_f32_16x16x32_bf16 v[124:127], v[88:91], a[200:203], v[124:127]
    v_mfma_f32_16x16x32_bf16 v[128:131], v[88:91], a[216:219], v[128:131]
    v_mfma_f32_16x16x32_bf16 v[132:135], v[88:91], a[232:235], v[132:135]
    v_mfma_f32_16x16x32_bf16 v[136:139], v[88:91], a[248:251], v[136:139]
    s_cmp_eq_u32 s69, 0
    s_cbranch_scc1 L_fl_90
    s_waitcnt vmcnt(5)
    s_mov_b64 exec, 1
    buffer_store_dword v24, v14, s[8:11], s69 offen sc1
    s_mov_b64 exec, -1
    s_mov_b32 s69, 0
L_fl_90:
    v_mfma_f32_16x16x32_bf16 v[140:143], v[88:91], v[232:235], v[140:143]
    s_waitcnt lgkmcnt(4)
    v_mfma_f32_16x16x32_bf16 v[112:115], v[92:95], a[156:159], v[112:115]
    v_mfma_f32_16x16x32_bf16 v[116:119], v[92:95], a[172:175], v[116:119]
    v_mfma_f32_16x16x32_bf16 v[120:123], v[92:95], a[188:191], v[120:123]
    v_mfma_f32_16x16x32_bf16 v[124:127], v[92:95], a[204:207], v[124:127]
    v_mfma_f32_16x16x32_bf16 v[128:131], v[92:95], a[220:223], v[128:131]
    v_mfma_f32_16x16x32_bf16 v[132:135], v[92:95], a[236:239], v[132:135]
    v_mfma_f32_16x16x32_bf16 v[136:139], v[92:95], a[252:255], v[136:139]
    v_mfma_f32_16x16x32_bf16 v[140:143], v[92:95], v[236:239], v[140:143]
    s_waitcnt lgkmcnt(0)
    v_mfma_f32_16x16x32_bf16 v[144:147], v[96:99], a[144:147], 0
    v_cvt_pk_bf16_f32 v32, v112, v116
    v_mfma_f32_16x16x32_bf16 v[148:151], v[96:99], a[160:163], 0
    v_cvt_pk_bf16_f32 v33, v120, v124
    v_mfma_f32_16x16x32_bf16 v[152:155], v[96:99], a[176:179], 0
    v_cvt_pk_bf16_f32 v34, v128, v132
    v_mfma_f32_16x16x32_bf16 v[156:159], v[96:99], a[192:195], 0
    v_cvt_pk_bf16_f32 v35, v136, v140
    v_mfma_f32_16x16x32_bf16 v[160:163], v[96:99], a[208:211], 0
    buffer_store_dwordx4 v[32:35], v7, s[8:11], s77 offen sc1
    s_add_u32 s77, s77, 32896
    v_mfma_f32_16x16x32_bf16 v[164:167], v[96:99], a[224:227], 0
    v_mfma_f32_16x16x32_bf16 v[168:171], v[96:99], a[240:243], 0
    v_mfma_f32_16x16x32_bf16 v[172:175], v[96:99], v[224:227], 0
    v_mfma_f32_16x16x32_bf16 v[144:147], v[100:103], a[148:151], v[144:147]
    v_cvt_pk_bf16_f32 v36, v113, v117
    v_mfma_f32_16x16x32_bf16 v[148:151], v[100:103], a[164:167], v[148:151]
    v_cvt_pk_bf16_f32 v37, v121, v125
    v_mfma_f32_16x16x32_bf16 v[152:155], v[100:103], a[180:183], v[152:155]
    v_cvt_pk_bf16_f32 v38, v129, v133
    v_mfma_f32_16x16x32_bf16 v[156:159], v[100:103], a[196:199], v[156:159]
    v_cvt_pk_bf16_f32 v39, v137, v141
    v_mfma_f32_16x16x32_bf16 v[160:163], v[100:103], a[212:215], v[160:163]
    buffer_store_dwordx4 v[36:39], v7, s[8:11], s77 offen sc1
    s_add_u32 s77, s77, 32896
    v_mfma_f32_16x16x32_bf16 v[164:167], v[100:103], a[228:231], v[164:167]
    v_mfma_f32_16x16x32_bf16 v[168:171], v[100:103], a[244:247], v[168:171]
    v_mfma_f32_16x16x32_bf16 v[172:175], v[100:103], v[228:231], v[172:175]
    v_mfma_f32_16x16x32_bf16 v[144:147], v[104:107], a[152:155], v[144:147]
    v_cvt_pk_bf16_f32 v40, v114, v118
    v_mfma_f32_16x16x32_bf16 v[148:151], v[104:107], a[168:171], v[148:151]
    v_cvt_pk_bf16_f32 v41, v122, v126
    v_mfma_f32_16x16x32_bf16 v[152:155], v[104:107], a[184:187], v[152:155]
    v_cvt_pk_bf16_f32 v42, v130, v134
    v_mfma_f32_16x16x32_bf16 v[156:159], v[104:107], a[200:203], v[156:159]
    v_cvt_pk_bf16_f32 v43, v138, v142
    v_mfma_f32_16x16x32_bf16 v[160:163], v[104:107], a[216:219], v[160:163]
    buffer_store_dwordx4 v[40:43], v7, s[8:11], s77 offen sc1
    s_add_u32 s77, s77, 32896
    v_mfma_f32_16x16x32_bf16 v[164:167], v[104:107], a[232:235], v[164:167]
    v_mfma_f32_16x16x32_bf16 v[168:171], v[104:107], a[248:251], v[168:171]
    v_mfma_f32_16x16x32_bf16 v[172:175], v[104:107], v[232:235], v[172:175]
    v_mfma_f32_16x16x32_bf16 v[144:147], v[108:111], a[156:159], v[144:147]
    v_cvt_pk_bf16_f32 v44, v115, v119
    v_mfma_f32_16x16x32_bf16 v[148:151], v[108:111], a[172:175], v[148:151]
    v_cvt_pk_bf16_f32 v45, v123, v127
    v_mfma_f32_16x16x32_bf16 v[152:155], v[108:111], a[188:191], v[152:155]
    v_cvt_pk_bf16_f32 v46, v131, v135
    v_mfma_f32_16x16x32_bf16 v[156:159], v[108:111], a[204:207], v[156:159]
    v_cvt_pk_bf16_f32 v47, v139, v143
    v_mfma_f32_16x16x32_bf16 v[160:163], v[108:111], a[220:223], v[160:163]
    buffer_store_dwordx4 v[44:47], v7, s[8:11], s77 offen sc1
    v_mfma_f32_16x16x32_bf16 v[164:167], v[108:111], a[236:239], v[164:167]
    v_mfma_f32_16x16x32_bf16 v[168:171], v[108:111], a[252:255], v[168:171]
    v_mfma_f32_16x16x32_bf16 v[172:175], v[108:111], v[236:239], v[172:175]
    v_mfma_f32_16x16x32_bf16 v[48:51], v[80:83], v[240:243], 0
    v_cvt_pk_bf16_f32 v112, v144, v148
    v_cvt_pk_bf16_f32 v116, v145, v149
    v_mfma_f32_16x16x32_bf16 v[52:55], v[96:99], v[240:243], 0
    v_cvt_pk_bf16_f32 v120, v146, v150
    v_cvt_pk_bf16_f32 v124, v147, v151
    v_mfma_f32_16x16x32_bf16 v[48:51], v[84:87], v[244:247], v[48:51]
    v_cvt_pk_bf16_f32 v113, v152, v156
    v_cvt_pk_bf16_f32 v117, v153, v157
    v_mfma_f32_16x16x32_bf16 v[52:55], v[100:103], v[244:247], v[52:55]
    v_cvt_pk_bf16_f32 v121, v154, v158
    v_cvt_pk_bf16_f32 v125, v155, v159
    v_mfma_f32_16x16x32_bf16 v[48:51], v[88:91], v[248:251], v[48:51]
    v_cvt_pk_bf16_f32 v114, v160, v164
    v_cvt_pk_bf16_f32 v118, v161, v165
    v_mfma_f32_16x16x32_bf16 v[52:55], v[104:107], v[248:251], v[52:55]
    v_cvt_pk_bf16_f32 v122, v162, v166
    v_cvt_pk_bf16_f32 v126, v163, v167
    v_mfma_f32_16x16x32_bf16 v[48:51], v[92:95], v[252:255], v[48:51]
    v_cvt_pk_bf16_f32 v115, v168, v172
    v_cvt_pk_bf16_f32 v119, v169, v173
    v_mfma_f32_16x16x32_bf16 v[52:55], v[108:111], v[252:255], v[52:55]
    v_cvt_pk_bf16_f32 v123, v170, v174
    v_cvt_pk_bf16_f32 v127, v171, v175
    buffer_store_dwordx4 v[112:115], v7, s[8:11], s78 offen sc1
    s_add_u32 s78, s78, 32896
    v_cvt_pk_bf16_f32 v128, v48, v49
    v_cvt_pk_bf16_f32 v129, v50, v51
    s_nop 1
    v_cvt_pk_bf16_f32 v130, v52, v53
    v_cvt_pk_bf16_f32 v131, v54, v55
    s_cmp_ge_u32 s67, 62
    s_cbranch_scc1 L_qo_doneS
    s_add_u32 s67, s67, 2
    s_waitcnt vmcnt(6)
    s_lshl_b32 s87, s66, 5
    s_add_u32 s87, s87, s5
    s_mul_i32 s87, s87, 2101248
    s_mul_i32 s63, s67, 24576
    s_add_u32 s87, s87, s63
    s_add_u32 s87, s87, 67108864
    s_lshl_b32 s93, s66, 5
    s_add_u32 s93, s93, s5
    s_lshl_b32 s93, s93, 2
    s_lshl_b32 s93, s93, 6
    s_add_u32 s93, s93, s67
    s_lshl_b32 s93, s93, 2
    s_add_u32 s93, s93, 131072
    s_mov_b32 s70, 0
    s_barrier
    ds_read_b128 v[32:35], v2 offset:0
    ds_read_b128 v[36:39], v2 offset:18432
    ds_read_b128 v[40:43], v3 offset:0
    ds_read_b128 v[44:47], v3 offset:18432
    ds_read_b128 v[48:51], v2 offset:1024
    ds_read_b128 v[52:55], v2 offset:19456
    ds_read_b128 v[56:59], v3 offset:1024
    ds_read_b128 v[60:63], v3 offset:19456
    s_waitcnt lgkmcnt(6)
    v_mfma_f32_16x16x32_bf16 v[64:67], a[0:3], v[32:35], 0
    v_mfma_f32_16x16x32_bf16 v[68:71], a[4:7], v[32:35], 0
    v_mfma_f32_16x16x32_bf16 v[72:75], a[0:3], v[36:39], 0
    v_mfma_f32_16x16x32_bf16 v[76:79], a[4:7], v[36:39], 0
    buffer_store_dwordx4 v[116:119], v7, s[8:11], s78 offen sc1
    s_add_u32 s78, s78, 32896
    ds_read_b128 v[32:35], v2 offset:2048
    ds_read_b128 v[36:39], v2 offset:20480
    s_waitcnt lgkmcnt(6)
    v_mfma_f32_16x16x32_bf16 v[64:67], a[8:11], v[40:43], v[64:67]
    v_mfma_f32_16x16x32_bf16 v[68:71], a[12:15], v[40:43], v[68:71]
    v_mfma_f32_16x16x32_bf16 v[72:75], a[8:11], v[44:47], v[72:75]
    v_mfma_f32_16x16x32_bf16 v[76:79], a[12:15], v[44:47], v[76:79]
    buffer_store_dwordx4 v[120:123], v7, s[8:11], s78 offen sc1
    s_add_u32 s78, s78, 32896
    ds_read_b128 v[40:43], v3 offset:2048
    ds_read_b128 v[44:47], v3 offset:20480
    s_waitcnt lgkmcnt(6)
    v_mfma_f32_16x16x32_bf16 v[64:67], a[16:19], v[48:51], v[64:67]
    v_mfma_f32_16x16x32_bf16 v[68:71], a[20:23], v[48:51], v[68:71]
    v_mfma_f32_16x16x32_bf16 v[72:75], a[16:19], v[52:55], v[72:75]
    v_mfma_f32_16x16x32_bf16 v[76:79], a[20:23], v[52:55], v[76:79]
    buffer_store_dwordx4 v[124:127], v7, s[8:11], s78 offen sc1
    ds_read_b128 v[48:51], v2 offset:3072
    ds_read_b128 v[52:55], v2 offset:21504
    s_waitcnt lgkmcnt(6)
    v_mfma_f32_16x16x32_bf16 v[64:67], a[24:27], v[56:59], v[64:67]
    v_mfma_f32_16x16x32_bf16 v[68:71], a[28:31], v[56:59], v[68:71]
    buffer_store_dword v128, v8, s[8:11], s84 offen sc1
    s_add_u32 s84, s84, 8192
    v_mfma_f32_16x16x32_bf16 v[72:75], a[24:27], v[60:63], v[72:75]
    v_mfma_f32_16x16x32_bf16 v[76:79], a[28:31], v[60:63], v[76:79]
    buffer_store_dword v129, v8, s[8:11], s84 offen sc1
    s_add_u32 s84, s84, 57344
    ds_read_b128 v[56:59], v3 offset:3072
    ds_read_b128 v[60:63], v3 offset:21504
    s_waitcnt lgkmcnt(6)
    v_mfma_f32_16x16x32_bf16 v[64:67], a[32:35], v[32:35], v[64:67]
    v_mfma_f32_16x16x32_bf16 v[68:71], a[36:39], v[32:35], v[68:71]
    buffer_store_dword v130, v8, s[8:11], s84 offen sc1
    s_add_u32 s84, s84, 8192
    v_mfma_f32_16x16x32_bf16 v[72:75], a[32:35], v[36:39], v[72:75]
    v_mfma_f32_16x16x32_bf16 v[76:79], a[36:39], v[36:39], v[76:79]
    buffer_store_dword v131, v8, s[8:11], s84 offen sc1
    ds_read_b128 v[32:35], v2 offset:4096
    ds_read_b128 v[36:39], v2 offset:22528
    s_waitcnt lgkmcnt(6)
    v_mfma_f32_16x16x32_bf16 v[64:67], a[40:43], v[40:43], v[64:67]
    v_mfma_f32_16x16x32_bf16 v[68:71], a[44:47], v[40:43], v[68:71]
    v_mfma_f32_16x16x32_bf16 v[72:75], a[40:43], v[44:47], v[72:75]
    v_mfma_f32_16x16x32_bf16 v[76:79], a[44:47], v[44:47], v[76:79]
    ds_read_b128 v[40:43], v3 offset:4096
    ds_read_b128 v[44:47], v3 offset:22528
    s_waitcnt lgkmcnt(6)
    v_mfma_f32_16x16x32_bf16 v[64:67], a[48:51], v[48:51], v[64:67]
    v_mfma_f32_16x16x32_bf16 v[68:71], a[52:55], v[48:51], v[68:71]
    v_mfma_f32_16x16x32_bf16 v[72:75], a[48:51], v[52:55], v[72:75]
    v_mfma_f32_16x16x32_bf16 v[76:79], a[52:55], v[52:55], v[76:79]
    ds_read_b128 v[48:51], v2 offset:5120
    ds_read_b128 v[52:55], v2 offset:23552
    s_waitcnt lgkmcnt(6)
    v_mfma_f32_16x16x32_bf16 v[64:67], a[56:59], v[56:59], v[64:67]
    v_mfma_f32_16x16x32_bf16 v[68:71], a[60:63], v[56:59], v[68:71]
    v_mfma_f32_16x16x32_bf16 v[72:75], a[56:59], v[60:63], v[72:75]
    v_mfma_f32_16x16x32_bf16 v[76:79], a[60:63], v[60:63], v[76:79]
    ds_read_b128 v[56:59], v3 offset:5120
    ds_read_b128 v[60:63], v3 offset:23552
    s_waitcnt lgkmcnt(6)
    v_mfma_f32_16x16x32_bf16 v[64:67], a[64:67], v[32:35], v[64:67]
    v_mfma_f32_16x16x32_bf16 v[68:71], a[68:71], v[32:35], v[68:71]
    v_mfma_f32_16x16x32_bf16 v[72:75], a[64:67], v[36:39], v[72:75]
    v_mfma_f32_16x16x32_bf16 v[76:79], a[68:71], v[36:39], v[76:79]
    s_waitcnt vmcnt(0)
    s_mov_b64 exec, 1
    buffer_store_dword v24, v14, s[8:11], s89 offen sc1
    s_mov_b64 exec, -1
    ds_read_b128 v[32:35], v2 offset:6144
    ds_read_b128 v[36:39], v2 offset:24576
    s_waitcnt lgkmcnt(6)
    v_mfma_f32_16x16x32_bf16 v[64:67], a[72:75], v[40:43], v[64:67]
    v_mfma_f32_16x16x32_bf16 v[68:71], a[76:79], v[40:43], v[68:71]
    v_mfma_f32_16x16x32_bf16 v[72:75], a[72:75], v[44:47], v[72:75]
    v_mfma_f32_16x16x32_bf16 v[76:79], a[76:79], v[44:47], v[76:79]
    ds_read_b128 v[40:43], v3 offset:6144
    ds_read_b128 v[44:47], v3 offset:24576
    s_waitcnt lgkmcnt(6)
    v_mfma_f32_16x16x32_bf16 v[64:67], a[80:83], v[48:51], v[64:67]
    v_mfma_f32_16x16x32_bf16 v[68:71], a[84:87], v[48:51], v[68:71]
    v_mfma_f32_16x16x32_bf16 v[72:75], a[80:83], v[52:55], v[72:75]
    v_mfma_f32_16x16x32_bf16 v[76:79], a[84:87], v[52:55], v[76:79]
    ds_read_b128 v[48:51], v2 offset:7168
    ds_read_b128 v[52:55], v2 offset:25600
    s_waitcnt lgkmcnt(6)
    v_mfma_f32_16x16x32_bf16 v[64:67], a[88:91], v[56:59], v[64:67]
    v_mfma_f32_16x16x32_bf16 v[68:71], a[92:95], v[56:59], v[68:71]
    v_mfma_f32_16x16x32_bf16 v[72:75], a[88:91], v[60:63], v[72:75]
    v_mfma_f32_16x16x32_bf16 v[76:79], a[92:95], v[60:63], v[76:79]
    ds_read_b128 v[56:59], v3 offset:7168
    ds_read_b128 v[60:63], v3 offset:25600
    s_waitcnt lgkmcnt(6)
    v_mfma_f32_16x16x32_bf16 v[64:67], a[96:99], v[32:35], v[64:67]
    v_mfma_f32_16x16x32_bf16 v[68:71], a[100:103], v[32:35], v[68:71]
    v_mfma_f32_16x16x32_bf16 v[72:75], a[96:99], v[36:39], v[72:75]
    v_mfma_f32_16x16x32_bf16 v[76:79], a[100:103], v[36:39], v[76:79]
    ds_read_b128 v[32:35], v2 offset:8192
    ds_read_b128 v[36:39], v2 offset:26624
    s_waitcnt lgkmcnt(6)
    v_mfma_f32_16x16x32_bf16 v[64:67], a[104:107], v[40:43], v[64:67]
    v_mfma_f32_16x16x32_bf16 v[68:71], a[108:111], v[40:43], v[68:71]
    v_mfma_f32_16x16x32_bf16 v[72:75], a[104:107], v[44:47], v[72:75]
    v_mfma_f32_16x16x32_bf16 v[76:79], a[108:111], v[44:47], v[76:79]
    buffer_load_dwordx2 v[194:195], v192, s[8:11], s90 offen sc1
    ds_read_b128 v[40:43], v3 offset:8192
    ds_read_b128 v[44:47], v3 offset:26624
    s_waitcnt lgkmcnt(6)
    v_mfma_f32_16x16x32_bf16 v[64:67], a[112:115], v[48:51], v[64:67]
    v_mfma_f32_16x16x32_bf16 v[68:71], a[116:119], v[48:51], v[68:71]
    v_mfma_f32_16x16x32_bf16 v[72:75], a[112:115], v[52:55], v[72:75]
    v_mfma_f32_16x16x32_bf16 v[76:79], a[116:119], v[52:55], v[76:79]
    s_waitcnt lgkmcnt(4)
    v_mfma_f32_16x16x32_bf16 v[64:67], a[120:123], v[56:59], v[64:67]
    v_mfma_f32_16x16x32_bf16 v[68:71], a[124:127], v[56:59], v[68:71]
    v_mfma_f32_16x16x32_bf16 v[72:75], a[120:123], v[60:63], v[72:75]
    v_mfma_f32_16x16x32_bf16 v[76:79], a[124:127], v[60:63], v[76:79]
    s_waitcnt lgkmcnt(2)
    v_mfma_f32_16x16x32_bf16 v[64:67], a[128:131], v[32:35], v[64:67]
    v_mfma_f32_16x16x32_bf16 v[68:71], a[132:135], v[32:35], v[68:71]
    v_mfma_f32_16x16x32_bf16 v[72:75], a[128:131], v[36:39], v[72:75]
    v_mfma_f32_16x16x32_bf16 v[76:79], a[132:135], v[36:39], v[76:79]
    s_waitcnt lgkmcnt(0)
    v_mfma_f32_16x16x32_bf16 v[64:67], a[136:139], v[40:43], v[64:67]
    v_mfma_f32_16x16x32_bf16 v[68:71], a[140:143], v[40:43], v[68:71]
    v_mfma_f32_16x16x32_bf16 v[72:75], a[136:139], v[44:47], v[72:75]
    v_mfma_f32_16x16x32_bf16 v[76:79], a[140:143], v[44:47], v[76:79]
    v_cvt_pk_bf16_f32 v32, v64, v65
    v_cvt_pk_bf16_f32 v33, v66, v67
    v_cvt_pk_bf16_f32 v34, v68, v69
    v_cvt_pk_bf16_f32 v35, v70, v71
    ds_write_b128 v190, v[32:35] offset:0
    v_cvt_pk_bf16_f32 v36, v72, v73
    v_cvt_pk_bf16_f32 v37, v74, v75
    s_nop 0
    v_cvt_pk_bf16_f32 v38, v76, v77
    v_cvt_pk_bf16_f32 v39, v78, v79
    ds_write_b128 v190, v[36:39] offset:4096
    s_waitcnt vmcnt(0)
    v_min_u32 v194, v194, v195
    v_cmp_eq_u32 vcc, 0, v194
    s_cbranch_vccz L_qj_91
    s_mov_b32 s60, 1048576
L_poll_92:
    buffer_load_dwordx2 v[194:195], v192, s[8:11], s90 offen sc1
    s_waitcnt vmcnt(0)
    v_min_u32 v194, v194, v195
    v_cmp_eq_u32 vcc, 0, v194
    s_cbranch_vccz L_pdone_93
    s_sub_u32 s60, s60, 1
    s_cbranch_scc1 L_abort
    s_branch L_poll_92
L_pdone_93:
L_qj_91:
    buffer_load_dwordx4 v[80:83], v9, s[8:11], s91 offen sc1
    s_add_u32 s91, s91, 4096
    buffer_load_dwordx4 v[84:87], v9, s[8:11], s91 offen sc1
    s_add_u32 s91, s91, 4096
    buffer_load_dwordx4 v[88:91], v9, s[8:11], s91 offen sc1
    s_add_u32 s91, s91, 4096
    buffer_load_dwordx4 v[92:95], v9, s[8:11], s91 offen sc1
    s_add_u32 s91, s91, 4096
    buffer_load_dwordx4 v[96:99], v9, s[8:11], s91 offen sc1
    s_add_u32 s91, s91, 4096
    buffer_load_dwordx4 v[100:103], v9, s[8:11], s91 offen sc1
    s_add_u32 s91, s91, 4096
    buffer_load_dwordx4 v[104:107], v9, s[8:11], s91 offen sc1
    s_add_u32 s91, s91, 4096
    buffer_load_dwordx4 v[108:111], v9, s[8:11], s91 offen sc1
    s_add_u32 s91, s91, 4096
    buffer_load_dwordx4 v[112:115], v4, s[8:11], s92 offen offset:0 sc1
    buffer_load_dwordx4 v[116:119], v4, s[8:11], s92 offen offset:1024 sc1
    buffer_load_dword v193, v15, s[8:11], s93 offen sc1
    s_add_u32 s75, s93, -65528
    buffer_load_dword v201, v15, s[8:11], s75 offen sc1
    s_waitcnt vmcnt(11)
    v_mfma_f32_16x16x32_bf16 v[40:43], v[28:31], v[80:83], 0
    s_waitcnt vmcnt(10)
    v_mfma_f32_16x16x32_bf16 v[40:43], v[28:31], v[84:87], v[40:43]
    s_waitcnt vmcnt(9)
    v_mfma_f32_16x16x32_bf16 v[40:43], v[28:31], v[88:91], v[40:43]
    s_waitcnt vmcnt(8)
    v_mfma_f32_16x16x32_bf16 v[40:43], v[28:31], v[92:95], v[40:43]
    s_waitcnt vmcnt(7)
    v_mfma_f32_16x16x32_bf16 v[40:43], v[28:31], v[96:99], v[40:43]
    s_waitcnt vmcnt(6)
    v_mfma_f32_16x16x32_bf16 v[40:43], v[28:31], v[100:103], v[40:43]
    s_waitcnt vmcnt(5)
    v_mfma_f32_16x16x32_bf16 v[40:43], v[28:31], v[104:107], v[40:43]
    s_waitcnt vmcnt(4)
    v_mfma_f32_16x16x32_bf16 v[40:43], v[28:31], v[108:111], v[40:43]
    s_waitcnt vmcnt(3)
    v_mfma_f32_16x16x32_bf16 v[44:47], v[196:199], v[112:115], 0
    s_waitcnt vmcnt(2)
    v_mfma_f32_16x16x32_bf16 v[44:47], v[196:199], v[116:119], v[44:47]
    s_mov_b64 exec, 0xffffffff
    ds_write2_b32 v11, v40, v41 offset0:0 offset1:16
    ds_write2_b32 v11, v42, v43 offset0:32 offset1:48
    s_mov_b64 exec, 0xffff
    s_nop 3
    ds_write_b128 v12, v[44:47]
    s_mov_b64 exec, -1
    v_mov_b32 v48, -1
    s_mov_b64 exec, 1
    buffer_store_dword v48, v14, s[8:11], s89 offen sc1
    s_mov_b64 exec, -1
    s_waitcnt vmcnt(1)
    v_cmp_eq_u32 vcc, 0, v193
    s_cbranch_vccnz L_kmn_94
    s_mov_b32 s70, 1
    s_cmp_lt_u32 s3, 2
    s_cbranch_scc1 L_kmn_94
    s_add_u32 s76, s87, 16384
    s_add_u32 s77, s76, 4096
    buffer_load_dwordx4 v[144:147], v4, s[8:11], s76 offen offset:0 sc1
    buffer_load_dwordx4 v[148:151], v4, s[8:11], s76 offen offset:2048 sc1
    buffer_load_dwordx4 v[152:155], v4, s[8:11], s77 offen offset:0 sc1
    buffer_load_dwordx4 v[156:159], v4, s[8:11], s77 offen offset:2048 sc1
    buffer_load_dwordx2 v[160:161], v200, s[8:11], s76 offen offset:0 sc1
    buffer_load_dwordx2 v[162:163], v200, s[8:11], s76 offen offset:2048 sc1
    buffer_load_dwordx2 v[164:165], v200, s[8:11], s77 offen offset:0 sc1
    buffer_load_dwordx2 v[166:167], v200, s[8:11], s77 offen offset:2048 sc1
L_kmn_94:
    s_waitcnt lgkmcnt(0)
    s_barrier
    s_branch L_qo_loopS
L_qo_doneS:
    buffer_store_dwordx4 v[116:119], v7, s[8:11], s78 offen sc1
    s_add_u32 s78, s78, 32896
    buffer_store_dwordx4 v[120:123], v7, s[8:11], s78 offen sc1
    s_add_u32 s78, s78, 32896
    buffer_store_dwordx4 v[124:127], v7, s[8:11], s78 offen sc1
    buffer_store_dword v128, v8, s[8:11], s84 offen sc1
    s_add_u32 s84, s84, 8192
    buffer_store_dword v129, v8, s[8:11], s84 offen sc1
    s_add_u32 s84, s84, 57344
    buffer_store_dword v130, v8, s[8:11], s84 offen sc1
    s_add_u32 s84, s84, 8192
    buffer_store_dword v131, v8, s[8:11], s84 offen sc1
    s_waitcnt vmcnt(0)
    s_mov_b64 exec, 1
    buffer_store_dword v24, v14, s[8:11], s89 offen sc1
    s_mov_b64 exec, -1
    s_mov_b32 s60, 1048576
L_poll_96:
    buffer_load_dwordx2 v[194:195], v192, s[8:11], s90 offen sc1
    s_waitcnt vmcnt(0)
    v_min_u32 v194, v194, v195
    v_cmp_eq_u32 vcc, 0, v194
    s_cbranch_vccz L_pdone_97
    s_sub_u32 s60, s60, 1
    s_cbranch_scc1 L_abort
    s_branch L_poll_96
L_pdone_97:
L_qj_95:
    buffer_load_dwordx4 v[80:83], v9, s[8:11], s91 offen sc1
    s_add_u32 s91, s91, 4096
    buffer_load_dwordx4 v[84:87], v9, s[8:11], s91 offen sc1
    s_add_u32 s91, s91, 4096
    buffer_load_dwordx4 v[88:91], v9, s[8:11], s91 offen sc1
    s_add_u32 s91, s91, 4096
    buffer_load_dwordx4 v[92:95], v9, s[8:11], s91 offen sc1
    s_add_u32 s91, s91, 4096
    buffer_load_dwordx4 v[96:99], v9, s[8:11], s91 offen sc1
    s_add_u32 s91, s91, 4096
    buffer_load_dwordx4 v[100:103], v9, s[8:11], s91 offen sc1
    s_add_u32 s91, s91, 4096
    buffer_load_dwordx4 v[104:107], v9, s[8:11], s91 offen sc1
    s_add_u32 s91, s91, 4096
    buffer_load_dwordx4 v[108:111], v9, s[8:11], s91 offen sc1
    s_add_u32 s91, s91, 4096
    buffer_load_dwordx4 v[112:115], v4, s[8:11], s92 offen offset:0 sc1
    buffer_load_dwordx4 v[116:119], v4, s[8:11], s92 offen offset:1024 sc1
    s_waitcnt vmcnt(9)
    v_mfma_f32_16x16x32_bf16 v[40:43], v[28:31], v[80:83], 0
    s_waitcnt vmcnt(8)
    v_mfma_f32_16x16x32_bf16 v[40:43], v[28:31], v[84:87], v[40:43]
    s_waitcnt vmcnt(7)
    v_mfma_f32_16x16x32_bf16 v[40:43], v[28:31], v[88:91], v[40:43]
    s_waitcnt vmcnt(6)
    v_mfma_f32_16x16x32_bf16 v[40:43], v[28:31], v[92:95], v[40:43]
    s_waitcnt vmcnt(5)
    v_mfma_f32_16x16x32_bf16 v[40:43], v[28:31], v[96:99], v[40:43]
    s_waitcnt vmcnt(4)
    v_mfma_f32_16x16x32_bf16 v[40:43], v[28:31], v[100:103], v[40:43]
    s_waitcnt vmcnt(3)
    v_mfma_f32_16x16x32_bf16 v[40:43], v[28:31], v[104:107], v[40:43]
    s_waitcnt vmcnt(2)
    v_mfma_f32_16x16x32_bf16 v[40:43], v[28:31], v[108:111], v[40:43]
    s_waitcnt vmcnt(1)
    v_mfma_f32_16x16x32_bf16 v[44:47], v[196:199], v[112:115], 0
    s_waitcnt vmcnt(0)
    v_mfma_f32_16x16x32_bf16 v[44:47], v[196:199], v[116:119], v[44:47]
    s_mov_b64 exec, 0xffffffff
    ds_write2_b32 v11, v40, v41 offset0:0 offset1:16
    ds_write2_b32 v11, v42, v43 offset0:32 offset1:48
    s_mov_b64 exec, 0xffff
    s_nop 3
    ds_write_b128 v12, v[44:47]
    s_mov_b64 exec, -1
    s_waitcnt lgkmcnt(0)
    s_barrier
    s_cmp_lg_u32 s3, 0
    s_cbranch_scc1 L_end_98
    v_add_u32 v40, v4, v6
    v_lshlrev_b32 v41, 1, v13
    v_add_u32 v41, 73728, v41
    ds_read_b128 v[32:35], v40 offset:16384
    ds_read_b128 v[36:39], v40 offset:16400
    ds_read_b32 v48, v41 offset:18432
    ds_read_b32 v49, v41 offset:18688
    ds_read_b32 v50, v41 offset:18944
    ds_read_b32 v51, v41 offset:19200
    v_lshlrev_b32 v80, 16, v176
    v_and_b32 v81, 0xffff0000, v176
    v_lshlrev_b32 v82, 16, v177
    v_and_b32 v83, 0xffff0000, v177
    v_lshlrev_b32 v84, 16, v178
    v_and_b32 v85, 0xffff0000, v178
    v_lshlrev_b32 v86, 16, v179
    v_and_b32 v87, 0xffff0000, v179
    v_lshlrev_b32 v88, 16, v180
    v_lshlrev_b32 v100, 16, v184
    v_and_b32 v101, 0xffff0000, v184
    v_lshlrev_b32 v102, 16, v185
    v_and_b32 v103, 0xffff0000, v185
    v_lshlrev_b32 v104, 16, v186
    v_and_b32 v105, 0xffff0000, v186
    v_lshlrev_b32 v106, 16, v187
    v_and_b32 v107, 0xffff0000, v187
    v_lshlrev_b32 v108, 16, v188
    s_mul_i32 s76, s82, 1152
    s_waitcnt lgkmcnt(0)
    v_pk_add_f32 v[48:49], v[48:49], v[50:51]
    v_add_f32 v40, v48, v49
    v_cvt_pk_bf16_f32 v64, v32, v33
    v_cvt_pk_bf16_f32 v65, v34, v35
    v_cvt_pk_bf16_f32 v66, v36, v37
    v_cvt_pk_bf16_f32 v67, v38, v39
    v_cvt_pk_bf16_f32 v68, v40, v40
    v_lshlrev_b32 v90, 16, v64
    v_and_b32 v91, 0xffff0000, v64
    v_lshlrev_b32 v92, 16, v65
    v_and_b32 v93, 0xffff0000, v65
    v_lshlrev_b32 v94, 16, v66
    v_and_b32 v95, 0xffff0000, v66
    v_lshlrev_b32 v96, 16, v67
    v_and_b32 v97, 0xffff0000, v67
    v_lshlrev_b32 v98, 16, v68
    v_pk_add_f32 v[80:81], v[80:81], v[90:91]
    v_pk_add_f32 v[82:83], v[82:83], v[92:93]
    v_pk_add_f32 v[84:85], v[84:85], v[94:95]
    v_pk_add_f32 v[86:87], v[86:87], v[96:97]
    v_add_f32 v88, v88, v98
    v_cvt_pk_bf16_f32 v64, v80, v81
    v_cvt_pk_bf16_f32 v65, v82, v83
    v_cvt_pk_bf16_f32 v66, v84, v85
    v_cvt_pk_bf16_f32 v67, v86, v87
    v_cvt_pk_bf16_f32 v68, v88, v88
    s_cmp_eq_u32 s66, 0
    s_cbranch_scc1 L_ln_99
    buffer_store_dwordx4 v[64:67], v4, s[56:59], s76 offen
    buffer_store_short v68, v13, s[56:59], s76 offen offset:1024
    s_branch L_qn_100
L_ln_99:
    v_lshlrev_b32 v80, 16, v64
    v_and_b32 v81, 0xffff0000, v64
    v_lshlrev_b32 v82, 16, v65
    v_and_b32 v83, 0xffff0000, v65
    v_lshlrev_b32 v84, 16, v66
    v_and_b32 v85, 0xffff0000, v66
    v_lshlrev_b32 v86, 16, v67
    v_and_b32 v87, 0xffff0000, v67
    v_lshlrev_b32 v88, 16, v68
    v_readfirstlane_b32 s64, v80
    s_nop 1
    v_mul_f32 v46, -1.0, s64
    v_mul_f32 v47, -1.0, s64
    v_pk_add_f32 v[90:91], v[80:81], v[46:47]
    v_pk_add_f32 v[92:93], v[82:83], v[46:47]
    v_pk_add_f32 v[94:95], v[84:85], v[46:47]
    v_pk_add_f32 v[96:97], v[86:87], v[46:47]
    v_add_f32 v98, v88, v46
    v_pk_add_f32 v[44:45], v[90:91], v[92:93]
    v_pk_mul_f32 v[42:43], v[90:91], v[90:91]
    v_pk_add_f32 v[44:45], v[44:45], v[94:95]
    v_pk_fma_f32 v[42:43], v[92:93], v[92:93], v[42:43]
    v_pk_add_f32 v[44:45], v[44:45], v[96:97]
    v_pk_fma_f32 v[42:43], v[94:95], v[94:95], v[42:43]
    v_add_f32 v44, v44, v98
    v_pk_fma_f32 v[42:43], v[96:97], v[96:97], v[42:43]
    v_add_f32 v44, v44, v45
    v_fmac_f32 v42, v98, v98
    v_add_f32 v42, v42, v43
    s_nop 1
    v_permlane32_swap_b32 v44, v42
    v_add_f32 v44, v44, v42
    v_mov_b32 v45, v44
    s_nop 1
    v_permlane16_swap_b32 v44, v45
    v_add_f32 v44, v44, v45
    s_nop 1
    v_add_f32_dpp v44, v44, v44 quad_perm:[1,0,3,2] row_mask:0xf bank_mask:0xf
    s_nop 1
    v_add_f32_dpp v44, v44, v44 quad_perm:[2,3,0,1] row_mask:0xf bank_mask:0xf
    s_nop 1
    v_add_f32_dpp v44, v44, v44 row_half_mirror row_mask:0xf bank_mask:0xf
    s_nop 1
    v_add_f32_dpp v44, v44, v44 row_mirror row_mask:0xf bank_mask:0xf
    v_mul_f32 v44, 1.7361111111e-03, v44
    s_nop 0
    v_readlane_b32 s64, v44, 0
    v_readlane_b32 s65, v44, 32
    s_nop 0
    v_mov_b32 v44, s64
    v_fma_f32 v42, -v44, v44, s65
    v_max_f32 v42, 0, v42
    v_add_f32 v42, 0x3727c5ac, v42
    v_rsq_f32 v42, v42
    v_mul_f32 v44, -1.0, v44
    v_mov_b32 v43, v42
    v_mul_f32 v44, v44, v42
    v_mov_b32 v45, v44
    v_pk_fma_f32 v[90:91], v[90:91], v[42:43], v[44:45]
    v_pk_fma_f32 v[92:93], v[92:93], v[42:43], v[44:45]
    v_pk_fma_f32 v[94:95], v[94:95], v[42:43], v[44:45]
    v_pk_fma_f32 v[96:97], v[96:97], v[42:43], v[44:45]
    v_fma_f32 v98, v98, v42, v44
    v_pk_fma_f32 v[80:81], v[90:91], v[100:101], v[80:81]
    v_pk_fma_f32 v[82:83], v[92:93], v[102:103], v[82:83]
    v_pk_fma_f32 v[84:85], v[94:95], v[104:105], v[84:85]
    v_pk_fma_f32 v[86:87], v[96:97], v[106:107], v[86:87]
    v_fma_f32 v88, v98, v108, v88
    v_cvt_pk_bf16_f32 v64, v80, v81
    v_cvt_pk_bf16_f32 v65, v82, v83
    v_cvt_pk_bf16_f32 v66, v84, v85
    v_cvt_pk_bf16_f32 v67, v86, v87
    v_cvt_pk_bf16_f32 v68, v88, v88
    s_add_u32 s77, s76, 13631488
    s_add_u32 s78, s76, 16777216
    v_add_u32 v41, 73728, v13
    buffer_store_dwordx4 v[64:67], v4, s[8:11], s77 offen sc1
    ds_write_b16 v41, v68 offset:19456
    v_lshlrev_b32 v80, 16, v64
    v_and_b32 v81, 0xffff0000, v64
    v_lshlrev_b32 v82, 16, v65
    v_and_b32 v83, 0xffff0000, v65
    v_lshlrev_b32 v84, 16, v66
    v_and_b32 v85, 0xffff0000, v66
    v_lshlrev_b32 v86, 16, v67
    v_and_b32 v87, 0xffff0000, v67
    v_lshlrev_b32 v88, 16, v68
    v_readfirstlane_b32 s64, v80
    s_nop 1
    v_mul_f32 v46, -1.0, s64
    v_mul_f32 v47, -1.0, s64
    v_pk_add_f32 v[90:91], v[80:81], v[46:47]
    v_pk_add_f32 v[92:93], v[82:83], v[46:47]
    v_pk_add_f32 v[94:95], v[84:85], v[46:47]
    v_pk_add_f32 v[96:97], v[86:87], v[46:47]
    v_add_f32 v98, v88, v46
    v_pk_add_f32 v[44:45], v[90:91], v[92:93]
    v_pk_mul_f32 v[42:43], v[90:91], v[90:91]
    v_pk_add_f32 v[44:45], v[44:45], v[94:95]
    v_pk_fma_f32 v[42:43], v[92:93], v[92:93], v[42:43]
    v_pk_add_f32 v[44:45], v[44:45], v[96:97]
    v_pk_fma_f32 v[42:43], v[94:95], v[94:95], v[42:43]
    v_add_f32 v44, v44, v98
    v_pk_fma_f32 v[42:43], v[96:97], v[96:97], v[42:43]
    v_add_f32 v44, v44, v45
    v_fmac_f32 v42, v98, v98
    v_add_f32 v42, v42, v43
    s_nop 1
    v_permlane32_swap_b32 v44, v42
    v_add_f32 v44, v44, v42
    v_mov_b32 v45, v44
    s_nop 1
    v_permlane16_swap_b32 v44, v45
    v_add_f32 v44, v44, v45
    s_nop 1
    v_add_f32_dpp v44, v44, v44 quad_perm:[1,0,3,2] row_mask:0xf bank_mask:0xf
    s_nop 1
    v_add_f32_dpp v44, v44, v44 quad_perm:[2,3,0,1] row_mask:0xf bank_mask:0xf
    s_nop 1
    v_add_f32_dpp v44, v44, v44 row_half_mirror row_mask:0xf bank_mask:0xf
    s_nop 1
    v_add_f32_dpp v44, v44, v44 row_mirror row_mask:0xf bank_mask:0xf
    v_mul_f32 v44, 1.7361111111e-03, v44
    s_nop 0
    v_readlane_b32 s64, v44, 0
    v_readlane_b32 s65, v44, 32
    s_nop 0
    v_mov_b32 v44, s64
    v_fma_f32 v42, -v44, v44, s65
    v_max_f32 v42, 0, v42
    v_sub_f32 v46, v46, v44
    v_cvt_pk_bf16_f32 v42, v42, v42
    v_and_b32 v42, 0xffff0000, v42
    v_cvt_pk_bf16_f32 v46, v46, v46
    v_and_b32 v46, 0xffff0000, v46
    v_add_f32 v42, 0x3727c5ac, v42
    v_mov_b32 v47, v46
    v_cvt_pk_bf16_f32 v42, v42, v42
    v_and_b32 v42, 0xffff0000, v42
    v_sqrt_f32 v42, v42
    v_pk_add_f32 v[90:91], v[80:81], v[46:47]
    v_pk_add_f32 v[92:93], v[82:83], v[46:47]
    v_pk_add_f32 v[94:95], v[84:85], v[46:47]
    v_pk_add_f32 v[96:97], v[86:87], v[46:47]
    v_add_f32 v98, v88, v46
    v_cvt_pk_bf16_f32 v42, v42, v42
    v_and_b32 v42, 0xffff0000, v42
    v_rcp_f32 v42, v42
    v_cvt_pk_bf16_f32 v72, v90, v91
    v_cvt_pk_bf16_f32 v73, v92, v93
    v_cvt_pk_bf16_f32 v74, v94, v95
    v_cvt_pk_bf16_f32 v75, v96, v97
    v_cvt_pk_bf16_f32 v76, v98, v98
    v_mov_b32 v43, v42
    v_lshlrev_b32 v90, 16, v72
    v_and_b32 v91, 0xffff0000, v72
    v_lshlrev_b32 v92, 16, v73
    v_and_b32 v93, 0xffff0000, v73
    v_lshlrev_b32 v94, 16, v74
    v_and_b32 v95, 0xffff0000, v74
    v_lshlrev_b32 v96, 16, v75
    v_and_b32 v97, 0xffff0000, v75
    v_lshlrev_b32 v98, 16, v76
    v_pk_mul_f32 v[90:91], v[90:91], v[42:43]
    v_pk_mul_f32 v[92:93], v[92:93], v[42:43]
    v_pk_mul_f32 v[94:95], v[94:95], v[42:43]
    v_pk_mul_f32 v[96:97], v[96:97], v[42:43]
    v_mul_f32 v98, v98, v42
    v_cvt_pk_bf16_f32 v72, v90, v91
    v_cvt_pk_bf16_f32 v73, v92, v93
    v_cvt_pk_bf16_f32 v74, v94, v95
    v_cvt_pk_bf16_f32 v75, v96, v97
    v_cvt_pk_bf16_f32 v76, v98, v98
    ds_write_b16 v41, v76 offset:19584
    buffer_store_dwordx4 v[72:75], v4, s[8:11], s78 offen sc1
    s_waitcnt lgkmcnt(0)
    ds_read_b128 v[32:35], v6 offset:19456
    ds_read_b128 v[36:39], v6 offset:19584
    s_lshr_b32 s63, s82, 5
    s_lshl_b32 s69, s5, 6
    s_add_u32 s69, s69, s63
    s_lshl_b32 s69, s69, 2
    s_add_u32 s69, s69, 24576
    s_waitcnt lgkmcnt(0)
    s_mov_b64 exec, 0xff
    buffer_store_dwordx4 v[32:35], v4, s[8:11], s77 offen offset:1024 sc1
    buffer_store_dwordx4 v[36:39], v4, s[8:11], s78 offen offset:1024 sc1
    s_mov_b64 exec, -1
L_qn_100:
    s_cmp_eq_u32 s69, 0
    s_cbranch_scc1 L_fl_101
    s_waitcnt vmcnt(0)
    s_mov_b64 exec, 1
    buffer_store_dword v24, v14, s[8:11], s69 offen sc1
    s_mov_b64 exec, -1
    s_mov_b32 s69, 0
L_fl_101:
L_end_98:
    s_endpgm
L_rf_88:
    s_cmp_lt_u32 s67, 2
    s_cbranch_scc1 L_rfok_89
    s_mov_b32 s60, 1048576
L_poll_102:
    buffer_load_dwordx2 v[40:41], v192, s[8:11], s90 offen sc1
    s_waitcnt vmcnt(0)
    v_and_b32 v40, v40, v41
    v_cmp_ne_u32 vcc, -1, v40
    s_cbranch_vccz L_pdone_103
    s_sub_u32 s60, s60, 1
    s_cbranch_scc1 L_abort
    s_branch L_poll_102
L_pdone_103:
    s_branch L_rfok_89
L_chain:
    s_barrier
    s_mov_b32 s48, s30
    s_mov_b32 s49, s31
    s_mov_b32 s50, 9216
    s_mov_b32 s51, 0x20000
    v_lshrrev_b32 v20, 4, v0
    v_bfe_u32 v23, v0, 1, 1
    v_and_b32 v24, 1, v0
    v_bfe_u32 v25, v0, 2, 2
    v_lshl_add_u32 v28, v25, 1, v24
    v_mul_u32_u24 v28, 1152, v28
    v_lshlrev_b32 v29, 6, v23
    v_lshl_add_u32 v29, v20, 3, v29
    v_add_u32 v29, v29, v28
    v_lshlrev_b32 v30, 2, v23
    v_lshl_add_u32 v30, v20, 5, v30
    v_add_u32 v30, v30, v28
    s_lshl_b32 s63, s3, 8
    buffer_load_ushort v4, v29, s[48:51], s63 offen offset:0
    buffer_load_ushort v72, v29, s[48:51], s63 offen offset:32
    buffer_load_ushort v5, v29, s[48:51], s63 offen offset:2
    buffer_load_ushort v73, v29, s[48:51], s63 offen offset:34
    buffer_load_ushort v6, v29, s[48:51], s63 offen offset:4
    buffer_load_ushort v74, v29, s[48:51], s63 offen offset:36
    buffer_load_ushort v7, v29, s[48:51], s63 offen offset:6
    buffer_load_ushort v75, v29, s[48:51], s63 offen offset:38
    buffer_load_ushort v8, v29, s[48:51], s63 offen offset:128
    buffer_load_ushort v76, v29, s[48:51], s63 offen offset:160
    buffer_load_ushort v9, v29, s[48:51], s63 offen offset:130
    buffer_load_ushort v77, v29, s[48:51], s63 offen offset:162
    buffer_load_ushort v10, v29, s[48:51], s63 offen offset:132
    buffer_load_ushort v78, v29, s[48:51], s63 offen offset:164
    buffer_load_ushort v11, v29, s[48:51], s63 offen offset:134
    buffer_load_ushort v79, v29, s[48:51], s63 offen offset:166
    buffer_load_dword v12, v30, s[48:51], 0 offen offset:1024
    buffer_load_dword v13, v30, s[48:51], 0 offen offset:1032
    buffer_load_dword v14, v30, s[48:51], 0 offen offset:1040
    buffer_load_dword v15, v30, s[48:51], 0 offen offset:1048
    s_mov_b32 s48, s32
    s_mov_b32 s49, s33
    s_mov_b32 s50, 4718592
    s_mov_b32 s51, 0x20000
    s_mov_b32 s52, s34
    s_mov_b32 s53, s35
    s_mov_b32 s54, 4718592
    s_mov_b32 s55, 0x20000
    s_mov_b32 s56, s36
    s_mov_b32 s57, s37
    s_mov_b32 s58, 4718592
    s_mov_b32 s59, 0x20000
    s_mov_b32 s92, s38
    s_mov_b32 s93, s39
    s_mov_b32 s94, 4718592
    s_mov_b32 s95, 0x20000
    s_mul_i32 s72, s3, 36864
    s_add_u32 s72, s72, 16384
    v_lshrrev_b32 v21, 3, v0
    v_and_b32 v23, 7, v0
    v_lshlrev_b32 v20, 13, v21
    v_lshl_add_u32 v20, v23, 4, v20
    v_mul_u32_u24 v21, 1152, v21
    v_lshl_add_u32 v21, v23, 4, v21
    v_lshrrev_b32 v22, 1, v0
    v_mul_u32_u24 v22, 1152, v22
    v_and_b32 v23, 1, v0
    v_lshl_add_u32 v22, v23, 4, v22
    v_lshrrev_b32 v23, 4, v0
    v_bfe_u32 v24, v0, 2, 2
    v_and_b32 v25, 3, v0
    v_lshl_add_u32 v30, v23, 3, v24
    v_lshlrev_b32 v30, 7, v30
    v_lshl_add_u32 v30, v25, 3, v30
    s_and_b32 s63, s3, 2
    s_mul_i32 s63, s63, 36864
    s_and_b32 s64, s3, 1
    s_lshl_b32 s65, s64, 6
    s_add_u32 s63, s63, s65
    s_add_u32 s63, s63, 16384
    v_add_u32 v30, s63, v30
    v_add_u32 v31, 36864, v30
    s_lshl_b32 s90, s5, 8
    s_lshr_b32 s63, s3, 1
    s_lshl_b32 s63, s63, 7
    s_add_u32 s90, s90, s63
    s_lshl_b32 s63, s64, 18
    s_add_u32 s97, s90, s63
    v_lshlrev_b32 v26, 4, v24
    v_lshl_add_u32 v26, v23, 1, v26
    v_lshlrev_b32 v26, 7, v26
    v_lshl_add_u32 v26, v25, 3, v26
    v_lshlrev_b32 v27, 5, v24
    v_xor_b32 v27, s65, v27
    v_add_u32 v26, v27, v26
    s_xor_b32 s63, s3, 1
    s_mul_i32 s63, s63, 36864
    s_add_u32 s63, s63, 16384
    v_add_u32 v27, s63, v26
    v_add_u32 v26, s72, v26
    v_xor_b32 v34, 32, v26
    v_xor_b32 v35, 32, v27
    v_xor_b32 v36, 32, v20
    v_xor_b32 v37, 64, v20
    v_xor_b32 v38, 96, v20
    v_and_b32 v28, 1, v23
    v_lshlrev_b32 v28, 4, v28
    v_lshrrev_b32 v29, 1, v23
    v_lshl_add_u32 v28, v29, 3, v28
    v_lshrrev_b32 v29, 1, v24
    v_lshl_add_u32 v28, v29, 2, v28
    v_and_b32 v29, 1, v24
    v_add_u32 v28, v28, v29
    v_lshlrev_b32 v29, 5, v28
    v_lshl_add_u32 v29, v25, 3, v29
    v_add_u32 v29, s72, v29
    v_lshlrev_b32 v28, 7, v28
    v_lshl_add_u32 v28, v25, 3, v28
    v_add_u32 v28, s72, v28
    s_mul_i32 s91, s5, 147456
    s_lshl_b32 s63, s3, 5
    s_add_u32 s96, s91, s63
    s_lshl_b32 s63, s3, 8
    s_add_u32 s91, s91, s63
    s_xor_b32 s63, s3, 0
    s_lshl_b32 s63, s63, 20
    s_add_u32 s73, s90, s63
    s_xor_b32 s63, s3, 2
    s_lshl_b32 s63, s63, 20
    s_add_u32 s75, s90, s63
    s_add_u32 m0, s72, 0
    s_add_u32 s63, s91, 0
    buffer_load_dwordx4 v21, s[92:95], s63 offen nt lds
    s_add_u32 m0, s72, 1024
    s_add_u32 s63, s91, 9216
    buffer_load_dwordx4 v21, s[92:95], s63 offen nt lds
    s_add_u32 m0, s72, 2048
    s_add_u32 s63, s91, 18432
    buffer_load_dwordx4 v21, s[92:95], s63 offen nt lds
    s_add_u32 m0, s72, 3072
    s_add_u32 s63, s91, 27648
    buffer_load_dwordx4 v21, s[92:95], s63 offen nt lds
    s_add_u32 m0, s72, 4096
    s_add_u32 s63, s91, 128
    buffer_load_dwordx4 v21, s[92:95], s63 offen nt lds
    s_add_u32 m0, s72, 5120
    s_add_u32 s63, s91, 9344
    buffer_load_dwordx4 v21, s[92:95], s63 offen nt lds
    s_add_u32 m0, s72, 6144
    s_add_u32 s63, s91, 18560
    buffer_load_dwordx4 v21, s[92:95], s63 offen nt lds
    s_add_u32 m0, s72, 7168
    s_add_u32 s63, s91, 27776
    buffer_load_dwordx4 v21, s[92:95], s63 offen nt lds
    s_add_u32 m0, s72, 8192
    s_add_u32 s63, s91, 36864
    buffer_load_dwordx4 v21, s[92:95], s63 offen nt lds
    s_add_u32 m0, s72, 9216
    s_add_u32 s63, s91, 46080
    buffer_load_dwordx4 v21, s[92:95], s63 offen nt lds
    s_add_u32 m0, s72, 10240
    s_add_u32 s63, s91, 55296
    buffer_load_dwordx4 v21, s[92:95], s63 offen nt lds
    s_add_u32 m0, s72, 11264
    s_add_u32 s63, s91, 64512
    buffer_load_dwordx4 v21, s[92:95], s63 offen nt lds
    s_add_u32 m0, s72, 12288
    s_add_u32 s63, s91, 36992
    buffer_load_dwordx4 v21, s[92:95], s63 offen nt lds
    s_add_u32 m0, s72, 13312
    s_add_u32 s63, s91, 46208
    buffer_load_dwordx4 v21, s[92:95], s63 offen nt lds
    s_add_u32 m0, s72, 14336
    s_add_u32 s63, s91, 55424
    buffer_load_dwordx4 v21, s[92:95], s63 offen nt lds
    s_add_u32 m0, s72, 15360
    s_add_u32 s63, s91, 64640
    buffer_load_dwordx4 v21, s[92:95], s63 offen nt lds
    s_add_u32 m0, s72, 16384
    s_add_u32 s63, s91, 73728
    buffer_load_dwordx4 v21, s[92:95], s63 offen nt lds
    s_add_u32 m0, s72, 17408
    s_add_u32 s63, s91, 82944
    buffer_load_dwordx4 v21, s[92:95], s63 offen nt lds
    s_add_u32 m0, s72, 18432
    s_add_u32 s63, s91, 92160
    buffer_load_dwordx4 v21, s[92:95], s63 offen nt lds
    s_add_u32 m0, s72, 19456
    s_add_u32 s63, s91, 101376
    buffer_load_dwordx4 v21, s[92:95], s63 offen nt lds
    s_add_u32 m0, s72, 20480
    s_add_u32 s63, s91, 73856
    buffer_load_dwordx4 v21, s[92:95], s63 offen nt lds
    s_add_u32 m0, s72, 21504
    s_add_u32 s63, s91, 83072
    buffer_load_dwordx4 v21, s[92:95], s63 offen nt lds
    s_add_u32 m0, s72, 22528
    s_add_u32 s63, s91, 92288
    buffer_load_dwordx4 v21, s[92:95], s63 offen nt lds
    s_add_u32 m0, s72, 23552
    s_add_u32 s63, s91, 101504
    buffer_load_dwordx4 v21, s[92:95], s63 offen nt lds
    s_waitcnt vmcnt(24)
    v_lshl_or_b32 v72, v72, 16, v4
    v_lshl_or_b32 v73, v73, 16, v5
    v_lshl_or_b32 v74, v74, 16, v6
    v_lshl_or_b32 v75, v75, 16, v7
    v_lshl_or_b32 v76, v76, 16, v8
    v_lshl_or_b32 v77, v77, 16, v9
    v_lshl_or_b32 v78, v78, 16, v10
    v_lshl_or_b32 v79, v79, 16, v11
    s_lshl_b32 s63, s3, 11
    v_lshlrev_b32 v2, 4, v0
    v_add_u32 v1, s63, v2
    v_add_u32 v3, s72, v2
    ds_write_b128 v1, v[72:75]
    ds_write_b128 v1, v[76:79] offset:1024
    ds_write_b128 v2, v[12:15] offset:8192
    s_waitcnt vmcnt(16)
    s_barrier
    ds_read_b64_tr_b16 v[40:41], v28 offset:0
    ds_read_b64_tr_b16 v[42:43], v28 offset:256
    ds_read_b64_tr_b16 v[144:145], v28 offset:32
    ds_read_b64_tr_b16 v[146:147], v28 offset:288
    ds_read_b64_tr_b16 v[160:161], v28 offset:64
    ds_read_b64_tr_b16 v[162:163], v28 offset:320
    ds_read_b64_tr_b16 v[176:177], v28 offset:96
    ds_read_b64_tr_b16 v[178:179], v28 offset:352
    ds_read_b64_tr_b16 v[192:193], v28 offset:4096
    ds_read_b64_tr_b16 v[194:195], v28 offset:4352
    ds_read_b64_tr_b16 v[208:209], v28 offset:4128
    ds_read_b64_tr_b16 v[210:211], v28 offset:4384
    s_waitcnt lgkmcnt(4)
    ds_read_b64_tr_b16 v[224:225], v28 offset:4160
    ds_read_b64_tr_b16 v[226:227], v28 offset:4416
    ds_read_b64_tr_b16 v[240:241], v28 offset:4192
    ds_read_b64_tr_b16 v[242:243], v28 offset:4448
    s_add_u32 m0, s72, 24576
    s_add_u32 s63, s91, 110592
    buffer_load_dwordx4 v21, s[92:95], s63 offen nt lds
    s_add_u32 m0, s72, 25600
    s_add_u32 s63, s91, 119808
    buffer_load_dwordx4 v21, s[92:95], s63 offen nt lds
    s_add_u32 m0, s72, 26624
    s_add_u32 s63, s91, 129024
    buffer_load_dwordx4 v21, s[92:95], s63 offen nt lds
    s_add_u32 m0, s72, 27648
    s_add_u32 s63, s91, 138240
    buffer_load_dwordx4 v21, s[92:95], s63 offen nt lds
    s_add_u32 m0, s72, 28672
    s_add_u32 s63, s91, 110720
    buffer_load_dwordx4 v21, s[92:95], s63 offen nt lds
    s_add_u32 m0, s72, 29696
    s_add_u32 s63, s91, 119936
    buffer_load_dwordx4 v21, s[92:95], s63 offen nt lds
    s_add_u32 m0, s72, 30720
    s_add_u32 s63, s91, 129152
    buffer_load_dwordx4 v21, s[92:95], s63 offen nt lds
    s_add_u32 m0, s72, 31744
    s_add_u32 s63, s91, 138368
    buffer_load_dwordx4 v21, s[92:95], s63 offen nt lds
    s_waitcnt lgkmcnt(0)
    s_waitcnt vmcnt(16)
    s_barrier
    ds_read_b64_tr_b16 v[44:45], v28 offset:8192
    ds_read_b64_tr_b16 v[46:47], v28 offset:8448
    ds_read_b64_tr_b16 v[148:149], v28 offset:8224
    ds_read_b64_tr_b16 v[150:151], v28 offset:8480
    ds_read_b64_tr_b16 v[164:165], v28 offset:8256
    ds_read_b64_tr_b16 v[166:167], v28 offset:8512
    ds_read_b64_tr_b16 v[180:181], v28 offset:8288
    ds_read_b64_tr_b16 v[182:183], v28 offset:8544
    ds_read_b64_tr_b16 v[196:197], v28 offset:12288
    ds_read_b64_tr_b16 v[198:199], v28 offset:12544
    ds_read_b64_tr_b16 v[212:213], v28 offset:12320
    ds_read_b64_tr_b16 v[214:215], v28 offset:12576
    s_waitcnt lgkmcnt(4)
    ds_read_b64_tr_b16 v[228:229], v28 offset:12352
    ds_read_b64_tr_b16 v[230:231], v28 offset:12608
    ds_read_b64_tr_b16 v[244:245], v28 offset:12384
    ds_read_b64_tr_b16 v[246:247], v28 offset:12640
    s_add_u32 m0, s72, 0
    s_add_u32 s63, s73, 524288
    buffer_load_dwordx4 v20, s[48:51], s63 offen nt lds
    s_add_u32 m0, s72, 1024
    s_add_u32 s63, s73, 589824
    buffer_load_dwordx4 v20, s[48:51], s63 offen nt lds
    s_add_u32 m0, s72, 2048
    s_add_u32 s63, s73, 655360
    buffer_load_dwordx4 v36, s[48:51], s63 offen nt lds
    s_add_u32 m0, s72, 3072
    s_add_u32 s63, s73, 720896
    buffer_load_dwordx4 v36, s[48:51], s63 offen nt lds
    s_add_u32 m0, s72, 4096
    s_add_u32 s63, s73, 786432
    buffer_load_dwordx4 v37, s[48:51], s63 offen nt lds
    s_add_u32 m0, s72, 5120
    s_add_u32 s63, s73, 851968
    buffer_load_dwordx4 v37, s[48:51], s63 offen nt lds
    s_add_u32 m0, s72, 6144
    s_add_u32 s63, s73, 917504
    buffer_load_dwordx4 v38, s[48:51], s63 offen nt lds
    s_add_u32 m0, s72, 7168
    s_add_u32 s63, s73, 983040
    buffer_load_dwordx4 v38, s[48:51], s63 offen nt lds
    s_waitcnt lgkmcnt(0)
    s_waitcnt vmcnt(16)
    s_barrier
    ds_read_b64_tr_b16 v[48:49], v28 offset:16384
    ds_read_b64_tr_b16 v[50:51], v28 offset:16640
    ds_read_b64_tr_b16 v[152:153], v28 offset:16416
    ds_read_b64_tr_b16 v[154:155], v28 offset:16672
    ds_read_b64_tr_b16 v[168:169], v28 offset:16448
    ds_read_b64_tr_b16 v[170:171], v28 offset:16704
    ds_read_b64_tr_b16 v[184:185], v28 offset:16480
    ds_read_b64_tr_b16 v[186:187], v28 offset:16736
    ds_read_b64_tr_b16 v[200:201], v28 offset:20480
    ds_read_b64_tr_b16 v[202:203], v28 offset:20736
    ds_read_b64_tr_b16 v[216:217], v28 offset:20512
    ds_read_b64_tr_b16 v[218:219], v28 offset:20768
    s_waitcnt lgkmcnt(4)
    ds_read_b64_tr_b16 v[232:233], v28 offset:20544
    ds_read_b64_tr_b16 v[234:235], v28 offset:20800
    ds_read_b64_tr_b16 v[248:249], v28 offset:20576
    ds_read_b64_tr_b16 v[250:251], v28 offset:20832
    s_add_u32 m0, s72, 8192
    s_add_u32 s63, s75, 524288
    buffer_load_dwordx4 v20, s[48:51], s63 offen nt lds
    s_add_u32 m0, s72, 9216
    s_add_u32 s63, s75, 589824
    buffer_load_dwordx4 v20, s[48:51], s63 offen nt lds
    s_add_u32 m0, s72, 10240
    s_add_u32 s63, s75, 655360
    buffer_load_dwordx4 v36, s[48:51], s63 offen nt lds
    s_add_u32 m0, s72, 11264
    s_add_u32 s63, s75, 720896
    buffer_load_dwordx4 v36, s[48:51], s63 offen nt lds
    s_add_u32 m0, s72, 12288
    s_add_u32 s63, s75, 786432
    buffer_load_dwordx4 v37, s[48:51], s63 offen nt lds
    s_add_u32 m0, s72, 13312
    s_add_u32 s63, s75, 851968
    buffer_load_dwordx4 v37, s[48:51], s63 offen nt lds
    s_add_u32 m0, s72, 14336
    s_add_u32 s63, s75, 917504
    buffer_load_dwordx4 v38, s[48:51], s63 offen nt lds
    s_add_u32 m0, s72, 15360
    s_add_u32 s63, s75, 983040
    buffer_load_dwordx4 v38, s[48:51], s63 offen nt lds
    s_waitcnt lgkmcnt(0)
    s_waitcnt vmcnt(16)
    s_barrier
    ds_read_b64_tr_b16 v[52:53], v28 offset:24576
    ds_read_b64_tr_b16 v[54:55], v28 offset:24832
    ds_read_b64_tr_b16 v[156:157], v28 offset:24608
    ds_read_b64_tr_b16 v[158:159], v28 offset:24864
    ds_read_b64_tr_b16 v[172:173], v28 offset:24640
    ds_read_b64_tr_b16 v[174:175], v28 offset:24896
    ds_read_b64_tr_b16 v[188:189], v28 offset:24672
    ds_read_b64_tr_b16 v[190:191], v28 offset:24928
    ds_read_b64_tr_b16 v[204:205], v28 offset:28672
    ds_read_b64_tr_b16 v[206:207], v28 offset:28928
    ds_read_b64_tr_b16 v[220:221], v28 offset:28704
    ds_read_b64_tr_b16 v[222:223], v28 offset:28960
    s_waitcnt lgkmcnt(4)
    ds_read_b64_tr_b16 v[236:237], v28 offset:28736
    ds_read_b64_tr_b16 v[238:239], v28 offset:28992
    ds_read_b64_tr_b16 v[252:253], v28 offset:28768
    ds_read_b64_tr_b16 v[254:255], v28 offset:29024
    s_add_u32 m0, s72, 16384
    s_add_u32 s63, s97, 4194304
    buffer_load_dwordx4 v20, s[48:51], s63 offen nt lds
    s_add_u32 m0, s72, 17408
    s_add_u32 s63, s97, 4259840
    buffer_load_dwordx4 v20, s[48:51], s63 offen nt lds
    s_add_u32 m0, s72, 18432
    s_add_u32 s63, s97, 4325376
    buffer_load_dwordx4 v20, s[48:51], s63 offen nt lds
    s_add_u32 m0, s72, 19456
    s_add_u32 s63, s97, 4390912
    buffer_load_dwordx4 v20, s[48:51], s63 offen nt lds
    s_waitcnt lgkmcnt(0)
    ds_write_b128 v3, v[40:43] offset:32768
    ds_write_b128 v3, v[44:47] offset:33792
    ds_write_b128 v3, v[48:51] offset:34816
    ds_write_b128 v3, v[52:55] offset:35840
    s_waitcnt lgkmcnt(0)
    s_waitcnt vmcnt(12)
    s_barrier
    ds_read_b64_tr_b16 a[0:1], v26 offset:0
    ds_read_b64_tr_b16 a[2:3], v26 offset:128
    ds_read_b64_tr_b16 a[4:5], v26 offset:1024
    ds_read_b64_tr_b16 a[6:7], v26 offset:1152
    ds_read_b64_tr_b16 a[8:9], v34 offset:0
    ds_read_b64_tr_b16 a[10:11], v34 offset:128
    ds_read_b64_tr_b16 a[12:13], v34 offset:1024
    ds_read_b64_tr_b16 a[14:15], v34 offset:1152
    ds_read_b64_tr_b16 a[16:17], v27 offset:0
    ds_read_b64_tr_b16 a[18:19], v27 offset:128
    ds_read_b64_tr_b16 a[20:21], v27 offset:1024
    ds_read_b64_tr_b16 a[22:23], v27 offset:1152
    s_waitcnt lgkmcnt(4)
    ds_read_b64_tr_b16 a[24:25], v35 offset:0
    ds_read_b64_tr_b16 a[26:27], v35 offset:128
    ds_read_b64_tr_b16 a[28:29], v35 offset:1024
    ds_read_b64_tr_b16 a[30:31], v35 offset:1152
    s_add_u32 m0, s72, 24576
    s_add_u32 s63, s73, 0
    buffer_load_dwordx4 v20, s[52:55], s63 offen nt lds
    s_add_u32 m0, s72, 25600
    s_add_u32 s63, s73, 65536
    buffer_load_dwordx4 v20, s[52:55], s63 offen nt lds
    s_add_u32 m0, s72, 26624
    s_add_u32 s63, s73, 131072
    buffer_load_dwordx4 v36, s[52:55], s63 offen nt lds
    s_add_u32 m0, s72, 27648
    s_add_u32 s63, s73, 196608
    buffer_load_dwordx4 v36, s[52:55], s63 offen nt lds
    s_add_u32 m0, s72, 28672
    s_add_u32 s63, s73, 262144
    buffer_load_dwordx4 v37, s[52:55], s63 offen nt lds
    s_add_u32 m0, s72, 29696
    s_add_u32 s63, s73, 327680
    buffer_load_dwordx4 v37, s[52:55], s63 offen nt lds
    s_add_u32 m0, s72, 30720
    s_add_u32 s63, s73, 393216
    buffer_load_dwordx4 v38, s[52:55], s63 offen nt lds
    s_add_u32 m0, s72, 31744
    s_add_u32 s63, s73, 458752
    buffer_load_dwordx4 v38, s[52:55], s63 offen nt lds
    s_waitcnt lgkmcnt(0)
    s_waitcnt vmcnt(12)
    s_barrier
    ds_read_b64_tr_b16 a[32:33], v26 offset:8192
    ds_read_b64_tr_b16 a[34:35], v26 offset:8320
    ds_read_b64_tr_b16 a[36:37], v26 offset:9216
    ds_read_b64_tr_b16 a[38:39], v26 offset:9344
    ds_read_b64_tr_b16 a[40:41], v34 offset:8192
    ds_read_b64_tr_b16 a[42:43], v34 offset:8320
    ds_read_b64_tr_b16 a[44:45], v34 offset:9216
    ds_read_b64_tr_b16 a[46:47], v34 offset:9344
    ds_read_b64_tr_b16 a[48:49], v27 offset:8192
    ds_read_b64_tr_b16 a[50:51], v27 offset:8320
    ds_read_b64_tr_b16 a[52:53], v27 offset:9216
    ds_read_b64_tr_b16 a[54:55], v27 offset:9344
    s_waitcnt lgkmcnt(4)
    ds_read_b64_tr_b16 a[56:57], v35 offset:8192
    ds_read_b64_tr_b16 a[58:59], v35 offset:8320
    ds_read_b64_tr_b16 a[60:61], v35 offset:9216
    ds_read_b64_tr_b16 a[62:63], v35 offset:9344
    s_add_u32 m0, s72, 0
    s_add_u32 s63, s73, 524288
    buffer_load_dwordx4 v20, s[52:55], s63 offen nt lds
    s_add_u32 m0, s72, 1024
    s_add_u32 s63, s73, 589824
    buffer_load_dwordx4 v20, s[52:55], s63 offen nt lds
    s_add_u32 m0, s72, 2048
    s_add_u32 s63, s73, 655360
    buffer_load_dwordx4 v36, s[52:55], s63 offen nt lds
    s_add_u32 m0, s72, 3072
    s_add_u32 s63, s73, 720896
    buffer_load_dwordx4 v36, s[52:55], s63 offen nt lds
    s_add_u32 m0, s72, 4096
    s_add_u32 s63, s73, 786432
    buffer_load_dwordx4 v37, s[52:55], s63 offen nt lds
    s_add_u32 m0, s72, 5120
    s_add_u32 s63, s73, 851968
    buffer_load_dwordx4 v37, s[52:55], s63 offen nt lds
    s_add_u32 m0, s72, 6144
    s_add_u32 s63, s73, 917504
    buffer_load_dwordx4 v38, s[52:55], s63 offen nt lds
    s_add_u32 m0, s72, 7168
    s_add_u32 s63, s73, 983040
    buffer_load_dwordx4 v38, s[52:55], s63 offen nt lds
    s_waitcnt lgkmcnt(0)
    s_waitcnt vmcnt(16)
    s_barrier
    ds_read_b64_tr_b16 a[64:65], v30 offset:16384
    ds_read_b64_tr_b16 a[66:67], v30 offset:16896
    ds_read_b64_tr_b16 a[68:69], v31 offset:16384
    ds_read_b64_tr_b16 a[70:71], v31 offset:16896
    ds_read_b64_tr_b16 a[72:73], v30 offset:16416
    ds_read_b64_tr_b16 a[74:75], v30 offset:16928
    ds_read_b64_tr_b16 a[76:77], v31 offset:16416
    ds_read_b64_tr_b16 a[78:79], v31 offset:16928
    s_add_u32 m0, s72, 8192
    s_add_u32 s63, s75, 0
    buffer_load_dwordx4 v20, s[52:55], s63 offen nt lds
    s_add_u32 m0, s72, 9216
    s_add_u32 s63, s75, 65536
    buffer_load_dwordx4 v20, s[52:55], s63 offen nt lds
    s_add_u32 m0, s72, 10240
    s_add_u32 s63, s75, 131072
    buffer_load_dwordx4 v36, s[52:55], s63 offen nt lds
    s_add_u32 m0, s72, 11264
    s_add_u32 s63, s75, 196608
    buffer_load_dwordx4 v36, s[52:55], s63 offen nt lds
    s_add_u32 m0, s72, 12288
    s_add_u32 s63, s75, 262144
    buffer_load_dwordx4 v37, s[52:55], s63 offen nt lds
    s_add_u32 m0, s72, 13312
    s_add_u32 s63, s75, 327680
    buffer_load_dwordx4 v37, s[52:55], s63 offen nt lds
    s_add_u32 m0, s72, 14336
    s_add_u32 s63, s75, 393216
    buffer_load_dwordx4 v38, s[52:55], s63 offen nt lds
    s_add_u32 m0, s72, 15360
    s_add_u32 s63, s75, 458752
    buffer_load_dwordx4 v38, s[52:55], s63 offen nt lds
    s_waitcnt lgkmcnt(0)
    s_waitcnt vmcnt(16)
    s_barrier
    ds_read_b64_tr_b16 a[80:81], v26 offset:24576
    ds_read_b64_tr_b16 a[82:83], v26 offset:24704
    ds_read_b64_tr_b16 a[84:85], v26 offset:25600
    ds_read_b64_tr_b16 a[86:87], v26 offset:25728
    ds_read_b64_tr_b16 a[88:89], v34 offset:24576
    ds_read_b64_tr_b16 a[90:91], v34 offset:24704
    ds_read_b64_tr_b16 a[92:93], v34 offset:25600
    ds_read_b64_tr_b16 a[94:95], v34 offset:25728
    ds_read_b64_tr_b16 a[112:113], v27 offset:24576
    ds_read_b64_tr_b16 a[114:115], v27 offset:24704
    ds_read_b64_tr_b16 a[116:117], v27 offset:25600
    ds_read_b64_tr_b16 a[118:119], v27 offset:25728
    s_waitcnt lgkmcnt(4)
    ds_read_b64_tr_b16 a[120:121], v35 offset:24576
    ds_read_b64_tr_b16 a[122:123], v35 offset:24704
    ds_read_b64_tr_b16 a[124:125], v35 offset:25600
    ds_read_b64_tr_b16 a[126:127], v35 offset:25728
    s_add_u32 m0, s72, 16384
    s_add_u32 s63, s97, 4194304
    buffer_load_dwordx4 v20, s[52:55], s63 offen nt lds
    s_add_u32 m0, s72, 17408
    s_add_u32 s63, s97, 4259840
    buffer_load_dwordx4 v20, s[52:55], s63 offen nt lds
    s_add_u32 m0, s72, 18432
    s_add_u32 s63, s97, 4325376
    buffer_load_dwordx4 v20, s[52:55], s63 offen nt lds
    s_add_u32 m0, s72, 19456
    s_add_u32 s63, s97, 4390912
    buffer_load_dwordx4 v20, s[52:55], s63 offen nt lds
    s_waitcnt lgkmcnt(0)
    s_waitcnt vmcnt(12)
    s_barrier
    ds_read_b64_tr_b16 a[96:97], v26 offset:0
    ds_read_b64_tr_b16 a[98:99], v26 offset:128
    ds_read_b64_tr_b16 a[100:101], v26 offset:1024
    ds_read_b64_tr_b16 a[102:103], v26 offset:1152
    ds_read_b64_tr_b16 a[104:105], v34 offset:0
    ds_read_b64_tr_b16 a[106:107], v34 offset:128
    ds_read_b64_tr_b16 a[108:109], v34 offset:1024
    ds_read_b64_tr_b16 a[110:111], v34 offset:1152
    ds_read_b64_tr_b16 a[128:129], v27 offset:0
    ds_read_b64_tr_b16 a[130:131], v27 offset:128
    ds_read_b64_tr_b16 a[132:133], v27 offset:1024
    ds_read_b64_tr_b16 a[134:135], v27 offset:1152
    s_waitcnt lgkmcnt(4)
    ds_read_b64_tr_b16 a[136:137], v35 offset:0
    ds_read_b64_tr_b16 a[138:139], v35 offset:128
    ds_read_b64_tr_b16 a[140:141], v35 offset:1024
    ds_read_b64_tr_b16 a[142:143], v35 offset:1152
    s_add_u32 m0, s72, 24576
    s_add_u32 s63, s73, 0
    buffer_load_dwordx4 v20, s[56:59], s63 offen nt lds
    s_add_u32 m0, s72, 25600
    s_add_u32 s63, s73, 65536
    buffer_load_dwordx4 v20, s[56:59], s63 offen nt lds
    s_add_u32 m0, s72, 26624
    s_add_u32 s63, s73, 131072
    buffer_load_dwordx4 v36, s[56:59], s63 offen nt lds
    s_add_u32 m0, s72, 27648
    s_add_u32 s63, s73, 196608
    buffer_load_dwordx4 v36, s[56:59], s63 offen nt lds
    s_add_u32 m0, s72, 28672
    s_add_u32 s63, s73, 262144
    buffer_load_dwordx4 v37, s[56:59], s63 offen nt lds
    s_add_u32 m0, s72, 29696
    s_add_u32 s63, s73, 327680
    buffer_load_dwordx4 v37, s[56:59], s63 offen nt lds
    s_add_u32 m0, s72, 30720
    s_add_u32 s63, s73, 393216
    buffer_load_dwordx4 v38, s[56:59], s63 offen nt lds
    s_add_u32 m0, s72, 31744
    s_add_u32 s63, s73, 458752
    buffer_load_dwordx4 v38, s[56:59], s63 offen nt lds
    s_waitcnt lgkmcnt(0)
    s_waitcnt vmcnt(12)
    s_barrier
    ds_read_b64_tr_b16 a[144:145], v26 offset:8192
    ds_read_b64_tr_b16 a[146:147], v26 offset:8320
    ds_read_b64_tr_b16 a[148:149], v26 offset:9216
    ds_read_b64_tr_b16 a[150:151], v26 offset:9344
    ds_read_b64_tr_b16 a[152:153], v34 offset:8192
    ds_read_b64_tr_b16 a[154:155], v34 offset:8320
    ds_read_b64_tr_b16 a[156:157], v34 offset:9216
    ds_read_b64_tr_b16 a[158:159], v34 offset:9344
    ds_read_b64_tr_b16 a[160:161], v27 offset:8192
    ds_read_b64_tr_b16 a[162:163], v27 offset:8320
    ds_read_b64_tr_b16 a[164:165], v27 offset:9216
    ds_read_b64_tr_b16 a[166:167], v27 offset:9344
    s_waitcnt lgkmcnt(4)
    ds_read_b64_tr_b16 a[168:169], v35 offset:8192
    ds_read_b64_tr_b16 a[170:171], v35 offset:8320
    ds_read_b64_tr_b16 a[172:173], v35 offset:9216
    ds_read_b64_tr_b16 a[174:175], v35 offset:9344
    s_add_u32 m0, s72, 0
    s_add_u32 s63, s73, 524288
    buffer_load_dwordx4 v20, s[56:59], s63 offen nt lds
    s_add_u32 m0, s72, 1024
    s_add_u32 s63, s73, 589824
    buffer_load_dwordx4 v20, s[56:59], s63 offen nt lds
    s_add_u32 m0, s72, 2048
    s_add_u32 s63, s73, 655360
    buffer_load_dwordx4 v36, s[56:59], s63 offen nt lds
    s_add_u32 m0, s72, 3072
    s_add_u32 s63, s73, 720896
    buffer_load_dwordx4 v36, s[56:59], s63 offen nt lds
    s_add_u32 m0, s72, 4096
    s_add_u32 s63, s73, 786432
    buffer_load_dwordx4 v37, s[56:59], s63 offen nt lds
    s_add_u32 m0, s72, 5120
    s_add_u32 s63, s73, 851968
    buffer_load_dwordx4 v37, s[56:59], s63 offen nt lds
    s_add_u32 m0, s72, 6144
    s_add_u32 s63, s73, 917504
    buffer_load_dwordx4 v38, s[56:59], s63 offen nt lds
    s_add_u32 m0, s72, 7168
    s_add_u32 s63, s73, 983040
    buffer_load_dwordx4 v38, s[56:59], s63 offen nt lds
    s_waitcnt lgkmcnt(0)
    s_waitcnt vmcnt(16)
    s_barrier
    ds_read_b64_tr_b16 a[176:177], v30 offset:16384
    ds_read_b64_tr_b16 a[178:179], v30 offset:16896
    ds_read_b64_tr_b16 a[180:181], v31 offset:16384
    ds_read_b64_tr_b16 a[182:183], v31 offset:16896
    ds_read_b64_tr_b16 a[184:185], v30 offset:16416
    ds_read_b64_tr_b16 a[186:187], v30 offset:16928
    ds_read_b64_tr_b16 a[188:189], v31 offset:16416
    ds_read_b64_tr_b16 a[190:191], v31 offset:16928
    s_add_u32 m0, s72, 8192
    s_add_u32 s63, s75, 0
    buffer_load_dwordx4 v20, s[56:59], s63 offen nt lds
    s_add_u32 m0, s72, 9216
    s_add_u32 s63, s75, 65536
    buffer_load_dwordx4 v20, s[56:59], s63 offen nt lds
    s_add_u32 m0, s72, 10240
    s_add_u32 s63, s75, 131072
    buffer_load_dwordx4 v36, s[56:59], s63 offen nt lds
    s_add_u32 m0, s72, 11264
    s_add_u32 s63, s75, 196608
    buffer_load_dwordx4 v36, s[56:59], s63 offen nt lds
    s_add_u32 m0, s72, 12288
    s_add_u32 s63, s75, 262144
    buffer_load_dwordx4 v37, s[56:59], s63 offen nt lds
    s_add_u32 m0, s72, 13312
    s_add_u32 s63, s75, 327680
    buffer_load_dwordx4 v37, s[56:59], s63 offen nt lds
    s_add_u32 m0, s72, 14336
    s_add_u32 s63, s75, 393216
    buffer_load_dwordx4 v38, s[56:59], s63 offen nt lds
    s_add_u32 m0, s72, 15360
    s_add_u32 s63, s75, 458752
    buffer_load_dwordx4 v38, s[56:59], s63 offen nt lds
    s_waitcnt lgkmcnt(0)
    s_waitcnt vmcnt(16)
    s_barrier
    ds_read_b64_tr_b16 a[192:193], v26 offset:24576
    ds_read_b64_tr_b16 a[194:195], v26 offset:24704
    ds_read_b64_tr_b16 a[196:197], v26 offset:25600
    ds_read_b64_tr_b16 a[198:199], v26 offset:25728
    ds_read_b64_tr_b16 a[200:201], v34 offset:24576
    ds_read_b64_tr_b16 a[202:203], v34 offset:24704
    ds_read_b64_tr_b16 a[204:205], v34 offset:25600
    ds_read_b64_tr_b16 a[206:207], v34 offset:25728
    ds_read_b64_tr_b16 a[224:225], v27 offset:24576
    ds_read_b64_tr_b16 a[226:227], v27 offset:24704
    ds_read_b64_tr_b16 a[228:229], v27 offset:25600
    ds_read_b64_tr_b16 a[230:231], v27 offset:25728
    s_waitcnt lgkmcnt(4)
    ds_read_b64_tr_b16 a[232:233], v35 offset:24576
    ds_read_b64_tr_b16 a[234:235], v35 offset:24704
    ds_read_b64_tr_b16 a[236:237], v35 offset:25600
    ds_read_b64_tr_b16 a[238:239], v35 offset:25728
    s_add_u32 m0, s72, 16384
    s_add_u32 s63, s75, 524288
    buffer_load_dwordx4 v20, s[56:59], s63 offen nt lds
    s_add_u32 m0, s72, 17408
    s_add_u32 s63, s75, 589824
    buffer_load_dwordx4 v20, s[56:59], s63 offen nt lds
    s_add_u32 m0, s72, 18432
    s_add_u32 s63, s75, 655360
    buffer_load_dwordx4 v36, s[56:59], s63 offen nt lds
    s_add_u32 m0, s72, 19456
    s_add_u32 s63, s75, 720896
    buffer_load_dwordx4 v36, s[56:59], s63 offen nt lds
    s_add_u32 m0, s72, 20480
    s_add_u32 s63, s75, 786432
    buffer_load_dwordx4 v37, s[56:59], s63 offen nt lds
    s_add_u32 m0, s72, 21504
    s_add_u32 s63, s75, 851968
    buffer_load_dwordx4 v37, s[56:59], s63 offen nt lds
    s_add_u32 m0, s72, 22528
    s_add_u32 s63, s75, 917504
    buffer_load_dwordx4 v38, s[56:59], s63 offen nt lds
    s_add_u32 m0, s72, 23552
    s_add_u32 s63, s75, 983040
    buffer_load_dwordx4 v38, s[56:59], s63 offen nt lds
    s_waitcnt lgkmcnt(0)
    s_cmp_ge_u32 s4, 3
    s_cbranch_scc1 L_cend_105
    s_mov_b32 s60, 1048576
    s_lshl_b32 s63, s7, 3
    s_add_u32 s64, s44, s63
    s_addc_u32 s65, s45, 0
    s_load_dwordx2 s[16:17], s[64:65], 0
    s_load_dwordx2 s[18:19], s[64:65], 32
    s_load_dwordx2 s[20:21], s[64:65], 64
    s_load_dwordx2 s[22:23], s[64:65], 96
    s_load_dwordx2 s[24:25], s[64:65], 128
    s_load_dwordx2 s[26:27], s[64:65], 160
    s_load_dwordx2 s[28:29], s[64:65], 192
    s_load_dwordx2 s[30:31], s[64:65], 224
L_cen_104:
    s_waitcnt lgkmcnt(0)
    s_mov_b32 s63, 0
    s_mov_b32 vcc_lo, 0
    s_mov_b32 vcc_hi, 0
    s_not_b32 s16, s16
    s_or_b32 vcc_hi, vcc_hi, s16
    s_and_b32 s16, s17, 0xff
    s_or_b32 vcc_hi, vcc_hi, s16
    s_lshr_b32 s17, s17, 8
    s_add_u32 s63, s63, s17
    s_xor_b32 s17, s17, 32
    s_or_b32 vcc_lo, vcc_lo, s17
    s_not_b32 s18, s18
    s_or_b32 vcc_hi, vcc_hi, s18
    s_and_b32 s18, s19, 0xff
    s_or_b32 vcc_hi, vcc_hi, s18
    s_lshr_b32 s19, s19, 8
    s_add_u32 s63, s63, s19
    s_xor_b32 s19, s19, 32
    s_or_b32 vcc_lo, vcc_lo, s19
    s_not_b32 s20, s20
    s_or_b32 vcc_hi, vcc_hi, s20
    s_and_b32 s20, s21, 0xff
    s_or_b32 vcc_hi, vcc_hi, s20
    s_lshr_b32 s21, s21, 8
    s_add_u32 s63, s63, s21
    s_xor_b32 s21, s21, 32
    s_or_b32 vcc_lo, vcc_lo, s21
    s_not_b32 s22, s22
    s_or_b32 vcc_hi, vcc_hi, s22
    s_and_b32 s22, s23, 0xff
    s_or_b32 vcc_hi, vcc_hi, s22
    s_lshr_b32 s23, s23, 8
    s_add_u32 s63, s63, s23
    s_xor_b32 s23, s23, 32
    s_or_b32 vcc_lo, vcc_lo, s23
    s_not_b32 s24, s24
    s_or_b32 vcc_hi, vcc_hi, s24
    s_and_b32 s24, s25, 0xff
    s_or_b32 vcc_hi, vcc_hi, s24
    s_lshr_b32 s25, s25, 8
    s_add_u32 s63, s63, s25
    s_xor_b32 s25, s25, 32
    s_or_b32 vcc_lo, vcc_lo, s25
    s_not_b32 s26, s26
    s_or_b32 vcc_hi, vcc_hi, s26
    s_and_b32 s26, s27, 0xff
    s_or_b32 vcc_hi, vcc_hi, s26
    s_lshr_b32 s27, s27, 8
    s_add_u32 s63, s63, s27
    s_xor_b32 s27, s27, 32
    s_or_b32 vcc_lo, vcc_lo, s27
    s_not_b32 s28, s28
    s_or_b32 vcc_hi, vcc_hi, s28
    s_and_b32 s28, s29, 0xff
    s_or_b32 vcc_hi, vcc_hi, s28
    s_lshr_b32 s29, s29, 8
    s_add_u32 s63, s63, s29
    s_xor_b32 s29, s29, 32
    s_or_b32 vcc_lo, vcc_lo, s29
    s_not_b32 s30, s30
    s_or_b32 vcc_hi, vcc_hi, s30
    s_and_b32 s30, s31, 0xff
    s_or_b32 vcc_hi, vcc_hi, s30
    s_lshr_b32 s31, s31, 8
    s_add_u32 s63, s63, s31
    s_xor_b32 s31, s31, 32
    s_or_b32 vcc_lo, vcc_lo, s31
    s_or_b32 vcc_hi, vcc_hi, vcc_lo
    s_cbranch_scc0 L_cend_105
    s_cmp_ge_u32 s63, 256
    s_cbranch_scc1 L_renumber
    s_sleep 16
    s_sub_u32 s60, s60, 1
    s_cbranch_scc1 L_abort
    s_load_dwordx2 s[16:17], s[64:65], 0 glc
    s_load_dwordx2 s[18:19], s[64:65], 32 glc
    s_load_dwordx2 s[20:21], s[64:65], 64 glc
    s_load_dwordx2 s[22:23], s[64:65], 96 glc
    s_load_dwordx2 s[24:25], s[64:65], 128 glc
    s_load_dwordx2 s[26:27], s[64:65], 160 glc
    s_load_dwordx2 s[28:29], s[64:65], 192 glc
    s_load_dwordx2 s[30:31], s[64:65], 224 glc
    s_branch L_cen_104
L_cend_105:
    s_mov_b32 s60, 1048576
    s_load_dwordx16 s[16:31], s[46:47], 2048
L_pz_106:
    s_waitcnt lgkmcnt(0)
    s_and_b32 s16, s16, s17
    s_and_b32 s16, s16, s18
    s_and_b32 s16, s16, s19
    s_and_b32 s16, s16, s20
    s_and_b32 s16, s16, s21
    s_and_b32 s16, s16, s22
    s_and_b32 s16, s16, s23
    s_and_b32 s16, s16, s24
    s_and_b32 s16, s16, s25
    s_and_b32 s16, s16, s26
    s_and_b32 s16, s16, s27
    s_and_b32 s16, s16, s28
    s_and_b32 s16, s16, s29
    s_and_b32 s16, s16, s30
    s_and_b32 s16, s16, s31
    s_cbranch_scc1 L_pzd_107
    s_sleep 16
    s_sub_u32 s60, s60, 1
    s_cbranch_scc1 L_abort
    s_load_dwordx16 s[16:31], s[46:47], 2048 glc
    s_branch L_pz_106
L_pzd_107:
    s_getpc_b64 s[16:17]
L_pc_108:
    s_add_u32 s16, s16, L_chain_setup - L_pc_108
    s_addc_u32 s17, s17, 0
    v_lshlrev_b32 v32, 7, v0
    global_load_dword v33, v32, s[16:17]
    s_lshr_b32 s18, s4, 2
    s_mul_i32 s18, s18, 2097152
    s_lshl_b32 s19, s5, 2
    s_add_u32 s19, s19, s3
    s_mul_i32 s19, s19, 4824
    s_add_u32 s18, s18, s19
    s_add_u32 s18, s18, 20971520
    buffer_load_dword v33, v32, s[8:11], s18 offen sc1
    s_waitcnt vmcnt(16)
    s_barrier
    ds_read_b64_tr_b16 a[208:209], v26 offset:0
    ds_read_b64_tr_b16 a[210:211], v26 offset:128
    ds_read_b64_tr_b16 a[212:213], v26 offset:1024
    ds_read_b64_tr_b16 a[214:215], v26 offset:1152
    ds_read_b64_tr_b16 a[216:217], v34 offset:0
    ds_read_b64_tr_b16 a[218:219], v34 offset:128
    ds_read_b64_tr_b16 a[220:221], v34 offset:1024
    ds_read_b64_tr_b16 a[222:223], v34 offset:1152
    ds_read_b64_tr_b16 a[240:241], v27 offset:0
    ds_read_b64_tr_b16 a[242:243], v27 offset:128
    ds_read_b64_tr_b16 a[244:245], v27 offset:1024
    ds_read_b64_tr_b16 a[246:247], v27 offset:1152
    s_waitcnt lgkmcnt(4)
    ds_read_b64_tr_b16 a[248:249], v35 offset:0
    ds_read_b64_tr_b16 a[250:251], v35 offset:128
    ds_read_b64_tr_b16 a[252:253], v35 offset:1024
    ds_read_b64_tr_b16 a[254:255], v35 offset:1152
    s_add_u32 m0, s72, 24576
    s_add_u32 s63, s97, 4194304
    buffer_load_dwordx4 v20, s[56:59], s63 offen nt lds
    s_add_u32 m0, s72, 25600
    s_add_u32 s63, s97, 4259840
    buffer_load_dwordx4 v20, s[56:59], s63 offen nt lds
    s_add_u32 m0, s72, 26624
    s_add_u32 s63, s97, 4325376
    buffer_load_dwordx4 v20, s[56:59], s63 offen nt lds
    s_add_u32 m0, s72, 27648
    s_add_u32 s63, s97, 4390912
    buffer_load_dwordx4 v20, s[56:59], s63 offen nt lds
    s_waitcnt lgkmcnt(0)
    s_waitcnt vmcnt(12)
    s_barrier
    ds_read_b64_tr_b16 v[80:81], v26 offset:8192
    ds_read_b64_tr_b16 v[82:83], v26 offset:8320
    ds_read_b64_tr_b16 v[84:85], v26 offset:9216
    ds_read_b64_tr_b16 v[86:87], v26 offset:9344
    ds_read_b64_tr_b16 v[88:89], v34 offset:8192
    ds_read_b64_tr_b16 v[90:91], v34 offset:8320
    ds_read_b64_tr_b16 v[92:93], v34 offset:9216
    ds_read_b64_tr_b16 v[94:95], v34 offset:9344
    ds_read_b64_tr_b16 v[112:113], v27 offset:8192
    ds_read_b64_tr_b16 v[114:115], v27 offset:8320
    ds_read_b64_tr_b16 v[116:117], v27 offset:9216
    ds_read_b64_tr_b16 v[118:119], v27 offset:9344
    s_waitcnt lgkmcnt(4)
    ds_read_b64_tr_b16 v[120:121], v35 offset:8192
    ds_read_b64_tr_b16 v[122:123], v35 offset:8320
    ds_read_b64_tr_b16 v[124:125], v35 offset:9216
    ds_read_b64_tr_b16 v[126:127], v35 offset:9344
    s_add_u32 m0, s72, 28672
    s_add_u32 s63, s96, 1024
    buffer_load_dwordx4 v22, s[92:95], s63 offen  lds
    s_add_u32 m0, s72, 29696
    s_add_u32 s63, s96, 37888
    buffer_load_dwordx4 v22, s[92:95], s63 offen  lds
    s_add_u32 m0, s72, 30720
    s_add_u32 s63, s96, 74752
    buffer_load_dwordx4 v22, s[92:95], s63 offen  lds
    s_add_u32 m0, s72, 31744
    s_add_u32 s63, s96, 111616
    buffer_load_dwordx4 v22, s[92:95], s63 offen  lds
    s_waitcnt lgkmcnt(0)
    s_waitcnt vmcnt(8)
    s_barrier
    ds_read_b64_tr_b16 v[96:97], v26 offset:16384
    ds_read_b64_tr_b16 v[98:99], v26 offset:16512
    ds_read_b64_tr_b16 v[100:101], v26 offset:17408
    ds_read_b64_tr_b16 v[102:103], v26 offset:17536
    ds_read_b64_tr_b16 v[104:105], v34 offset:16384
    ds_read_b64_tr_b16 v[106:107], v34 offset:16512
    ds_read_b64_tr_b16 v[108:109], v34 offset:17408
    ds_read_b64_tr_b16 v[110:111], v34 offset:17536
    ds_read_b64_tr_b16 v[128:129], v27 offset:16384
    ds_read_b64_tr_b16 v[130:131], v27 offset:16512
    ds_read_b64_tr_b16 v[132:133], v27 offset:17408
    ds_read_b64_tr_b16 v[134:135], v27 offset:17536
    s_waitcnt lgkmcnt(4)
    ds_read_b64_tr_b16 v[136:137], v35 offset:16384
    ds_read_b64_tr_b16 v[138:139], v35 offset:16512
    ds_read_b64_tr_b16 v[140:141], v35 offset:17408
    ds_read_b64_tr_b16 v[142:143], v35 offset:17536
    s_add_u32 m0, s72, 0
    s_add_u32 s63, s73, 0
    buffer_load_dwordx4 v20, s[48:51], s63 offen nt lds
    s_add_u32 m0, s72, 1024
    s_add_u32 s63, s73, 65536
    buffer_load_dwordx4 v20, s[48:51], s63 offen nt lds
    s_add_u32 m0, s72, 2048
    s_add_u32 s63, s73, 131072
    buffer_load_dwordx4 v36, s[48:51], s63 offen nt lds
    s_add_u32 m0, s72, 3072
    s_add_u32 s63, s73, 196608
    buffer_load_dwordx4 v36, s[48:51], s63 offen nt lds
    s_add_u32 m0, s72, 4096
    s_add_u32 s63, s73, 262144
    buffer_load_dwordx4 v37, s[48:51], s63 offen nt lds
    s_add_u32 m0, s72, 5120
    s_add_u32 s63, s73, 327680
    buffer_load_dwordx4 v37, s[48:51], s63 offen nt lds
    s_add_u32 m0, s72, 6144
    s_add_u32 s63, s73, 393216
    buffer_load_dwordx4 v38, s[48:51], s63 offen nt lds
    s_add_u32 m0, s72, 7168
    s_add_u32 s63, s73, 458752
    buffer_load_dwordx4 v38, s[48:51], s63 offen nt lds
    s_waitcnt lgkmcnt(0)
    s_waitcnt vmcnt(12)
    s_barrier
    ds_read_b64_tr_b16 v[40:41], v30 offset:24576
    ds_read_b64_tr_b16 v[42:43], v30 offset:25088
    ds_read_b64_tr_b16 v[44:45], v31 offset:24576
    ds_read_b64_tr_b16 v[46:47], v31 offset:25088
    ds_read_b64_tr_b16 v[48:49], v30 offset:24608
    ds_read_b64_tr_b16 v[50:51], v30 offset:25120
    ds_read_b64_tr_b16 v[52:53], v31 offset:24608
    ds_read_b64_tr_b16 v[54:55], v31 offset:25120
    s_add_u32 m0, s72, 8192
    s_add_u32 s63, s75, 0
    buffer_load_dwordx4 v20, s[48:51], s63 offen nt lds
    s_add_u32 m0, s72, 9216
    s_add_u32 s63, s75, 65536
    buffer_load_dwordx4 v20, s[48:51], s63 offen nt lds
    s_add_u32 m0, s72, 10240
    s_add_u32 s63, s75, 131072
    buffer_load_dwordx4 v36, s[48:51], s63 offen nt lds
    s_add_u32 m0, s72, 11264
    s_add_u32 s63, s75, 196608
    buffer_load_dwordx4 v36, s[48:51], s63 offen nt lds
    s_add_u32 m0, s72, 12288
    s_add_u32 s63, s75, 262144
    buffer_load_dwordx4 v37, s[48:51], s63 offen nt lds
    s_add_u32 m0, s72, 13312
    s_add_u32 s63, s75, 327680
    buffer_load_dwordx4 v37, s[48:51], s63 offen nt lds
    s_add_u32 m0, s72, 14336
    s_add_u32 s63, s75, 393216
    buffer_load_dwordx4 v38, s[48:51], s63 offen nt lds
    s_add_u32 m0, s72, 15360
    s_add_u32 s63, s75, 458752
    buffer_load_dwordx4 v38, s[48:51], s63 offen nt lds
    s_waitcnt lgkmcnt(0)
    s_barrier
    ds_write_b128 v3, v[40:43] offset:24576
    ds_write_b128 v3, v[44:47] offset:25600
    ds_write_b128 v3, v[48:51] offset:26624
    ds_write_b128 v3, v[52:55] offset:27648
    s_waitcnt lgkmcnt(0)
    s_waitcnt vmcnt(16)
    s_barrier
    ds_read_b64_tr_b16 v[40:41], v29 offset:28672
    ds_read_b64_tr_b16 v[42:43], v29 offset:28736
    ds_read_b64_tr_b16 v[44:45], v29 offset:29696
    ds_read_b64_tr_b16 v[46:47], v29 offset:29760
    ds_read_b64_tr_b16 v[48:49], v29 offset:30720
    ds_read_b64_tr_b16 v[50:51], v29 offset:30784
    ds_read_b64_tr_b16 v[52:53], v29 offset:31744
    ds_read_b64_tr_b16 v[54:55], v29 offset:31808
    s_add_u32 m0, s72, 16384
    s_add_u32 s63, s75, 524288
    buffer_load_dwordx4 v20, s[52:55], s63 offen nt lds
    s_add_u32 m0, s72, 17408
    s_add_u32 s63, s75, 589824
    buffer_load_dwordx4 v20, s[52:55], s63 offen nt lds
    s_add_u32 m0, s72, 18432
    s_add_u32 s63, s75, 655360
    buffer_load_dwordx4 v36, s[52:55], s63 offen nt lds
    s_add_u32 m0, s72, 19456
    s_add_u32 s63, s75, 720896
    buffer_load_dwordx4 v36, s[52:55], s63 offen nt lds
    s_add_u32 m0, s72, 20480
    s_add_u32 s63, s75, 786432
    buffer_load_dwordx4 v37, s[52:55], s63 offen nt lds
    s_add_u32 m0, s72, 21504
    s_add_u32 s63, s75, 851968
    buffer_load_dwordx4 v37, s[52:55], s63 offen nt lds
    s_add_u32 m0, s72, 22528
    s_add_u32 s63, s75, 917504
    buffer_load_dwordx4 v38, s[52:55], s63 offen nt lds
    s_add_u32 m0, s72, 23552
    s_add_u32 s63, s75, 983040
    buffer_load_dwordx4 v38, s[52:55], s63 offen nt lds
    s_waitcnt lgkmcnt(0)
    ds_write_b128 v3, v[40:43] offset:28672
    ds_write_b128 v3, v[44:47] offset:29696
    ds_write_b128 v3, v[48:51] offset:30720
    ds_write_b128 v3, v[52:55] offset:31744
    s_waitcnt lgkmcnt(0)
    s_waitcnt vmcnt(16)
    s_barrier
    ds_read_b64_tr_b16 v[40:41], v26 offset:0
    ds_read_b64_tr_b16 v[42:43], v26 offset:128
    ds_read_b64_tr_b16 v[44:45], v26 offset:1024
    ds_read_b64_tr_b16 v[46:47], v26 offset:1152
    ds_read_b64_tr_b16 v[48:49], v34 offset:0
    ds_read_b64_tr_b16 v[50:51], v34 offset:128
    ds_read_b64_tr_b16 v[52:53], v34 offset:1024
    ds_read_b64_tr_b16 v[54:55], v34 offset:1152
    ds_read_b64_tr_b16 v[56:57], v27 offset:0
    ds_read_b64_tr_b16 v[58:59], v27 offset:128
    ds_read_b64_tr_b16 v[60:61], v27 offset:1024
    ds_read_b64_tr_b16 v[62:63], v27 offset:1152
    s_waitcnt lgkmcnt(4)
    ds_read_b64_tr_b16 v[64:65], v35 offset:0
    ds_read_b64_tr_b16 v[66:67], v35 offset:128
    ds_read_b64_tr_b16 v[68:69], v35 offset:1024
    ds_read_b64_tr_b16 v[70:71], v35 offset:1152
    s_waitcnt lgkmcnt(0)
    s_barrier
    ds_write_b128 v3, v[40:43] offset:0
    ds_write_b128 v3, v[44:47] offset:1024
    ds_write_b128 v3, v[48:51] offset:2048
    ds_write_b128 v3, v[52:55] offset:3072
    ds_write_b128 v3, v[56:59] offset:4096
    ds_write_b128 v3, v[60:63] offset:5120
    ds_write_b128 v3, v[64:67] offset:6144
    ds_write_b128 v3, v[68:71] offset:7168
    s_waitcnt lgkmcnt(0)
    s_lshr_b32 s66, s4, 2
    s_lshl_b32 s69, s5, 2
    s_add_u32 s69, s69, s3
    s_lshl_b32 s79, s66, 7
    s_add_u32 s79, s79, s69
    s_lshl_b32 s79, s79, 8
    s_lshl_b32 s77, s66, 5
    s_add_u32 s77, s77, s5
    s_mul_i32 s77, s77, 2101248
    s_add_u32 s77, s77, 67108864
    s_add_u32 s78, s77, 16384
    s_lshl_b32 s18, s3, 12
    s_add_u32 s18, s18, s77
    s_add_u32 s19, s79, 65536
    v_and_b32 v32, 0xfff, v32
    v_mov_b32 v39, 0
    buffer_load_dword v33, v32, s[8:11], s18 offen sc1
    buffer_load_dword v39, v39, s[8:11], s19 offen sc1
    s_waitcnt vmcnt(8)
    s_barrier
    ds_read_b64_tr_b16 v[40:41], v26 offset:8192
    ds_read_b64_tr_b16 v[42:43], v26 offset:8320
    ds_read_b64_tr_b16 v[44:45], v26 offset:9216
    ds_read_b64_tr_b16 v[46:47], v26 offset:9344
    ds_read_b64_tr_b16 v[48:49], v34 offset:8192
    ds_read_b64_tr_b16 v[50:51], v34 offset:8320
    ds_read_b64_tr_b16 v[52:53], v34 offset:9216
    ds_read_b64_tr_b16 v[54:55], v34 offset:9344
    ds_read_b64_tr_b16 v[56:57], v27 offset:8192
    ds_read_b64_tr_b16 v[58:59], v27 offset:8320
    ds_read_b64_tr_b16 v[60:61], v27 offset:9216
    ds_read_b64_tr_b16 v[62:63], v27 offset:9344
    s_waitcnt lgkmcnt(4)
    ds_read_b64_tr_b16 v[64:65], v35 offset:8192
    ds_read_b64_tr_b16 v[66:67], v35 offset:8320
    ds_read_b64_tr_b16 v[68:69], v35 offset:9216
    ds_read_b64_tr_b16 v[70:71], v35 offset:9344
    s_waitcnt lgkmcnt(0)
    s_barrier
    ds_write_b128 v3, v[40:43] offset:8192
    ds_write_b128 v3, v[44:47] offset:9216
    ds_write_b128 v3, v[48:51] offset:10240
    ds_write_b128 v3, v[52:55] offset:11264
    ds_write_b128 v3, v[56:59] offset:12288
    ds_write_b128 v3, v[60:63] offset:13312
    ds_write_b128 v3, v[64:67] offset:14336
    ds_write_b128 v3, v[68:71] offset:15360
    s_waitcnt lgkmcnt(0)
    s_waitcnt vmcnt(0)
    s_barrier
    ds_read_b64_tr_b16 v[40:41], v26 offset:16384
    ds_read_b64_tr_b16 v[42:43], v26 offset:16512
    ds_read_b64_tr_b16 v[44:45], v26 offset:17408
    ds_read_b64_tr_b16 v[46:47], v26 offset:17536
    ds_read_b64_tr_b16 v[48:49], v34 offset:16384
    ds_read_b64_tr_b16 v[50:51], v34 offset:16512
    ds_read_b64_tr_b16 v[52:53], v34 offset:17408
    ds_read_b64_tr_b16 v[54:55], v34 offset:17536
    ds_read_b64_tr_b16 v[56:57], v27 offset:16384
    ds_read_b64_tr_b16 v[58:59], v27 offset:16512
    ds_read_b64_tr_b16 v[60:61], v27 offset:17408
    ds_read_b64_tr_b16 v[62:63], v27 offset:17536
    s_waitcnt lgkmcnt(4)
    ds_read_b64_tr_b16 v[64:65], v35 offset:16384
    ds_read_b64_tr_b16 v[66:67], v35 offset:16512
    ds_read_b64_tr_b16 v[68:69], v35 offset:17408
    ds_read_b64_tr_b16 v[70:71], v35 offset:17536
    s_waitcnt lgkmcnt(0)
    s_barrier
    ds_write_b128 v3, v[40:43] offset:16384
    ds_write_b128 v3, v[44:47] offset:17408
    ds_write_b128 v3, v[48:51] offset:18432
    ds_write_b128 v3, v[52:55] offset:19456
    ds_write_b128 v3, v[56:59] offset:20480
    ds_write_b128 v3, v[60:63] offset:21504
    ds_write_b128 v3, v[64:67] offset:22528
    ds_write_b128 v3, v[68:71] offset:23552
    s_waitcnt lgkmcnt(0)
L_chain_setup:
    s_waitcnt vmcnt(0)
    v_readfirstlane_b32 s83, v39
    s_lshr_b32 s66, s4, 2
    s_mul_i32 s68, s66, 2097152
    s_add_u32 s68, s68, 20971520
    s_lshl_b32 s69, s5, 2
    s_add_u32 s69, s69, s3
    s_lshl_b32 s51, s3, 11
    s_lshl_b32 s54, s5, 6
    s_and_b32 s71, s5, 1
    s_or_b32 s71, s71, s3
    s_and_b32 s63, s3, 1
    s_lshl_b32 s64, s5, 1
    s_add_u32 s63, s63, s64
    s_lshr_b32 s64, s63, 4
    s_lshl_b32 s64, s64, 1
    s_lshr_b32 s65, s3, 1
    s_add_u32 s64, s64, s65
    s_lshl_b32 s64, s64, 4
    s_and_b32 s65, s63, 15
    s_add_u32 s70, s64, s65
    s_lshl_b32 s70, s70, 11
    s_sub_u32 s70, s70, s51
    s_and_b32 s65, s63, 3
    s_lshl_b32 s65, s65, 2
    s_add_u32 s64, s64, s65
    s_bfe_u32 s65, s63, 0x20002
    s_add_u32 s64, s64, s65
    s_lshl_b32 s49, s64, 6
    s_lshr_b32 s63, s5, 1
    s_add_u32 s63, s63, 128
    s_lshl_b32 s50, s63, 6
    s_lshl_b32 s48, s63, 11
    s_lshr_b32 s63, s3, 1
    s_lshl_b32 s63, s63, 11
    s_and_b32 s64, s3, 1
    s_lshl_b32 s64, s64, 9
    s_add_u32 s63, s63, s64
    s_add_u32 s52, s63, 12288
    s_lshl_b32 s63, s3, 2
    s_add_u32 s53, s63, 10240
    s_mov_b32 s86, 0x000f000f
    s_mov_b32 s87, 0x000f000f
    s_mov_b32 s84, 0xcccccccc
    s_mov_b32 s85, 0xcccccccc
    s_mov_b32 s88, 1040356334
    v_lshrrev_b32 v20, 4, v0
    v_and_b32 v24, 1, v0
    v_bfe_u32 v25, v0, 2, 2
    v_mov_b32 v26, 0x3f80
    v_mov_b32 v27, 0x3f800000
    v_cmp_eq_u32 vcc, 1, v24
    s_nop 1
    v_cndmask_b32 v28, v26, v27, vcc
    v_cmp_eq_u32 vcc, v25, v20
    s_nop 1
    v_cndmask_b32 v4, 0, v28, vcc
    v_mov_b32 v5, 0
    v_mov_b32 v6, 0
    v_mov_b32 v7, v4
    v_lshlrev_b32 v2, 4, v0
    ds_read_b128 v[36:39], v1
    ds_read_b128 v[48:51], v1 offset:1024
    ds_read_b128 v[40:43], v2 offset:8192
    s_waitcnt lgkmcnt(0)
    s_add_u32 s75, s68, 589824
    s_add_u32 s63, s75, 8192
    s_cmp_lg_u32 s5, 0
    s_cbranch_scc1 L_m0done
    buffer_store_dwordx4 v[48:51], v1, s[8:11], s75 offen offset:1024 sc1
    s_cmp_lg_u32 s3, 0
    s_cbranch_scc1 L_m0done
    buffer_store_dwordx4 v[40:43], v2, s[8:11], s63 offen sc1
L_m0done:
    v_mov_b32 v26, 0x4444
    v_mov_b32 v27, 0xeeee
    v_cndmask_b32 v0, v26, v27, s[84:85]
    s_mov_b32 s67, 0
    s_add_u32 s77, s77, s51
    s_mul_i32 s63, s3, 160
    s_add_u32 m0, s63, 8192
    s_add_u32 s80, s70, s68
    s_add_u32 s80, s80, 294912
    s_add_u32 s73, s68, 294912
    s_lshl_b32 s94, s5, 10
    s_lshl_b32 s63, s3, 8
    s_sub_u32 s94, s94, s63
    s_add_u32 s94, s94, 262144
    s_barrier
    v_mov_b64 v[20:21], 0
    v_mov_b64 v[22:23], 0
    s_mov_b64 exec, 0x1
    v_mov_b32 v20, 0x3f80
    s_mov_b64 exec, 0x2
    v_mov_b32 v21, 0x3f80
    s_mov_b64 exec, 0x10
    v_mov_b32 v20, 0x3f800000
    s_mov_b64 exec, 0x20
    v_mov_b32 v21, 0x3f800000
    s_mov_b64 exec, 0x100
    v_mov_b32 v22, 0x3f80
    s_mov_b64 exec, 0x200
    v_mov_b32 v23, 0x3f80
    s_mov_b64 exec, 0x1000
    v_mov_b32 v22, 0x3f800000
    s_mov_b64 exec, 0x2000
    v_mov_b32 v23, 0x3f800000
    s_mov_b64 exec, 0xffff
    ds_write_b128 v2, v[20:23] offset:8960
    s_mov_b64 exec, -1
    s_waitcnt lgkmcnt(0)
    s_cmp_lg_u32 s6, 0
    s_cbranch_scc1 L_chain_safe
    ds_read_b128 v[56:59], v3 offset:0
    ds_read_b128 v[60:63], v3 offset:1024
    ds_read_b128 v[64:67], v3 offset:2048
    ds_read_b128 v[68:71], v3 offset:3072
    v_mov_b64 v[12:13], 0
    v_mov_b64 v[14:15], 0
    v_mov_b64 v[16:17], 0
    v_mov_b64 v[18:19], 0
    v_mov_b64 v[20:21], 0
    v_mov_b64 v[22:23], 0
    v_mov_b64 v[24:25], 0
    v_mov_b64 v[26:27], 0
    v_mov_b64 v[28:29], 0
    v_mov_b64 v[30:31], 0
    v_mov_b64 v[32:33], 0
    v_mov_b64 v[34:35], 0
    s_add_u32 s95, s75, 589696
    s_add_u32 s74, s49, s75
    s_add_u32 s76, s50, s75
    s_add_u32 s93, s73, s94
    s_and_b32 s73, s67, 1
    s_mul_i32 s73, s73, 294912
    s_add_u32 s73, s73, s68
    s_add_u32 s82, s73, s54
    s_add_u32 s55, s82, 32768
    s_lshl_b32 s56, s51, 2
    s_add_u32 s56, s56, s82
    s_add_u32 s56, s56, 262144
    s_sub_u32 s57, s75, s51
    s_add_u32 s57, s57, 8192
    s_add_u32 s58, s79, 131068
    s_add_u32 s59, s77, s51
    s_add_u32 s59, s59, 24576
    s_add_u32 s89, s79, 65540
    s_lshl_b32 s90, s69, 7
    s_add_u32 s90, s90, s75
    s_add_u32 s90, s90, 18432
    s_min_u32 s90, s90, s95
    s_mov_b32 s92, s80
    s_add_u32 s80, s70, s73
    s_add_u32 s81, s48, s73
    s_add_u32 s74, s74, 9216
    s_add_u32 s76, s76, 9216
    s_cmp_lg_u32 s83, 0
    s_cselect_b32 s91, s77, s68
    s_add_u32 s58, s78, s51
    s_add_u32 s58, s58, 1792
    s_mov_b32 s60, 1048576
    s_waitcnt lgkmcnt(0)
L_stepF:
    s_waitcnt vmcnt(2)
    v_max3_u32 v2, v36, v37, v38
    v_max_u32 v2, v2, v39
L_stepbF:
    ds_write_b128 v1, v[36:39]
    v_smfmac_f32_16x16x64_bf16 v[12:15], v[36:39], v[56:63], v0
    v_cmp_eq_u32 vcc, -1, v2
    v_smfmac_f32_16x16x64_bf16 v[16:19], v[36:39], v[64:71], v0
    s_cbranch_vccnz L_ge_109
    v_xor_b32 v2, 2048, v1
    s_waitcnt lgkmcnt(0)
    s_barrier
    ds_read_b128 v[8:11], v2 offset:0
    v_smfmac_f32_16x16x64_bf16 v[20:23], v[36:39], a[80:87], v0
    buffer_load_dwordx4 v[48:51], v1, s[8:11], s75 offen offset:1024 sc1
    ds_read_b128 v[56:59], v3 offset:4096
    v_smfmac_f32_16x16x64_bf16 v[24:27], v[36:39], a[88:95], v0
    ds_read_b128 v[60:63], v3 offset:5120
    ds_read_b128 v[64:67], v3 offset:6144
    v_smfmac_f32_16x16x64_bf16 v[28:31], v[36:39], a[192:199], v0
    ds_read_b128 v[68:71], v3 offset:7168
    v_xor_b32 v2, 4096, v1
    v_smfmac_f32_16x16x64_bf16 v[32:35], v[36:39], a[200:207], v0
    ds_read_b128 v[52:55], v2 offset:0
    v_xor_b32 v2, 6144, v1
    s_waitcnt lgkmcnt(5)
    v_smfmac_f32_16x16x64_bf16 v[20:23], v[8:11], a[112:119], v0
    ds_read_b128 v[44:47], v2 offset:0
    v_smfmac_f32_16x16x64_bf16 v[24:27], v[8:11], a[120:127], v0
    buffer_load_dwordx4 v[72:75], v1, s[8:11], s91 offen offset:2048 sc1
    v_smfmac_f32_16x16x64_bf16 v[28:31], v[8:11], a[224:231], v0
    v_smfmac_f32_16x16x64_bf16 v[32:35], v[8:11], a[232:239], v0
    buffer_load_dwordx4 v[76:79], v1, s[8:11], s91 offen offset:3072 sc1
    s_waitcnt lgkmcnt(4)
    v_smfmac_f32_16x16x64_bf16 v[12:15], v[8:11], v[56:63], v0
    ds_read_b128 v[56:59], v3 offset:8192
    s_waitcnt lgkmcnt(3)
    v_smfmac_f32_16x16x64_bf16 v[16:19], v[8:11], v[64:71], v0
    ds_read_b128 v[60:63], v3 offset:9216
    s_waitcnt lgkmcnt(3)
    v_smfmac_f32_16x16x64_bf16 v[20:23], v[52:55], a[144:151], v0
    ds_read_b128 v[64:67], v3 offset:10240
    v_smfmac_f32_16x16x64_bf16 v[24:27], v[52:55], a[152:159], v0
    ds_read_b128 v[68:71], v3 offset:11264
    v_smfmac_f32_16x16x64_bf16 v[28:31], v[52:55], v[80:87], v0
    buffer_load_dwordx4 v[8:11], v1, s[8:11], s57 offen sc1
    v_smfmac_f32_16x16x64_bf16 v[32:35], v[52:55], v[88:95], v0
    s_waitcnt lgkmcnt(4)
    v_smfmac_f32_16x16x64_bf16 v[20:23], v[44:47], a[160:167], v0
    buffer_load_dwordx4 v[40:43], v1, s[8:11], s91 offen offset:1024 sc1
    v_smfmac_f32_16x16x64_bf16 v[24:27], v[44:47], a[168:175], v0
    s_waitcnt vmcnt(4)
    v_max3_u32 v2, v48, v49, v50
    v_smfmac_f32_16x16x64_bf16 v[28:31], v[44:47], v[112:119], v0
    v_max_u32 v2, v2, v51
    v_smfmac_f32_16x16x64_bf16 v[32:35], v[44:47], v[120:127], v0
    v_cmp_eq_u32 vcc, -1, v2
    s_waitcnt lgkmcnt(2)
    v_smfmac_f32_16x16x64_bf16 v[12:15], v[52:55], v[56:63], v0
    ds_read_b128 v[56:59], v3 offset:12288
    s_cbranch_vccnz L_go_110
L_gook_111:
    ds_write_b128 v1, v[48:51] offset:1024
    s_waitcnt lgkmcnt(2)
    v_smfmac_f32_16x16x64_bf16 v[16:19], v[52:55], v[64:71], v0
    ds_read_b128 v[60:63], v3 offset:13312
    v_smfmac_f32_16x16x64_bf16 v[12:15], v[48:51], a[0:7], v0
    ds_read_b128 v[64:67], v3 offset:14336
    buffer_load_dwordx4 v[36:39], v1, s[8:11], s91 offen offset:0 sc1
    v_smfmac_f32_16x16x64_bf16 v[16:19], v[48:51], a[8:15], v0
    ds_read_b128 v[68:71], v3 offset:15360
    v_xor_b32 v2, 4096, v1
    v_smfmac_f32_16x16x64_bf16 v[20:23], v[48:51], a[96:103], v0
    s_waitcnt lgkmcnt(3)
    s_barrier
    ds_read_b128 v[52:55], v2 offset:1024
    v_smfmac_f32_16x16x64_bf16 v[24:27], v[48:51], a[104:111], v0
    buffer_store_dword v0, v5, s[8:11], s58 offen sc1
    v_smfmac_f32_16x16x64_bf16 v[28:31], v[48:51], a[208:215], v0
    v_xor_b32 v2, 6144, v1
    v_smfmac_f32_16x16x64_bf16 v[32:35], v[48:51], a[216:223], v0
    ds_read_b128 v[48:51], v2 offset:1024
    s_waitcnt lgkmcnt(4)
    v_smfmac_f32_16x16x64_bf16 v[12:15], v[44:47], v[56:63], v0
    ds_read_b128 v[56:59], v3 offset:16384
    v_and_b32 v2, 0x1f0, v1
    s_waitcnt lgkmcnt(3)
    v_smfmac_f32_16x16x64_bf16 v[16:19], v[44:47], v[64:71], v0
    ds_read_b128 v[60:63], v3 offset:17408
    v_lshl_add_u32 v2, v2, 3, s59
    s_waitcnt lgkmcnt(3)
    v_smfmac_f32_16x16x64_bf16 v[12:15], v[52:55], a[32:39], v0
    ds_read_b128 v[64:67], v3 offset:18432
    v_writelane_b32 v2, s89, 32
    v_smfmac_f32_16x16x64_bf16 v[16:19], v[52:55], a[40:47], v0
    ds_read_b128 v[68:71], v3 offset:19456
    v_writelane_b32 v2, s90, 33
    buffer_load_dword v2, s[8:11], 0 offen sc1 lds
    v_smfmac_f32_16x16x64_bf16 v[28:31], v[52:55], v[96:103], v0
    v_xor_b32 v2, 2048, v1
    ds_read_b128 v[44:47], v2 offset:1024
    v_smfmac_f32_16x16x64_bf16 v[32:35], v[52:55], v[104:111], v0
    s_waitcnt vmcnt(4)
    v_max3_u32 v2, v8, v9, v10
    s_waitcnt lgkmcnt(5)
    v_smfmac_f32_16x16x64_bf16 v[12:15], v[48:51], a[48:55], v0
    v_max_u32 v2, v2, v11
    v_smfmac_f32_16x16x64_bf16 v[16:19], v[48:51], a[56:63], v0
    v_cmp_eq_u32 vcc, -1, v2
    s_waitcnt lgkmcnt(3)
    v_smfmac_f32_16x16x64_bf16 v[20:23], v[52:55], v[56:63], v0
    ds_read_b128 v[56:59], v3 offset:20480
    s_cbranch_vccnz L_t8_112
L_t8ok_113:
    s_waitcnt lgkmcnt(2)
    v_smfmac_f32_16x16x64_bf16 v[24:27], v[52:55], v[64:71], v0
    ds_read_b128 v[60:63], v3 offset:21504
    v_mov_b64 v[52:53], -1
    s_waitcnt lgkmcnt(2)
    v_smfmac_f32_16x16x64_bf16 v[12:15], v[44:47], a[16:23], v0
    ds_read_b128 v[64:67], v3 offset:22528
    v_mov_b64 v[54:55], -1
    v_smfmac_f32_16x16x64_bf16 v[16:19], v[44:47], a[24:31], v0
    ds_read_b128 v[68:71], v3 offset:23552
    v_lshrrev_b32 v2, 2, v1
    v_smfmac_f32_16x16x64_bf16 v[12:15], v[8:11], a[64:71], v0
    buffer_store_dwordx4 v[52:55], v1, s[8:11], s92 offen
    v_smfmac_f32_16x16x64_bf16 v[16:19], v[8:11], a[72:79], v0
    buffer_store_dword v52, v2, s[8:11], s93 offen
    v_smfmac_f32_16x16x64_bf16 v[20:23], v[44:47], a[128:135], v0
    v_add_f32 v12, v12, v14
    v_smfmac_f32_16x16x64_bf16 v[24:27], v[44:47], a[136:143], v0
    s_cmp_eq_u32 s83, 0
    s_cbranch_scc1 L_kvwait_114
L_kvok_115:
    v_add_f32 v13, v13, v15
    v_smfmac_f32_16x16x64_bf16 v[20:23], v[8:11], a[176:183], v0
    buffer_store_dwordx4 v[52:55], v1, s[8:11], s92 offen offset:1024
    v_smfmac_f32_16x16x64_bf16 v[24:27], v[8:11], a[184:191], v0
    v_add_f32 v16, v16, v18
    s_waitcnt lgkmcnt(2)
    v_smfmac_f32_16x16x64_bf16 v[20:23], v[48:51], v[56:63], v0
    ds_read_b128 v[56:59], v3 offset:24576
    v_add_f32 v17, v17, v19
    s_waitcnt lgkmcnt(1)
    v_smfmac_f32_16x16x64_bf16 v[24:27], v[48:51], v[64:71], v0
    ds_read_b128 v[60:63], v3 offset:25600
    v_and_b32 v2, 0x3ff, v1
    v_cvt_pk_bf16_f32 v52, v12, v13
    v_cvt_pk_bf16_f32 v53, v16, v17
    ds_read_b128 v[64:67], v3 offset:26624
    ds_read_b128 v[68:71], v3 offset:27648
    v_mfma_f32_16x16x16_bf16 v[12:15], v[52:53], v[4:5], 0
    v_add_f32 v20, v20, v22
    v_add_f32 v21, v21, v23
    v_mfma_f32_16x16x16_bf16 v[16:19], v[52:53], v[6:7], 0
    v_add_f32 v24, v24, v26
    v_add_f32 v25, v25, v27
    v_cvt_pk_bf16_f32 v54, v20, v21
    v_cvt_pk_bf16_f32 v55, v24, v25
    v_smfmac_f32_16x16x64_bf16 v[28:31], v[44:47], a[240:247], v0
    v_mfma_f32_16x16x16_bf16 v[20:23], v[54:55], v[4:5], 0
    v_cvt_pk_bf16_f32 v12, v12, v13
    v_cvt_pk_bf16_f32 v13, v14, v15
    v_mfma_f32_16x16x16_bf16 v[24:27], v[54:55], v[6:7], 0
    v_cvt_pk_bf16_f32 v14, v16, v17
    v_cvt_pk_bf16_f32 v15, v18, v19
    v_smfmac_f32_16x16x64_bf16 v[32:35], v[44:47], a[248:255], v0
    s_waitcnt vmcnt(5)
    v_mfma_f32_16x16x32_bf16 v[16:19], v[36:39], v[12:15], 0
    v_cvt_pk_bf16_f32 v44, v20, v21
    v_cvt_pk_bf16_f32 v45, v22, v23
    v_mfma_f32_16x16x32_bf16 v[52:55], v[40:43], v[12:15], 0
    v_cvt_pk_bf16_f32 v46, v24, v25
    v_cvt_pk_bf16_f32 v47, v26, v27
    v_add_u32 v20, s53, v2
    s_nop 0
    v_mfma_f32_16x16x32_bf16 v[24:27], v[44:47], v[12:15], 0
    v_smfmac_f32_16x16x64_bf16 v[28:31], v[48:51], v[128:135], v0
    v_cndmask_b32 v16, v16, v52, s[84:85]
    v_cndmask_b32 v17, v17, v53, s[84:85]
    v_cndmask_b32 v18, v18, v54, s[84:85]
    v_cndmask_b32 v19, v19, v55, s[84:85]
    v_cndmask_b32 v24, v24, v25, s[84:85]
    v_smfmac_f32_16x16x64_bf16 v[32:35], v[48:51], v[136:143], v0
    ds_write_b128 v1, v[16:19] offset:9216
    ds_write_b32 v20, v24
    s_waitcnt lgkmcnt(4)
    v_smfmac_f32_16x16x64_bf16 v[28:31], v[8:11], v[56:63], v0
    s_waitcnt lgkmcnt(2)
    v_smfmac_f32_16x16x64_bf16 v[32:35], v[8:11], v[64:71], v0
    v_and_b32 v8, 0xf0, v1
    v_mov_b64 v[36:37], 0
    v_mov_b64 v[38:39], 0
    v_mov_b64 v[40:41], 0
    v_mov_b64 v[42:43], 0
    s_waitcnt lgkmcnt(0)
    s_barrier
    ds_read_b128 v[12:15], v2 offset:9216
    v_pk_add_f32 v[28:29], v[28:29], v[30:31]
    ds_read_b128 v[16:19], v2 offset:11264
    v_pk_add_f32 v[32:33], v[32:33], v[34:35]
    ds_read_b128 v[20:23], v2 offset:13312
    v_cvt_pk_bf16_f32 v28, v28, v29
    ds_read_b128 v[24:27], v2 offset:15360
    v_cvt_pk_bf16_f32 v29, v32, v33
    ds_read_b128 v[52:55], v2 offset:10240
    v_cvt_pk_bf16_f32 v30, v32, v33
    v_mov_b32_dpp v32, v28 quad_perm:[2,3,0,1] row_mask:0xf bank_mask:0xf
    v_mov_b32_dpp v33, v29 quad_perm:[2,3,0,1] row_mask:0xf bank_mask:0xf
    v_cndmask_b32 v44, v44, v28, s[84:85]
    v_cndmask_b32 v45, v45, v29, s[84:85]
    v_cndmask_b32 v46, v46, v32, s[84:85]
    v_cndmask_b32 v47, v47, v33, s[84:85]
    buffer_store_dwordx4 v[44:47], v1, s[8:11], s78 offen sc1
    v_mov_b32 v31, 0
    s_cmp_eq_u32 s67, 63
    s_cbranch_scc1 L_lastF
    s_waitcnt lgkmcnt(3)
    v_pk_add_f32 v[12:13], v[12:13], v[16:17]
    v_pk_add_f32 v[14:15], v[14:15], v[18:19]
    s_waitcnt lgkmcnt(1)
    v_pk_add_f32 v[20:21], v[20:21], v[24:25]
    v_pk_add_f32 v[22:23], v[22:23], v[26:27]
    s_waitcnt lgkmcnt(0)
    v_pk_add_f32 v[52:53], v[52:53], v[54:55]
    v_pk_add_f32 v[12:13], v[12:13], v[20:21]
    v_pk_add_f32 v[14:15], v[14:15], v[22:23]
    v_add_f32 v16, v52, v53
    v_max3_f32 v17, v12, v13, v14
    v_max3_f32 v17, v17, v15, v16
    v_bfe_u32 v11, v1, 8, 1
    v_lshl_or_b32 v8, v11, 5, v8
    v_max_f32_dpp v17, v17, v17 quad_perm:[2,3,0,1] row_mask:0xf bank_mask:0xf
    v_mov_b32 v18, v17
    v_bfe_u32 v11, v1, 9, 1
    v_lshl_or_b32 v8, v11, 8, v8
    v_permlane16_swap_b32 v17, v18
    v_max_f32 v17, v17, v18
    v_mov_b32 v18, v17
    v_add_u32 v8, s52, v8
    v_mov_b32 v35, 0
    v_permlane32_swap_b32 v17, v18
    v_max_f32 v17, v17, v18
    v_mul_f32 v17, s88, v17
    v_fma_f32 v12, v12, s88, -v17
    v_fma_f32 v13, v13, s88, -v17
    v_fma_f32 v14, v14, s88, -v17
    v_fma_f32 v15, v15, s88, -v17
    v_fma_f32 v16, v16, s88, -v17
    v_exp_f32 v16, v16
    v_exp_f32 v12, v12
    v_exp_f32 v13, v13
    v_exp_f32 v14, v14
    v_exp_f32 v15, v15
    v_cvt_pk_bf16_f32 v52, v12, v13
    v_cvt_pk_bf16_f32 v53, v14, v15
    v_mov_b32_dpp v34, v16 quad_perm:[2,3,0,1] row_mask:0xf bank_mask:0xf
    v_mov_b32_dpp v54, v52 quad_perm:[2,3,0,1] row_mask:0xf bank_mask:0xf
    v_mov_b32_dpp v55, v53 quad_perm:[2,3,0,1] row_mask:0xf bank_mask:0xf
    v_cvt_pk_bf16_f32 v34, v16, v34
    v_pk_add_f32 v[12:13], v[12:13], v[14:15]
    v_mfma_f32_16x16x32_bf16 v[20:23], v[72:75], v[52:55], 0
    v_add_f32 v12, v12, v16
    v_add_f32 v17, v12, v13
    v_mfma_f32_16x16x32_bf16 v[24:27], v[76:79], v[52:55], 0
    ds_read_b128 v[56:59], v3 offset:32768
    v_add_f32_dpp v17, v17, v17 quad_perm:[2,3,0,1] row_mask:0xf bank_mask:0xf
    v_mov_b32 v18, v17
    v_mfma_f32_16x16x16_bf16 v[20:23], v[28:29], v[34:35], v[20:23]
    ds_read_b128 v[60:63], v3 offset:33792
    v_permlane16_swap_b32 v17, v18
    v_add_f32 v17, v17, v18
    v_mov_b32 v18, v17
    v_mfma_f32_16x16x16_bf16 v[24:27], v[30:31], v[34:35], v[24:27]
    ds_read_b128 v[64:67], v3 offset:34816
    v_permlane32_swap_b32 v17, v18
    v_add_f32 v17, v17, v18
    v_rcp_f32 v17, v17
    ds_read_b128 v[68:71], v3 offset:35840
    s_not_b64 exec, s[84:85]
    v_pk_mul_f32 v[20:21], v[20:21], v[16:17] op_sel:[0,1] op_sel_hi:[1,1]
    v_pk_mul_f32 v[22:23], v[22:23], v[16:17] op_sel:[0,1] op_sel_hi:[1,1]
    v_pk_mul_f32 v[24:25], v[24:25], v[16:17] op_sel:[0,1] op_sel_hi:[1,1]
    v_pk_mul_f32 v[26:27], v[26:27], v[16:17] op_sel:[0,1] op_sel_hi:[1,1]
    v_cvt_pk_bf16_f32 v12, v20, v21
    v_cvt_pk_bf16_f32 v13, v22, v23
    v_cvt_pk_bf16_f32 v14, v24, v25
    v_cvt_pk_bf16_f32 v15, v26, v27
    ds_write_b128 v8, v[12:15]
    s_mov_b64 exec, -1
    v_mov_b64 v[20:21], 0
    v_mov_b64 v[22:23], 0
    v_mov_b64 v[24:25], 0
    v_mov_b64 v[26:27], 0
    v_mov_b64 v[28:29], 0
    v_mov_b64 v[30:31], 0
    v_mov_b64 v[32:33], 0
    v_mov_b64 v[34:35], 0
    v_mov_b64 v[44:45], 0
    v_mov_b64 v[46:47], 0
    v_mov_b64 v[48:49], 0
    v_mov_b64 v[50:51], 0
    s_waitcnt lgkmcnt(0)
    s_barrier
    ds_read_b128 v[12:15], v2 offset:12288
    v_and_b32 v11, 0xffffffc0, v1
    ds_read_b128 v[16:19], v2 offset:14336
    v_and_b32 v9, 0x30, v1
    v_lshl_or_b32 v9, v11, 5, v9
    s_add_u32 s75, s75, 9216
    v_bfe_u32 v10, v1, 2, 6
    s_add_u32 s67, s67, 1
    v_and_b32 v11, 0x300, v1
    s_add_u32 s79, s79, 4
    v_lshl_or_b32 v10, v11, 3, v10
    s_add_u32 s77, s77, 24576
    v_mov_b64 v[52:53], 0
    s_add_u32 s78, s78, 24576
    v_mov_b64 v[54:55], 0
    s_mov_b32 s60, 1048576
    s_waitcnt lgkmcnt(1)
    v_smfmac_f32_16x16x64_bf16 v[20:23], v[12:15], v[56:63], v0
    ds_read_b128 v[56:59], v3 offset:28672
    s_waitcnt lgkmcnt(1)
    v_smfmac_f32_16x16x64_bf16 v[20:23], v[16:19], v[64:71], v0
    ds_read_b128 v[60:63], v3 offset:29696
    v_smfmac_f32_16x16x64_bf16 v[24:27], v[12:15], v[144:151], v0
    ds_read_b128 v[64:67], v3 offset:30720
    v_smfmac_f32_16x16x64_bf16 v[24:27], v[16:19], v[152:159], v0
    ds_read_b128 v[68:71], v3 offset:31744
    v_add_f32 v20, v20, v22
    v_smfmac_f32_16x16x64_bf16 v[28:31], v[12:15], v[160:167], v0
    v_add_f32 v21, v21, v23
    v_smfmac_f32_16x16x64_bf16 v[28:31], v[16:19], v[168:175], v0
    v_cvt_pk_bf16_f32 v20, v20, v21
    v_add_f32 v24, v24, v26
    v_smfmac_f32_16x16x64_bf16 v[32:35], v[12:15], v[176:183], v0
    v_add_f32 v25, v25, v27
    v_smfmac_f32_16x16x64_bf16 v[32:35], v[16:19], v[184:191], v0
    v_cvt_pk_bf16_f32 v21, v24, v25
    v_add_f32 v28, v28, v30
    v_smfmac_f32_16x16x64_bf16 v[36:39], v[12:15], v[192:199], v0
    v_add_f32 v29, v29, v31
    v_cvt_pk_bf16_f32 v22, v28, v29
    v_smfmac_f32_16x16x64_bf16 v[36:39], v[16:19], v[200:207], v0
    v_add_f32 v32, v32, v34
    v_add_f32 v33, v33, v35
    v_cvt_pk_bf16_f32 v23, v32, v33
    buffer_store_dwordx4 v[20:23], v9, s[8:11], s82 offen
    s_cmp_ge_u32 s3, 2
    v_smfmac_f32_16x16x64_bf16 v[40:43], v[12:15], v[208:215], v0
    v_smfmac_f32_16x16x64_bf16 v[40:43], v[16:19], v[216:223], v0
    v_add_f32 v36, v36, v38
    v_smfmac_f32_16x16x64_bf16 v[44:47], v[12:15], v[224:231], v0
    v_add_f32 v37, v37, v39
    v_smfmac_f32_16x16x64_bf16 v[44:47], v[16:19], v[232:239], v0
    v_cvt_pk_bf16_f32 v36, v36, v37
    v_add_f32 v40, v40, v42
    v_smfmac_f32_16x16x64_bf16 v[48:51], v[12:15], v[240:247], v0
    v_add_f32 v41, v41, v43
    v_smfmac_f32_16x16x64_bf16 v[48:51], v[16:19], v[248:255], v0
    v_cvt_pk_bf16_f32 v37, v40, v41
    v_add_f32 v44, v44, v46
    s_waitcnt lgkmcnt(2)
    v_smfmac_f32_16x16x64_bf16 v[52:55], v[12:15], v[56:63], v0
    v_add_f32 v45, v45, v47
    v_cvt_pk_bf16_f32 v38, v44, v45
    s_waitcnt lgkmcnt(0)
    v_smfmac_f32_16x16x64_bf16 v[52:55], v[16:19], v[64:71], v0
    v_add_f32 v48, v48, v50
    v_add_f32 v49, v49, v51
    v_cvt_pk_bf16_f32 v39, v48, v49
    buffer_store_dwordx4 v[36:39], v9, s[8:11], s55 offen
    s_nop 2
    s_nop 0
    v_add_f32 v52, v52, v54
    v_add_f32 v53, v53, v55
    v_cvt_pk_bf16_f32 v52, v52, v53
    buffer_store_dword v52, v10, s[8:11], s56 offen
    s_nop 15
    s_nop 3
    s_cbranch_scc1 L_ne_116
    buffer_load_dwordx4 v[72:75], v1, s[8:11], s80 offen sc1
    buffer_load_dwordx4 v[76:79], v1, s[8:11], s80 offen offset:1024 sc1
L_ne_116:
    v_and_b32 v8, 0xf0, v1
    ds_read_b128 v[52:55], v8 offset:8960
    ds_read_b128 v[56:59], v3 offset:0
    ds_read_b128 v[60:63], v3 offset:1024
    ds_read_b128 v[64:67], v3 offset:2048
    ds_read_b128 v[68:71], v3 offset:3072
    v_bfe_u32 v8, v1, 2, 4
    v_bfe_u32 v9, v1, 8, 2
    v_lshl_or_b32 v8, v9, 4, v8
    v_mov_b64 v[12:13], 0
    s_add_u32 s93, s73, s94
    s_and_b32 s73, s67, 1
    v_mov_b64 v[14:15], 0
    s_mul_i32 s73, s73, 294912
    s_add_u32 s73, s73, s68
    v_mov_b64 v[16:17], 0
    s_add_u32 s82, s73, s54
    s_add_u32 s55, s82, 32768
    v_mov_b64 v[18:19], 0
    s_lshl_b32 s56, s51, 2
    s_add_u32 s56, s56, s82
    v_mov_b64 v[20:21], 0
    s_add_u32 s56, s56, 262144
    s_sub_u32 s57, s75, s51
    v_mov_b64 v[22:23], 0
    s_add_u32 s57, s57, 8192
    s_add_u32 s58, s79, 131068
    v_mov_b64 v[24:25], 0
    s_add_u32 s59, s77, s51
    s_add_u32 s59, s59, 24576
    v_mov_b64 v[26:27], 0
    s_add_u32 s89, s79, 65540
    s_lshl_b32 s90, s69, 7
    v_mov_b64 v[28:29], 0
    s_add_u32 s90, s90, s75
    s_add_u32 s90, s90, 18432
    v_mov_b64 v[30:31], 0
    s_min_u32 s90, s90, s95
    v_mov_b64 v[32:33], 0
    v_mov_b64 v[34:35], 0
    s_cmp_ge_u32 s3, 2
    s_cbranch_scc1 L_odd_117
    s_waitcnt vmcnt(0) lgkmcnt(0)
L_red_120:
    v_mfma_f32_16x16x32_bf16 v[40:43], v[52:55], v[72:75], 0
    v_max3_u32 v10, v72, v73, v74
    v_max3_u32 v11, v75, v76, v77
    v_mfma_f32_16x16x32_bf16 v[40:43], v[52:55], v[76:79], v[40:43]
    v_max3_u32 v10, v10, v78, v79
    v_max_u32 v10, v10, v11
    v_cmp_eq_u32 vcc, -1, v10
    s_cbranch_vccnz L_redr_121
    s_nop 3
    v_add_f32_dpp v40, v40, v40 row_ror:4 row_mask:0xf bank_mask:0xf
    v_add_f32_dpp v41, v41, v41 row_ror:4 row_mask:0xf bank_mask:0xf
    s_nop 0
    v_add_f32_dpp v40, v40, v40 row_ror:8 row_mask:0xf bank_mask:0xf
    v_add_f32_dpp v41, v41, v41 row_ror:8 row_mask:0xf bank_mask:0xf
    s_mov_b64 exec, s[86:87]
    v_cvt_pk_bf16_f32 v40, v40, v41
    buffer_store_dword v40, v8, s[8:11], s74 offen
    s_mov_b64 exec, -1
    s_cmp_lg_u32 s71, 0
    s_cbranch_scc1 L_one_118
    buffer_load_dwordx4 v[44:47], v1, s[8:11], s81 offen sc1
    buffer_load_dwordx4 v[48:51], v1, s[8:11], s81 offen offset:1024 sc1
    v_mov_b32 v2, m0
    ds_read_b32 v2, v2 offset:128
    s_waitcnt lgkmcnt(0)
    v_readfirstlane_b32 s83, v2
    s_nop 15
    s_nop 15
    buffer_load_dwordx4 v[36:39], v1, s[8:11], s75 offen offset:0 sc1
    s_waitcnt vmcnt(1) lgkmcnt(0)
L_red_122:
    v_mfma_f32_16x16x32_bf16 v[40:43], v[52:55], v[44:47], 0
    v_max3_u32 v10, v44, v45, v46
    v_max3_u32 v11, v47, v48, v49
    v_mfma_f32_16x16x32_bf16 v[40:43], v[52:55], v[48:51], v[40:43]
    v_max3_u32 v10, v10, v50, v51
    v_max_u32 v10, v10, v11
    v_cmp_eq_u32 vcc, -1, v10
    s_cbranch_vccnz L_redr_123
    s_nop 3
    v_add_f32_dpp v40, v40, v40 row_ror:4 row_mask:0xf bank_mask:0xf
    v_add_f32_dpp v41, v41, v41 row_ror:4 row_mask:0xf bank_mask:0xf
    s_nop 0
    v_add_f32_dpp v40, v40, v40 row_ror:8 row_mask:0xf bank_mask:0xf
    v_add_f32_dpp v41, v41, v41 row_ror:8 row_mask:0xf bank_mask:0xf
    s_mov_b64 exec, s[86:87]
    v_cvt_pk_bf16_f32 v40, v40, v41
    buffer_store_dword v40, v8, s[8:11], s76 offen
    s_mov_b64 exec, -1
    buffer_load_dwordx4 v[36:39], v1, s[8:11], s75 offen offset:0 sc1
    s_mov_b32 s92, s80
    s_add_u32 s80, s70, s73
    s_add_u32 s81, s48, s73
    s_add_u32 s74, s74, 9216
    s_add_u32 s76, s76, 9216
    s_cmp_lg_u32 s83, 0
    s_cselect_b32 s91, s77, s68
    s_branch L_stepF
L_one_118:
    v_mov_b32 v2, m0
    ds_read_b32 v2, v2 offset:128
    s_waitcnt lgkmcnt(0)
    v_readfirstlane_b32 s83, v2
    s_nop 15
    buffer_load_dwordx4 v[36:39], v1, s[8:11], s75 offen offset:0 sc1
    s_nop 15
    s_nop 7
    buffer_load_dwordx4 v[36:39], v1, s[8:11], s75 offen offset:0 sc1
    s_nop 15
    s_nop 7
    buffer_load_dwordx4 v[36:39], v1, s[8:11], s75 offen offset:0 sc1
    s_mov_b32 s92, s80
    s_add_u32 s80, s70, s73
    s_add_u32 s81, s48, s73
    s_add_u32 s74, s74, 9216
    s_add_u32 s76, s76, 9216
    s_cmp_lg_u32 s83, 0
    s_cselect_b32 s91, s77, s68
    s_branch L_stepF
L_odd_117:
    buffer_load_dwordx4 v[72:75], v1, s[8:11], s80 offen sc1
    buffer_load_dwordx4 v[76:79], v1, s[8:11], s80 offen offset:1024 sc1
    s_waitcnt vmcnt(2)
    v_mov_b32 v2, m0
    ds_read_b32 v2, v2 offset:128
    s_waitcnt vmcnt(0) lgkmcnt(0)
L_red_124:
    v_mfma_f32_16x16x32_bf16 v[40:43], v[52:55], v[72:75], 0
    v_max3_u32 v10, v72, v73, v74
    v_max3_u32 v11, v75, v76, v77
    v_mfma_f32_16x16x32_bf16 v[40:43], v[52:55], v[76:79], v[40:43]
    v_max3_u32 v10, v10, v78, v79
    v_max_u32 v10, v10, v11
    v_cmp_eq_u32 vcc, -1, v10
    s_cbranch_vccnz L_redr_125
    s_nop 3
    v_add_f32_dpp v40, v40, v40 row_ror:4 row_mask:0xf bank_mask:0xf
    v_add_f32_dpp v41, v41, v41 row_ror:4 row_mask:0xf bank_mask:0xf
    s_nop 0
    v_add_f32_dpp v40, v40, v40 row_ror:8 row_mask:0xf bank_mask:0xf
    v_add_f32_dpp v41, v41, v41 row_ror:8 row_mask:0xf bank_mask:0xf
    s_mov_b64 exec, s[86:87]
    v_cvt_pk_bf16_f32 v40, v40, v41
    buffer_store_dword v40, v8, s[8:11], s74 offen
    s_mov_b64 exec, -1
    buffer_load_dwordx4 v[36:39], v1, s[8:11], s75 offen offset:0 sc1
    s_waitcnt lgkmcnt(0)
    v_readfirstlane_b32 s83, v2
    s_nop 15
    s_nop 7
    buffer_load_dwordx4 v[36:39], v1, s[8:11], s75 offen offset:0 sc1
    s_nop 15
    s_nop 7
    buffer_load_dwordx4 v[36:39], v1, s[8:11], s75 offen offset:0 sc1
    s_mov_b32 s92, s80
    s_add_u32 s80, s70, s73
    s_add_u32 s81, s48, s73
    s_add_u32 s74, s74, 9216
    s_add_u32 s76, s76, 9216
    s_cmp_lg_u32 s83, 0
    s_cselect_b32 s91, s77, s68
    s_branch L_stepF
L_redr_121:
    s_mov_b64 exec, vcc
    buffer_load_dwordx4 v[72:75], v1, s[8:11], s80 offen sc1
    buffer_load_dwordx4 v[76:79], v1, s[8:11], s80 offen offset:1024 sc1
    s_sub_u32 s60, s60, 1
    s_cbranch_scc1 L_abort
    s_mov_b64 exec, -1
    s_waitcnt vmcnt(0)
    s_branch L_red_120
L_redr_123:
    s_mov_b64 exec, vcc
    buffer_load_dwordx4 v[44:47], v1, s[8:11], s81 offen sc1
    buffer_load_dwordx4 v[48:51], v1, s[8:11], s81 offen offset:1024 sc1
    s_sub_u32 s60, s60, 1
    s_cbranch_scc1 L_abort
    s_mov_b64 exec, -1
    s_waitcnt vmcnt(0)
    s_branch L_red_122
L_redr_125:
    s_mov_b64 exec, vcc
    buffer_load_dwordx4 v[72:75], v1, s[8:11], s80 offen sc1
    buffer_load_dwordx4 v[76:79], v1, s[8:11], s80 offen offset:1024 sc1
    s_sub_u32 s60, s60, 1
    s_cbranch_scc1 L_abort
    s_mov_b64 exec, -1
    s_waitcnt vmcnt(0)
    s_branch L_red_124
L_ge_109:
    s_mov_b64 exec, vcc
    buffer_load_dwordx4 v[36:39], v1, s[8:11], s75 offen offset:0 sc1
    s_mov_b64 exec, -1
    s_nop 3
    v_mov_b64 v[12:13], 0
    v_mov_b64 v[14:15], 0
    v_mov_b64 v[16:17], 0
    v_mov_b64 v[18:19], 0
L_ge_126:
    s_waitcnt vmcnt(2)
    v_max3_u32 v2, v36, v37, v38
    v_max_u32 v2, v2, v39
    v_cmp_eq_u32 vcc, -1, v2
    s_cbranch_vccz L_stepbF
    s_mov_b64 exec, vcc
    buffer_load_dwordx4 v[36:39], v1, s[8:11], s75 offen offset:0 sc1
    s_sub_u32 s60, s60, 1
    s_cbranch_scc1 L_abort
    s_mov_b64 exec, -1
    s_branch L_ge_126
L_go_110:
    s_mov_b64 exec, vcc
    buffer_load_dwordx4 v[48:51], v1, s[8:11], s75 offen offset:1024 sc1
    s_sub_u32 s60, s60, 1
    s_cbranch_scc1 L_abort
    s_mov_b64 exec, -1
    s_waitcnt vmcnt(0)
    v_max3_u32 v2, v48, v49, v50
    v_max_u32 v2, v2, v51
    v_cmp_eq_u32 vcc, -1, v2
    s_cbranch_vccnz L_go_110
    s_branch L_gook_111
L_t8_112:
    s_mov_b64 exec, vcc
    buffer_load_dwordx4 v[8:11], v1, s[8:11], s57 offen sc1
    s_sub_u32 s60, s60, 1
    s_cbranch_scc1 L_abort
    s_mov_b64 exec, -1
    s_waitcnt vmcnt(0)
    v_max3_u32 v2, v8, v9, v10
    v_max_u32 v2, v2, v11
    v_cmp_eq_u32 vcc, -1, v2
    s_cbranch_vccnz L_t8_112
    s_branch L_t8ok_113
L_kvwait_114:
    s_cmp_eq_u32 s67, 63
    s_cbranch_scc1 L_kvok_115
    s_sub_u32 s83, s89, 4
    s_mov_b32 s60, 1048576
L_poll_127:
    buffer_load_dword v2, v5, s[8:11], s83 offen sc1
    s_waitcnt vmcnt(0)
    v_cmp_eq_u32 vcc, 0, v2
    s_cbranch_vccz L_pdone_128
    s_sleep 1
    s_sub_u32 s60, s60, 1
    s_cbranch_scc1 L_abort
    s_branch L_poll_127
L_pdone_128:
    buffer_load_dwordx4 v[36:39], v1, s[8:11], s77 offen offset:0 sc1
    buffer_load_dwordx4 v[40:43], v1, s[8:11], s77 offen offset:1024 sc1
    buffer_load_dwordx4 v[72:75], v1, s[8:11], s77 offen offset:2048 sc1
    buffer_load_dwordx4 v[76:79], v1, s[8:11], s77 offen offset:3072 sc1
    s_waitcnt vmcnt(0)
    s_branch L_kvok_115
L_lastF:
    s_add_u32 s80, s79, 131072
    s_mov_b64 exec, 1
    s_waitcnt vmcnt(0)
    buffer_store_dword v0, v5, s[8:11], s80 offen sc1
    s_mov_b64 exec, -1
    s_endpgm
L_chain_safe:
    ds_read_b128 v[56:59], v3 offset:0
    ds_read_b128 v[60:63], v3 offset:1024
    ds_read_b128 v[64:67], v3 offset:2048
    ds_read_b128 v[68:71], v3 offset:3072
    v_mov_b64 v[12:13], 0
    v_mov_b64 v[14:15], 0
    v_mov_b64 v[16:17], 0
    v_mov_b64 v[18:19], 0
    v_mov_b64 v[20:21], 0
    v_mov_b64 v[22:23], 0
    v_mov_b64 v[24:25], 0
    v_mov_b64 v[26:27], 0
    v_mov_b64 v[28:29], 0
    v_mov_b64 v[30:31], 0
    v_mov_b64 v[32:33], 0
    v_mov_b64 v[34:35], 0
    s_add_u32 s95, s75, 589696
    s_add_u32 s74, s49, s75
    s_add_u32 s76, s50, s75
    s_add_u32 s93, s73, s94
    s_and_b32 s73, s67, 1
    s_mul_i32 s73, s73, 294912
    s_add_u32 s73, s73, s68
    s_add_u32 s82, s73, s54
    s_add_u32 s55, s82, 32768
    s_lshl_b32 s56, s51, 2
    s_add_u32 s56, s56, s82
    s_add_u32 s56, s56, 262144
    s_sub_u32 s57, s75, s51
    s_add_u32 s57, s57, 8192
    s_add_u32 s58, s79, 131068
    s_add_u32 s59, s77, s51
    s_add_u32 s59, s59, 24576
    s_add_u32 s89, s79, 65540
    s_lshl_b32 s90, s69, 7
    s_add_u32 s90, s90, s75
    s_add_u32 s90, s90, 18432
    s_min_u32 s90, s90, s95
    s_mov_b32 s92, s80
    s_add_u32 s80, s70, s73
    s_add_u32 s81, s48, s73
    s_add_u32 s74, s74, 9216
    s_add_u32 s76, s76, 9216
    s_cmp_lg_u32 s83, 0
    s_cselect_b32 s91, s77, s68
    s_add_u32 s58, s78, s51
    s_add_u32 s58, s58, 1792
    s_mov_b32 s60, 1048576
    s_waitcnt lgkmcnt(0)
L_stepS:
    s_waitcnt vmcnt(2)
    v_max3_u32 v2, v36, v37, v38
    v_max_u32 v2, v2, v39
L_stepbS:
    ds_write_b128 v1, v[36:39]
    v_smfmac_f32_16x16x64_bf16 v[12:15], v[36:39], v[56:63], v0
    v_cmp_eq_u32 vcc, -1, v2
    v_smfmac_f32_16x16x64_bf16 v[16:19], v[36:39], v[64:71], v0
    s_cbranch_vccnz L_ge_129
    v_xor_b32 v2, 2048, v1
    s_waitcnt lgkmcnt(0)
    s_barrier
    ds_read_b128 v[8:11], v2 offset:0
    v_smfmac_f32_16x16x64_bf16 v[20:23], v[36:39], a[80:87], v0
    buffer_load_dwordx4 v[48:51], v1, s[8:11], s75 offen offset:1024 sc1
    ds_read_b128 v[56:59], v3 offset:4096
    v_smfmac_f32_16x16x64_bf16 v[24:27], v[36:39], a[88:95], v0
    ds_read_b128 v[60:63], v3 offset:5120
    ds_read_b128 v[64:67], v3 offset:6144
    v_smfmac_f32_16x16x64_bf16 v[28:31], v[36:39], a[192:199], v0
    ds_read_b128 v[68:71], v3 offset:7168
    v_xor_b32 v2, 4096, v1
    v_smfmac_f32_16x16x64_bf16 v[32:35], v[36:39], a[200:207], v0
    ds_read_b128 v[52:55], v2 offset:0
    v_xor_b32 v2, 6144, v1
    s_waitcnt lgkmcnt(5)
    v_smfmac_f32_16x16x64_bf16 v[20:23], v[8:11], a[112:119], v0
    ds_read_b128 v[44:47], v2 offset:0
    v_smfmac_f32_16x16x64_bf16 v[24:27], v[8:11], a[120:127], v0
    buffer_load_dwordx4 v[72:75], v1, s[8:11], s91 offen offset:2048 sc1
    v_smfmac_f32_16x16x64_bf16 v[28:31], v[8:11], a[224:231], v0
    v_smfmac_f32_16x16x64_bf16 v[32:35], v[8:11], a[232:239], v0
    buffer_load_dwordx4 v[76:79], v1, s[8:11], s91 offen offset:3072 sc1
    s_waitcnt lgkmcnt(4)
    v_smfmac_f32_16x16x64_bf16 v[12:15], v[8:11], v[56:63], v0
    ds_read_b128 v[56:59], v3 offset:8192
    s_waitcnt lgkmcnt(3)
    v_smfmac_f32_16x16x64_bf16 v[16:19], v[8:11], v[64:71], v0
    ds_read_b128 v[60:63], v3 offset:9216
    s_waitcnt lgkmcnt(3)
    v_smfmac_f32_16x16x64_bf16 v[20:23], v[52:55], a[144:151], v0
    ds_read_b128 v[64:67], v3 offset:10240
    v_smfmac_f32_16x16x64_bf16 v[24:27], v[52:55], a[152:159], v0
    ds_read_b128 v[68:71], v3 offset:11264
    v_smfmac_f32_16x16x64_bf16 v[28:31], v[52:55], v[80:87], v0
    buffer_load_dwordx4 v[8:11], v1, s[8:11], s57 offen sc1
    v_smfmac_f32_16x16x64_bf16 v[32:35], v[52:55], v[88:95], v0
    s_waitcnt lgkmcnt(4)
    v_smfmac_f32_16x16x64_bf16 v[20:23], v[44:47], a[160:167], v0
    buffer_load_dwordx4 v[40:43], v1, s[8:11], s91 offen offset:1024 sc1
    v_smfmac_f32_16x16x64_bf16 v[24:27], v[44:47], a[168:175], v0
    s_waitcnt vmcnt(4)
    v_max3_u32 v2, v48, v49, v50
    v_smfmac_f32_16x16x64_bf16 v[28:31], v[44:47], v[112:119], v0
    v_max_u32 v2, v2, v51
    v_smfmac_f32_16x16x64_bf16 v[32:35], v[44:47], v[120:127], v0
    v_cmp_eq_u32 vcc, -1, v2
    s_waitcnt lgkmcnt(2)
    v_smfmac_f32_16x16x64_bf16 v[12:15], v[52:55], v[56:63], v0
    ds_read_b128 v[56:59], v3 offset:12288
    s_cbranch_vccnz L_go_130
L_gook_131:
    ds_write_b128 v1, v[48:51] offset:1024
    s_waitcnt lgkmcnt(2)
    v_smfmac_f32_16x16x64_bf16 v[16:19], v[52:55], v[64:71], v0
    ds_read_b128 v[60:63], v3 offset:13312
    v_smfmac_f32_16x16x64_bf16 v[12:15], v[48:51], a[0:7], v0
    ds_read_b128 v[64:67], v3 offset:14336
    buffer_load_dwordx4 v[36:39], v1, s[8:11], s91 offen offset:0 sc1
    v_smfmac_f32_16x16x64_bf16 v[16:19], v[48:51], a[8:15], v0
    ds_read_b128 v[68:71], v3 offset:15360
    v_xor_b32 v2, 4096, v1
    v_smfmac_f32_16x16x64_bf16 v[20:23], v[48:51], a[96:103], v0
    s_waitcnt lgkmcnt(3)
    s_barrier
    ds_read_b128 v[52:55], v2 offset:1024
    v_smfmac_f32_16x16x64_bf16 v[24:27], v[48:51], a[104:111], v0
    buffer_store_dword v0, v5, s[8:11], s58 offen sc1
    v_smfmac_f32_16x16x64_bf16 v[28:31], v[48:51], a[208:215], v0
    v_xor_b32 v2, 6144, v1
    v_smfmac_f32_16x16x64_bf16 v[32:35], v[48:51], a[216:223], v0
    ds_read_b128 v[48:51], v2 offset:1024
    s_waitcnt lgkmcnt(4)
    v_smfmac_f32_16x16x64_bf16 v[12:15], v[44:47], v[56:63], v0
    ds_read_b128 v[56:59], v3 offset:16384
    v_and_b32 v2, 0x1f0, v1
    s_waitcnt lgkmcnt(3)
    v_smfmac_f32_16x16x64_bf16 v[16:19], v[44:47], v[64:71], v0
    ds_read_b128 v[60:63], v3 offset:17408
    v_lshl_add_u32 v2, v2, 3, s59
    s_waitcnt lgkmcnt(3)
    v_smfmac_f32_16x16x64_bf16 v[12:15], v[52:55], a[32:39], v0
    ds_read_b128 v[64:67], v3 offset:18432
    v_writelane_b32 v2, s89, 32
    v_smfmac_f32_16x16x64_bf16 v[16:19], v[52:55], a[40:47], v0
    ds_read_b128 v[68:71], v3 offset:19456
    v_writelane_b32 v2, s90, 33
    buffer_load_dword v2, s[8:11], 0 offen sc1 lds
    v_smfmac_f32_16x16x64_bf16 v[28:31], v[52:55], v[96:103], v0
    v_xor_b32 v2, 2048, v1
    ds_read_b128 v[44:47], v2 offset:1024
    v_smfmac_f32_16x16x64_bf16 v[32:35], v[52:55], v[104:111], v0
    s_waitcnt vmcnt(4)
    v_max3_u32 v2, v8, v9, v10
    s_waitcnt lgkmcnt(5)
    v_smfmac_f32_16x16x64_bf16 v[12:15], v[48:51], a[48:55], v0
    v_max_u32 v2, v2, v11
    v_smfmac_f32_16x16x64_bf16 v[16:19], v[48:51], a[56:63], v0
    v_cmp_eq_u32 vcc, -1, v2
    s_waitcnt lgkmcnt(3)
    v_smfmac_f32_16x16x64_bf16 v[20:23], v[52:55], v[56:63], v0
    ds_read_b128 v[56:59], v3 offset:20480
    s_cbranch_vccnz L_t8_132
L_t8ok_133:
    s_waitcnt lgkmcnt(2)
    v_smfmac_f32_16x16x64_bf16 v[24:27], v[52:55], v[64:71], v0
    ds_read_b128 v[60:63], v3 offset:21504
    v_mov_b64 v[52:53], -1
    s_waitcnt lgkmcnt(2)
    v_smfmac_f32_16x16x64_bf16 v[12:15], v[44:47], a[16:23], v0
    ds_read_b128 v[64:67], v3 offset:22528
    v_mov_b64 v[54:55], -1
    v_smfmac_f32_16x16x64_bf16 v[16:19], v[44:47], a[24:31], v0
    ds_read_b128 v[68:71], v3 offset:23552
    v_lshrrev_b32 v2, 2, v1
    v_smfmac_f32_16x16x64_bf16 v[12:15], v[8:11], a[64:71], v0
    buffer_store_dwordx4 v[52:55], v1, s[8:11], s92 offen sc1
    v_smfmac_f32_16x16x64_bf16 v[16:19], v[8:11], a[72:79], v0
    buffer_store_dword v52, v2, s[8:11], s93 offen sc1
    v_smfmac_f32_16x16x64_bf16 v[20:23], v[44:47], a[128:135], v0
    v_add_f32 v12, v12, v14
    v_smfmac_f32_16x16x64_bf16 v[24:27], v[44:47], a[136:143], v0
    s_cmp_eq_u32 s83, 0
    s_cbranch_scc1 L_kvwait_134
L_kvok_135:
    v_add_f32 v13, v13, v15
    v_smfmac_f32_16x16x64_bf16 v[20:23], v[8:11], a[176:183], v0
    buffer_store_dwordx4 v[52:55], v1, s[8:11], s92 offen offset:1024 sc1
    v_smfmac_f32_16x16x64_bf16 v[24:27], v[8:11], a[184:191], v0
    v_add_f32 v16, v16, v18
    s_waitcnt lgkmcnt(2)
    v_smfmac_f32_16x16x64_bf16 v[20:23], v[48:51], v[56:63], v0
    ds_read_b128 v[56:59], v3 offset:24576
    v_add_f32 v17, v17, v19
    s_waitcnt lgkmcnt(1)
    v_smfmac_f32_16x16x64_bf16 v[24:27], v[48:51], v[64:71], v0
    ds_read_b128 v[60:63], v3 offset:25600
    v_and_b32 v2, 0x3ff, v1
    v_cvt_pk_bf16_f32 v52, v12, v13
    v_cvt_pk_bf16_f32 v53, v16, v17
    ds_read_b128 v[64:67], v3 offset:26624
    ds_read_b128 v[68:71], v3 offset:27648
    v_mfma_f32_16x16x16_bf16 v[12:15], v[52:53], v[4:5], 0
    v_add_f32 v20, v20, v22
    v_add_f32 v21, v21, v23
    v_mfma_f32_16x16x16_bf16 v[16:19], v[52:53], v[6:7], 0
    v_add_f32 v24, v24, v26
    v_add_f32 v25, v25, v27
    v_cvt_pk_bf16_f32 v54, v20, v21
    v_cvt_pk_bf16_f32 v55, v24, v25
    v_smfmac_f32_16x16x64_bf16 v[28:31], v[44:47], a[240:247], v0
    v_mfma_f32_16x16x16_bf16 v[20:23], v[54:55], v[4:5], 0
    v_cvt_pk_bf16_f32 v12, v12, v13
    v_cvt_pk_bf16_f32 v13, v14, v15
    v_mfma_f32_16x16x16_bf16 v[24:27], v[54:55], v[6:7], 0
    v_cvt_pk_bf16_f32 v14, v16, v17
    v_cvt_pk_bf16_f32 v15, v18, v19
    v_smfmac_f32_16x16x64_bf16 v[32:35], v[44:47], a[248:255], v0
    s_waitcnt vmcnt(5)
    v_mfma_f32_16x16x32_bf16 v[16:19], v[36:39], v[12:15], 0
    v_cvt_pk_bf16_f32 v44, v20, v21
    v_cvt_pk_bf16_f32 v45, v22, v23
    v_mfma_f32_16x16x32_bf16 v[52:55], v[40:43], v[12:15], 0
    v_cvt_pk_bf16_f32 v46, v24, v25
    v_cvt_pk_bf16_f32 v47, v26, v27
    v_add_u32 v20, s53, v2
    s_nop 0
    v_mfma_f32_16x16x32_bf16 v[24:27], v[44:47], v[12:15], 0
    v_smfmac_f32_16x16x64_bf16 v[28:31], v[48:51], v[128:135], v0
    v_cndmask_b32 v16, v16, v52, s[84:85]
    v_cndmask_b32 v17, v17, v53, s[84:85]
    v_cndmask_b32 v18, v18, v54, s[84:85]
    v_cndmask_b32 v19, v19, v55, s[84:85]
    v_cndmask_b32 v24, v24, v25, s[84:85]
    v_smfmac_f32_16x16x64_bf16 v[32:35], v[48:51], v[136:143], v0
    ds_write_b128 v1, v[16:19] offset:9216
    ds_write_b32 v20, v24
    s_waitcnt lgkmcnt(4)
    v_smfmac_f32_16x16x64_bf16 v[28:31], v[8:11], v[56:63], v0
    s_waitcnt lgkmcnt(2)
    v_smfmac_f32_16x16x64_bf16 v[32:35], v[8:11], v[64:71], v0
    v_and_b32 v8, 0xf0, v1
    v_mov_b64 v[36:37], 0
    v_mov_b64 v[38:39], 0
    v_mov_b64 v[40:41], 0
    v_mov_b64 v[42:43], 0
    s_waitcnt lgkmcnt(0)
    s_barrier
    ds_read_b128 v[12:15], v2 offset:9216
    v_pk_add_f32 v[28:29], v[28:29], v[30:31]
    ds_read_b128 v[16:19], v2 offset:11264
    v_pk_add_f32 v[32:33], v[32:33], v[34:35]
    ds_read_b128 v[20:23], v2 offset:13312
    v_cvt_pk_bf16_f32 v28, v28, v29
    ds_read_b128 v[24:27], v2 offset:15360
    v_cvt_pk_bf16_f32 v29, v32, v33
    ds_read_b128 v[52:55], v2 offset:10240
    v_cvt_pk_bf16_f32 v30, v32, v33
    v_mov_b32_dpp v32, v28 quad_perm:[2,3,0,1] row_mask:0xf bank_mask:0xf
    v_mov_b32_dpp v33, v29 quad_perm:[2,3,0,1] row_mask:0xf bank_mask:0xf
    v_cndmask_b32 v44, v44, v28, s[84:85]
    v_cndmask_b32 v45, v45, v29, s[84:85]
    v_cndmask_b32 v46, v46, v32, s[84:85]
    v_cndmask_b32 v47, v47, v33, s[84:85]
    buffer_store_dwordx4 v[44:47], v1, s[8:11], s78 offen sc1
    v_mov_b32 v31, 0
    s_cmp_eq_u32 s67, 63
    s_cbranch_scc1 L_lastS
    s_waitcnt lgkmcnt(3)
    v_pk_add_f32 v[12:13], v[12:13], v[16:17]
    v_pk_add_f32 v[14:15], v[14:15], v[18:19]
    s_waitcnt lgkmcnt(1)
    v_pk_add_f32 v[20:21], v[20:21], v[24:25]
    v_pk_add_f32 v[22:23], v[22:23], v[26:27]
    s_waitcnt lgkmcnt(0)
    v_pk_add_f32 v[52:53], v[52:53], v[54:55]
    v_pk_add_f32 v[12:13], v[12:13], v[20:21]
    v_pk_add_f32 v[14:15], v[14:15], v[22:23]
    v_add_f32 v16, v52, v53
    v_max3_f32 v17, v12, v13, v14
    v_max3_f32 v17, v17, v15, v16
    v_bfe_u32 v11, v1, 8, 1
    v_lshl_or_b32 v8, v11, 5, v8
    v_max_f32_dpp v17, v17, v17 quad_perm:[2,3,0,1] row_mask:0xf bank_mask:0xf
    v_mov_b32 v18, v17
    v_bfe_u32 v11, v1, 9, 1
    v_lshl_or_b32 v8, v11, 8, v8
    v_permlane16_swap_b32 v17, v18
    v_max_f32 v17, v17, v18
    v_mov_b32 v18, v17
    v_add_u32 v8, s52, v8
    v_mov_b32 v35, 0
    v_permlane32_swap_b32 v17, v18
    v_max_f32 v17, v17, v18
    v_mul_f32 v17, s88, v17
    v_fma_f32 v12, v12, s88, -v17
    v_fma_f32 v13, v13, s88, -v17
    v_fma_f32 v14, v14, s88, -v17
    v_fma_f32 v15, v15, s88, -v17
    v_fma_f32 v16, v16, s88, -v17
    v_exp_f32 v16, v16
    v_exp_f32 v12, v12
    v_exp_f32 v13, v13
    v_exp_f32 v14, v14
    v_exp_f32 v15, v15
    v_cvt_pk_bf16_f32 v52, v12, v13
    v_cvt_pk_bf16_f32 v53, v14, v15
    v_mov_b32_dpp v34, v16 quad_perm:[2,3,0,1] row_mask:0xf bank_mask:0xf
    v_mov_b32_dpp v54, v52 quad_perm:[2,3,0,1] row_mask:0xf bank_mask:0xf
    v_mov_b32_dpp v55, v53 quad_perm:[2,3,0,1] row_mask:0xf bank_mask:0xf
    v_cvt_pk_bf16_f32 v34, v16, v34
    v_pk_add_f32 v[12:13], v[12:13], v[14:15]
    v_mfma_f32_16x16x32_bf16 v[20:23], v[72:75], v[52:55], 0
    v_add_f32 v12, v12, v16
    v_add_f32 v17, v12, v13
    v_mfma_f32_16x16x32_bf16 v[24:27], v[76:79], v[52:55], 0
    ds_read_b128 v[56:59], v3 offset:32768
    v_add_f32_dpp v17, v17, v17 quad_perm:[2,3,0,1] row_mask:0xf bank_mask:0xf
    v_mov_b32 v18, v17
    v_mfma_f32_16x16x16_bf16 v[20:23], v[28:29], v[34:35], v[20:23]
    ds_read_b128 v[60:63], v3 offset:33792
    v_permlane16_swap_b32 v17, v18
    v_add_f32 v17, v17, v18
    v_mov_b32 v18, v17
    v_mfma_f32_16x16x16_bf16 v[24:27], v[30:31], v[34:35], v[24:27]
    ds_read_b128 v[64:67], v3 offset:34816
    v_permlane32_swap_b32 v17, v18
    v_add_f32 v17, v17, v18
    v_rcp_f32 v17, v17
    ds_read_b128 v[68:71], v3 offset:35840
    s_not_b64 exec, s[84:85]
    v_pk_mul_f32 v[20:21], v[20:21], v[16:17] op_sel:[0,1] op_sel_hi:[1,1]
    v_pk_mul_f32 v[22:23], v[22:23], v[16:17] op_sel:[0,1] op_sel_hi:[1,1]
    v_pk_mul_f32 v[24:25], v[24:25], v[16:17] op_sel:[0,1] op_sel_hi:[1,1]
    v_pk_mul_f32 v[26:27], v[26:27], v[16:17] op_sel:[0,1] op_sel_hi:[1,1]
    v_cvt_pk_bf16_f32 v12, v20, v21
    v_cvt_pk_bf16_f32 v13, v22, v23
    v_cvt_pk_bf16_f32 v14, v24, v25
    v_cvt_pk_bf16_f32 v15, v26, v27
    ds_write_b128 v8, v[12:15]
    s_mov_b64 exec, -1
    v_mov_b64 v[20:21], 0
    v_mov_b64 v[22:23], 0
    v_mov_b64 v[24:25], 0
    v_mov_b64 v[26:27], 0
    v_mov_b64 v[28:29], 0
    v_mov_b64 v[30:31], 0
    v_mov_b64 v[32:33], 0
    v_mov_b64 v[34:35], 0
    v_mov_b64 v[44:45], 0
    v_mov_b64 v[46:47], 0
    v_mov_b64 v[48:49], 0
    v_mov_b64 v[50:51], 0
    s_waitcnt lgkmcnt(0)
    s_barrier
    ds_read_b128 v[12:15], v2 offset:12288
    v_and_b32 v11, 0xffffffc0, v1
    ds_read_b128 v[16:19], v2 offset:14336
    v_and_b32 v9, 0x30, v1
    v_lshl_or_b32 v9, v11, 5, v9
    s_add_u32 s75, s75, 9216
    v_bfe_u32 v10, v1, 2, 6
    s_add_u32 s67, s67, 1
    v_and_b32 v11, 0x300, v1
    s_add_u32 s79, s79, 4
    v_lshl_or_b32 v10, v11, 3, v10
    s_add_u32 s77, s77, 24576
    v_mov_b64 v[52:53], 0
    s_add_u32 s78, s78, 24576
    v_mov_b64 v[54:55], 0
    s_mov_b32 s60, 1048576
    s_waitcnt lgkmcnt(1)
    v_smfmac_f32_16x16x64_bf16 v[20:23], v[12:15], v[56:63], v0
    ds_read_b128 v[56:59], v3 offset:28672
    s_waitcnt lgkmcnt(1)
    v_smfmac_f32_16x16x64_bf16 v[20:23], v[16:19], v[64:71], v0
    ds_read_b128 v[60:63], v3 offset:29696
    v_smfmac_f32_16x16x64_bf16 v[24:27], v[12:15], v[144:151], v0
    ds_read_b128 v[64:67], v3 offset:30720
    v_smfmac_f32_16x16x64_bf16 v[24:27], v[16:19], v[152:159], v0
    ds_read_b128 v[68:71], v3 offset:31744
    v_add_f32 v20, v20, v22
    v_smfmac_f32_16x16x64_bf16 v[28:31], v[12:15], v[160:167], v0
    v_add_f32 v21, v21, v23
    v_smfmac_f32_16x16x64_bf16 v[28:31], v[16:19], v[168:175], v0
    v_cvt_pk_bf16_f32 v20, v20, v21
    v_add_f32 v24, v24, v26
    v_smfmac_f32_16x16x64_bf16 v[32:35], v[12:15], v[176:183], v0
    v_add_f32 v25, v25, v27
    v_smfmac_f32_16x16x64_bf16 v[32:35], v[16:19], v[184:191], v0
    v_cvt_pk_bf16_f32 v21, v24, v25
    v_add_f32 v28, v28, v30
    v_smfmac_f32_16x16x64_bf16 v[36:39], v[12:15], v[192:199], v0
    v_add_f32 v29, v29, v31
    v_cvt_pk_bf16_f32 v22, v28, v29
    v_smfmac_f32_16x16x64_bf16 v[36:39], v[16:19], v[200:207], v0
    v_add_f32 v32, v32, v34
    v_add_f32 v33, v33, v35
    v_cvt_pk_bf16_f32 v23, v32, v33
    buffer_store_dwordx4 v[20:23], v9, s[8:11], s82 offen sc1
    s_cmp_ge_u32 s3, 2
    v_smfmac_f32_16x16x64_bf16 v[40:43], v[12:15], v[208:215], v0
    v_smfmac_f32_16x16x64_bf16 v[40:43], v[16:19], v[216:223], v0
    v_add_f32 v36, v36, v38
    v_smfmac_f32_16x16x64_bf16 v[44:47], v[12:15], v[224:231], v0
    v_add_f32 v37, v37, v39
    v_smfmac_f32_16x16x64_bf16 v[44:47], v[16:19], v[232:239], v0
    v_cvt_pk_bf16_f32 v36, v36, v37
    v_add_f32 v40, v40, v42
    v_smfmac_f32_16x16x64_bf16 v[48:51], v[12:15], v[240:247], v0
    v_add_f32 v41, v41, v43
    v_smfmac_f32_16x16x64_bf16 v[48:51], v[16:19], v[248:255], v0
    v_cvt_pk_bf16_f32 v37, v40, v41
    v_add_f32 v44, v44, v46
    s_waitcnt lgkmcnt(2)
    v_smfmac_f32_16x16x64_bf16 v[52:55], v[12:15], v[56:63], v0
    v_add_f32 v45, v45, v47
    v_cvt_pk_bf16_f32 v38, v44, v45
    s_waitcnt lgkmcnt(0)
    v_smfmac_f32_16x16x64_bf16 v[52:55], v[16:19], v[64:71], v0
    v_add_f32 v48, v48, v50
    v_add_f32 v49, v49, v51
    v_cvt_pk_bf16_f32 v39, v48, v49
    buffer_store_dwordx4 v[36:39], v9, s[8:11], s55 offen sc1
    s_nop 2
    s_nop 0
    v_add_f32 v52, v52, v54
    v_add_f32 v53, v53, v55
    v_cvt_pk_bf16_f32 v52, v52, v53
    buffer_store_dword v52, v10, s[8:11], s56 offen sc1
    s_nop 15
    s_nop 3
    s_cbranch_scc1 L_ne_136
    buffer_load_dwordx4 v[72:75], v1, s[8:11], s80 offen sc1
    buffer_load_dwordx4 v[76:79], v1, s[8:11], s80 offen offset:1024 sc1
L_ne_136:
    v_and_b32 v8, 0xf0, v1
    ds_read_b128 v[52:55], v8 offset:8960
    ds_read_b128 v[56:59], v3 offset:0
    ds_read_b128 v[60:63], v3 offset:1024
    ds_read_b128 v[64:67], v3 offset:2048
    ds_read_b128 v[68:71], v3 offset:3072
    v_bfe_u32 v8, v1, 2, 4
    v_bfe_u32 v9, v1, 8, 2
    v_lshl_or_b32 v8, v9, 4, v8
    v_mov_b64 v[12:13], 0
    s_add_u32 s93, s73, s94
    s_and_b32 s73, s67, 1
    v_mov_b64 v[14:15], 0
    s_mul_i32 s73, s73, 294912
    s_add_u32 s73, s73, s68
    v_mov_b64 v[16:17], 0
    s_add_u32 s82, s73, s54
    s_add_u32 s55, s82, 32768
    v_mov_b64 v[18:19], 0
    s_lshl_b32 s56, s51, 2
    s_add_u32 s56, s56, s82
    v_mov_b64 v[20:21], 0
    s_add_u32 s56, s56, 262144
    s_sub_u32 s57, s75, s51
    v_mov_b64 v[22:23], 0
    s_add_u32 s57, s57, 8192
    s_add_u32 s58, s79, 131068
    v_mov_b64 v[24:25], 0
    s_add_u32 s59, s77, s51
    s_add_u32 s59, s59, 24576
    v_mov_b64 v[26:27], 0
    s_add_u32 s89, s79, 65540
    s_lshl_b32 s90, s69, 7
    v_mov_b64 v[28:29], 0
    s_add_u32 s90, s90, s75
    s_add_u32 s90, s90, 18432
    v_mov_b64 v[30:31], 0
    s_min_u32 s90, s90, s95
    v_mov_b64 v[32:33], 0
    v_mov_b64 v[34:35], 0
    s_cmp_ge_u32 s3, 2
    s_cbranch_scc1 L_odd_137
    s_waitcnt vmcnt(0) lgkmcnt(0)
L_red_140:
    v_mfma_f32_16x16x32_bf16 v[40:43], v[52:55], v[72:75], 0
    v_max3_u32 v10, v72, v73, v74
    v_max3_u32 v11, v75, v76, v77
    v_mfma_f32_16x16x32_bf16 v[40:43], v[52:55], v[76:79], v[40:43]
    v_max3_u32 v10, v10, v78, v79
    v_max_u32 v10, v10, v11
    v_cmp_eq_u32 vcc, -1, v10
    s_cbranch_vccnz L_redr_141
    s_nop 3
    v_add_f32_dpp v40, v40, v40 row_ror:4 row_mask:0xf bank_mask:0xf
    v_add_f32_dpp v41, v41, v41 row_ror:4 row_mask:0xf bank_mask:0xf
    s_nop 0
    v_add_f32_dpp v40, v40, v40 row_ror:8 row_mask:0xf bank_mask:0xf
    v_add_f32_dpp v41, v41, v41 row_ror:8 row_mask:0xf bank_mask:0xf
    s_mov_b64 exec, s[86:87]
    v_cvt_pk_bf16_f32 v40, v40, v41
    buffer_store_dword v40, v8, s[8:11], s74 offen sc1
    s_mov_b64 exec, -1
    s_cmp_lg_u32 s71, 0
    s_cbranch_scc1 L_one_138
    buffer_load_dwordx4 v[44:47], v1, s[8:11], s81 offen sc1
    buffer_load_dwordx4 v[48:51], v1, s[8:11], s81 offen offset:1024 sc1
    v_mov_b32 v2, m0
    ds_read_b32 v2, v2 offset:128
    s_waitcnt lgkmcnt(0)
    v_readfirstlane_b32 s83, v2
    s_nop 15
    s_nop 15
    buffer_load_dwordx4 v[36:39], v1, s[8:11], s75 offen offset:0 sc1
    s_waitcnt vmcnt(1) lgkmcnt(0)
L_red_142:
    v_mfma_f32_16x16x32_bf16 v[40:43], v[52:55], v[44:47], 0
    v_max3_u32 v10, v44, v45, v46
    v_max3_u32 v11, v47, v48, v49
    v_mfma_f32_16x16x32_bf16 v[40:43], v[52:55], v[48:51], v[40:43]
    v_max3_u32 v10, v10, v50, v51
    v_max_u32 v10, v10, v11
    v_cmp_eq_u32 vcc, -1, v10
    s_cbranch_vccnz L_redr_143
    s_nop 3
    v_add_f32_dpp v40, v40, v40 row_ror:4 row_mask:0xf bank_mask:0xf
    v_add_f32_dpp v41, v41, v41 row_ror:4 row_mask:0xf bank_mask:0xf
    s_nop 0
    v_add_f32_dpp v40, v40, v40 row_ror:8 row_mask:0xf bank_mask:0xf
    v_add_f32_dpp v41, v41, v41 row_ror:8 row_mask:0xf bank_mask:0xf
    s_mov_b64 exec, s[86:87]
    v_cvt_pk_bf16_f32 v40, v40, v41
    buffer_store_dword v40, v8, s[8:11], s76 offen sc1
    s_mov_b64 exec, -1
    buffer_load_dwordx4 v[36:39], v1, s[8:11], s75 offen offset:0 sc1
    s_mov_b32 s92, s80
    s_add_u32 s80, s70, s73
    s_add_u32 s81, s48, s73
    s_add_u32 s74, s74, 9216
    s_add_u32 s76, s76, 9216
    s_cmp_lg_u32 s83, 0
    s_cselect_b32 s91, s77, s68
    s_branch L_stepS
L_one_138:
    v_mov_b32 v2, m0
    ds_read_b32 v2, v2 offset:128
    s_waitcnt lgkmcnt(0)
    v_readfirstlane_b32 s83, v2
    s_nop 15
    buffer_load_dwordx4 v[36:39], v1, s[8:11], s75 offen offset:0 sc1
    s_nop 15
    s_nop 7
    buffer_load_dwordx4 v[36:39], v1, s[8:11], s75 offen offset:0 sc1
    s_nop 15
    s_nop 7
    buffer_load_dwordx4 v[36:39], v1, s[8:11], s75 offen offset:0 sc1
    s_mov_b32 s92, s80
    s_add_u32 s80, s70, s73
    s_add_u32 s81, s48, s73
    s_add_u32 s74, s74, 9216
    s_add_u32 s76, s76, 9216
    s_cmp_lg_u32 s83, 0
    s_cselect_b32 s91, s77, s68
    s_branch L_stepS
L_odd_137:
    buffer_load_dwordx4 v[72:75], v1, s[8:11], s80 offen sc1
    buffer_load_dwordx4 v[76:79], v1, s[8:11], s80 offen offset:1024 sc1
    s_waitcnt vmcnt(2)
    v_mov_b32 v2, m0
    ds_read_b32 v2, v2 offset:128
    s_waitcnt vmcnt(0) lgkmcnt(0)
L_red_144:
    v_mfma_f32_16x16x32_bf16 v[40:43], v[52:55], v[72:75], 0
    v_max3_u32 v10, v72, v73, v74
    v_max3_u32 v11, v75, v76, v77
    v_mfma_f32_16x16x32_bf16 v[40:43], v[52:55], v[76:79], v[40:43]
    v_max3_u32 v10, v10, v78, v79
    v_max_u32 v10, v10, v11
    v_cmp_eq_u32 vcc, -1, v10
    s_cbranch_vccnz L_redr_145
    s_nop 3
    v_add_f32_dpp v40, v40, v40 row_ror:4 row_mask:0xf bank_mask:0xf
    v_add_f32_dpp v41, v41, v41 row_ror:4 row_mask:0xf bank_mask:0xf
    s_nop 0
    v_add_f32_dpp v40, v40, v40 row_ror:8 row_mask:0xf bank_mask:0xf
    v_add_f32_dpp v41, v41, v41 row_ror:8 row_mask:0xf bank_mask:0xf
    s_mov_b64 exec, s[86:87]
    v_cvt_pk_bf16_f32 v40, v40, v41
    buffer_store_dword v40, v8, s[8:11], s74 offen sc1
    s_mov_b64 exec, -1
    buffer_load_dwordx4 v[36:39], v1, s[8:11], s75 offen offset:0 sc1
    s_waitcnt lgkmcnt(0)
    v_readfirstlane_b32 s83, v2
    s_nop 15
    s_nop 7
    buffer_load_dwordx4 v[36:39], v1, s[8:11], s75 offen offset:0 sc1
    s_nop 15
    s_nop 7
    buffer_load_dwordx4 v[36:39], v1, s[8:11], s75 offen offset:0 sc1
    s_mov_b32 s92, s80
    s_add_u32 s80, s70, s73
    s_add_u32 s81, s48, s73
    s_add_u32 s74, s74, 9216
    s_add_u32 s76, s76, 9216
    s_cmp_lg_u32 s83, 0
    s_cselect_b32 s91, s77, s68
    s_branch L_stepS
L_redr_141:
    s_mov_b64 exec, vcc
    buffer_load_dwordx4 v[72:75], v1, s[8:11], s80 offen sc1
    buffer_load_dwordx4 v[76:79], v1, s[8:11], s80 offen offset:1024 sc1
    s_sub_u32 s60, s60, 1
    s_cbranch_scc1 L_abort
    s_mov_b64 exec, -1
    s_waitcnt vmcnt(0)
    s_branch L_red_140
L_redr_143:
    s_mov_b64 exec, vcc
    buffer_load_dwordx4 v[44:47], v1, s[8:11], s81 offen sc1
    buffer_load_dwordx4 v[48:51], v1, s[8:11], s81 offen offset:1024 sc1
    s_sub_u32 s60, s60, 1
    s_cbranch_scc1 L_abort
    s_mov_b64 exec, -1
    s_waitcnt vmcnt(0)
    s_branch L_red_142
L_redr_145:
    s_mov_b64 exec, vcc
    buffer_load_dwordx4 v[72:75], v1, s[8:11], s80 offen sc1
    buffer_load_dwordx4 v[76:79], v1, s[8:11], s80 offen offset:1024 sc1
    s_sub_u32 s60, s60, 1
    s_cbranch_scc1 L_abort
    s_mov_b64 exec, -1
    s_waitcnt vmcnt(0)
    s_branch L_red_144
L_ge_129:
    s_mov_b64 exec, vcc
    buffer_load_dwordx4 v[36:39], v1, s[8:11], s75 offen offset:0 sc1
    s_mov_b64 exec, -1
    s_nop 3
    v_mov_b64 v[12:13], 0
    v_mov_b64 v[14:15], 0
    v_mov_b64 v[16:17], 0
    v_mov_b64 v[18:19], 0
L_ge_146:
    s_waitcnt vmcnt(2)
    v_max3_u32 v2, v36, v37, v38
    v_max_u32 v2, v2, v39
    v_cmp_eq_u32 vcc, -1, v2
    s_cbranch_vccz L_stepbS
    s_mov_b64 exec, vcc
    buffer_load_dwordx4 v[36:39], v1, s[8:11], s75 offen offset:0 sc1
    s_sub_u32 s60, s60, 1
    s_cbranch_scc1 L_abort
    s_mov_b64 exec, -1
    s_branch L_ge_146
L_go_130:
    s_mov_b64 exec, vcc
    buffer_load_dwordx4 v[48:51], v1, s[8:11], s75 offen offset:1024 sc1
    s_sub_u32 s60, s60, 1
    s_cbranch_scc1 L_abort
    s_mov_b64 exec, -1
    s_waitcnt vmcnt(0)
    v_max3_u32 v2, v48, v49, v50
    v_max_u32 v2, v2, v51
    v_cmp_eq_u32 vcc, -1, v2
    s_cbranch_vccnz L_go_130
    s_branch L_gook_131
L_t8_132:
    s_mov_b64 exec, vcc
    buffer_load_dwordx4 v[8:11], v1, s[8:11], s57 offen sc1
    s_sub_u32 s60, s60, 1
    s_cbranch_scc1 L_abort
    s_mov_b64 exec, -1
    s_waitcnt vmcnt(0)
    v_max3_u32 v2, v8, v9, v10
    v_max_u32 v2, v2, v11
    v_cmp_eq_u32 vcc, -1, v2
    s_cbranch_vccnz L_t8_132
    s_branch L_t8ok_133
L_kvwait_134:
    s_cmp_eq_u32 s67, 63
    s_cbranch_scc1 L_kvok_135
    s_sub_u32 s83, s89, 4
    s_mov_b32 s60, 1048576
L_poll_147:
    buffer_load_dword v2, v5, s[8:11], s83 offen sc1
    s_waitcnt vmcnt(0)
    v_cmp_eq_u32 vcc, 0, v2
    s_cbranch_vccz L_pdone_148
    s_sleep 1
    s_sub_u32 s60, s60, 1
    s_cbranch_scc1 L_abort
    s_branch L_poll_147
L_pdone_148:
    buffer_load_dwordx4 v[36:39], v1, s[8:11], s77 offen offset:0 sc1
    buffer_load_dwordx4 v[40:43], v1, s[8:11], s77 offen offset:1024 sc1
    buffer_load_dwordx4 v[72:75], v1, s[8:11], s77 offen offset:2048 sc1
    buffer_load_dwordx4 v[76:79], v1, s[8:11], s77 offen offset:3072 sc1
    s_waitcnt vmcnt(0)
    s_branch L_kvok_135
L_lastS:
    s_add_u32 s80, s79, 131072
    s_mov_b64 exec, 1
    s_waitcnt vmcnt(0)
    buffer_store_dword v0, v5, s[8:11], s80 offen sc1
    s_mov_b64 exec, -1
    s_endpgm
L_renumber:
    s_load_dwordx16 s[16:31], s[0:1], 0
    s_waitcnt vmcnt(0) lgkmcnt(0)
    s_cmp_lg_u32 s7, 0
    s_cbranch_scc1 L_abort
    s_mov_b32 s7, 1
    s_cmp_eq_u32 vcc_lo, 0
    s_cbranch_scc1 L_ticket
    s_mov_b32 s6, 1
    s_and_b32 s4, s2, 7
    s_lshr_b32 s5, s2, 3
    s_barrier
    s_branch L_restart
L_ticket:
    s_barrier
    v_mov_b32 v2, 0
    s_cmp_lg_u32 s3, 0
    s_cbranch_scc1 L_ticket2
    s_lshl_b32 s64, s61, 5
    s_add_u32 s64, s64, 16
    v_mov_b32 v1, 1
    s_mov_b64 exec, 1
    buffer_atomic_add v1, v2, s[12:15], s64 offen sc0
    s_waitcnt vmcnt(0)
    ds_write_b32 v2, v1
    s_waitcnt lgkmcnt(0)
    s_mov_b64 exec, -1
L_ticket2:
    s_barrier
    ds_read_b32 v1, v2
    s_waitcnt lgkmcnt(0)
    v_and_b32 v1, 31, v1
    s_nop 0
    v_readfirstlane_b32 s5, v1
    s_barrier
    s_branch L_restart
L_abort:
    s_endpgm
.section .rodata,"a"
.p2align 6
.amdhsa_kernel interleave_layers__ssm_conv_h3__memory_aug_recurrent_mem_tr__prompt_kernel
  .amdhsa_next_free_vgpr 512
  .amdhsa_next_free_sgpr 102
  .amdhsa_accum_offset 256
  .amdhsa_group_segment_fixed_size 0
  .amdhsa_kernarg_size 128
  .amdhsa_user_sgpr_count 2
  .amdhsa_user_sgpr_kernarg_segment_ptr 1
  .amdhsa_system_sgpr_workgroup_id_x 1
.end_amdhsa_kernel
```
